```python
import torch

def _softmax(x, axis=-1):
    return torch.softmax(x, dim=axis)
def _gelu(x):
    return torch.nn.functional.gelu(x, approximate="tanh")
def _silu(x):
    return torch.nn.functional.silu(x)
def _sigmoid(x):
    return torch.sigmoid(x)
def _layernorm(x, axis=-1, eps=1e-5):
    m = x.mean(dim=axis, keepdim=True)
    v = x.var(dim=axis, keepdim=True, unbiased=False)
    return (x - m) / torch.sqrt(v + eps)
def _scatter_add(tgt, idx, src, axis=0):
    return tgt.clone().index_add_(axis, idx, src)
def _segment_sum(src, seg, n):
    out = torch.zeros((n,) + src.shape[1:], dtype=src.dtype)
    return out.index_add_(0, seg, src)
def _pad(x, pw):
    flat = tuple(v for pair in reversed(pw) for v in pair)
    return torch.nn.functional.pad(x, flat)

kernel_name = 'recurrent_scan__mha_block_cached__glu_gated_swiglu__decode'

def setup_inputs():

    _w = (lambda a: (lambda t: t.to(torch.bfloat16) if t.is_floating_point() else t)(torch.as_tensor(a)))
    def _A_setup():
        B, Sq, D = 8, 1, 576
        H, Sk, Dh = 32, 4096, 128
        return {
            "x": _w((lambda *s: torch.randn(*s, dtype=torch.bfloat16) * 0.05)(B, Sq, D)),
            "k_cache": _w((lambda *s: torch.randn(*s, dtype=torch.bfloat16) * 3.2)(B, H, Sk, Dh)),
            "v_cache": _w((lambda *s: torch.randn(*s, dtype=torch.bfloat16) * 3.2)(B, H, Sk, Dh)),
            "wq": _w((lambda *s: torch.randn(*s, dtype=torch.bfloat16) * 3.2)(D, H * Dh) * (D ** -0.5)),
            "wo": _w((lambda *s: torch.randn(*s, dtype=torch.bfloat16) * 3.2)(H * Dh, D) * ((H * Dh) ** -0.5)),
        }
    _A_in = _A_setup()

    def _B_setup():
        B, S, D, F = 8, 1, 576, 4608
        return {
            "x": _w((lambda *s: torch.randn(*s, dtype=torch.bfloat16) * 0.05)(B, S, D)),
            "w1": _w((lambda *s: torch.randn(*s, dtype=torch.bfloat16) * 0.4)(D, F) * (2.0 / D) ** 0.5),
            "w3": _w((lambda *s: torch.randn(*s, dtype=torch.bfloat16) * 0.4)(D, F) * (2.0 / D) ** 0.5),
            "w2": _w((lambda *s: torch.randn(*s, dtype=torch.bfloat16) * 0.4)(F, D) * (2.0 / F) ** 0.5),
        }
    _B_in = _B_setup()

    return {
        "A_x": _A_in["x"],
        "A_k_cache": _A_in["k_cache"],
        "A_v_cache": _A_in["v_cache"],
        "A_wq": _A_in["wq"],
        "A_wo": _A_in["wo"],
        "B_x": _B_in["x"],
        "B_w1": _B_in["w1"],
        "B_w3": _B_in["w3"],
        "B_w2": _B_in["w2"],
    }

def reference(A_x, A_k_cache, A_v_cache, A_wq, A_wo, B_x, B_w1, B_w3, B_w2):
    def _A_ref(x, k_cache, v_cache, wq, wo):
        B, Sq, D = x.shape
        H, Dh = 32, 128
        q = (lambda x, *d: x.permute(*d))((x @ wq).reshape(B, Sq, H, Dh), 0, 2, 1, 3)
        scores = torch.einsum("bhqd,bhkd->bhqk", q, k_cache) * (Dh ** -0.5)
        p = _softmax(scores, axis=-1)
        o = torch.einsum("bhqk,bhkd->bhqd", p, v_cache)
        return (lambda x, *d: x.permute(*d))(o, 0, 2, 1, 3).reshape(B, Sq, H * Dh) @ wo

    def _B_ref(x, w1, w3, w2):
        gate = torch.einsum("bsd,df->bsf", x, w1)
        up = torch.einsum("bsd,df->bsf", x, w3)
        h = _silu(gate) * up
        out = torch.einsum("bsf,fd->bsd", h, w2)
        return out

    x = A_x
    xn = _layernorm(x, axis=-1)
    s = _A_ref(xn, A_k_cache, A_v_cache, A_wq, A_wo)
    g = _silu(_B_ref(xn, B_w1, B_w3, B_w2))
    return x + s * g
```

```asm
; @launch grid=(256,1,1) block=(320,1,1) lds=154496
.amdgcn_target "amdgcn-amd-amdhsa--gfx950"
.text
.globl recurrent_scan__mha_block_cached__glu_gated_swiglu__decode_kernel
.p2align 8
.type recurrent_scan__mha_block_cached__glu_gated_swiglu__decode_kernel,@function
recurrent_scan__mha_block_cached__glu_gated_swiglu__decode_kernel:
    s_cmp_ge_u32 s2, 256
    s_cbranch_scc1 L_end2
    s_load_dwordx16 s[4:19], s[0:1], 0
    s_load_dwordx8 s[20:27], s[0:1], 64
    v_lshrrev_b32 v4, 6, v0
    v_and_b32 v1, 63, v0
    v_readfirstlane_b32 s28, v4
    v_lshrrev_b32 v2, 4, v1
    v_and_b32 v3, 15, v1
    s_and_b32 s64, s2, 7
    s_lshl_b32 s64, s64, 2
    s_bfe_u32 s65, s2, 0x20003
    s_add_u32 s30, s64, s65
    s_lshr_b32 s29, s2, 5
    s_cmp_eq_u32 s28, 4
    s_cbranch_scc1 L_helper
    s_lshl_b32 s31, s29, 5
    s_add_u32 s31, s31, s30
    v_lshlrev_b32 v20, 4, v1
    s_lshl_b32 s64, s28, 10
    v_add_u32 v20, s64, v20
    s_lshl_b32 s67, s31, 20
    s_setprio 2
    s_waitcnt lgkmcnt(0)
    s_add_u32 s32, s6, s67
    s_addc_u32 s33, s7, 0
    s_mov_b32 s34, 1048576
    s_mov_b32 s35, 0x20000
    s_mov_b32 s66, 0
    buffer_load_dwordx4 v[48:51], v20, s[32:35], s66 offen nt
    s_mov_b32 s66, 4096
    buffer_load_dwordx4 v[52:55], v20, s[32:35], s66 offen nt
    s_mov_b32 s66, 8192
    buffer_load_dwordx4 v[56:59], v20, s[32:35], s66 offen nt
    s_mov_b32 s66, 12288
    buffer_load_dwordx4 v[60:63], v20, s[32:35], s66 offen nt
    s_mov_b32 s66, 16384
    buffer_load_dwordx4 v[64:67], v20, s[32:35], s66 offen nt
    s_mov_b32 s66, 20480
    buffer_load_dwordx4 v[68:71], v20, s[32:35], s66 offen nt
    s_mov_b32 s66, 24576
    buffer_load_dwordx4 v[72:75], v20, s[32:35], s66 offen nt
    s_mov_b32 s66, 28672
    buffer_load_dwordx4 v[76:79], v20, s[32:35], s66 offen nt
    s_mov_b32 s66, 32768
    buffer_load_dwordx4 v[80:83], v20, s[32:35], s66 offen nt
    s_mov_b32 s66, 36864
    buffer_load_dwordx4 v[84:87], v20, s[32:35], s66 offen nt
    s_mov_b32 s66, 40960
    buffer_load_dwordx4 v[88:91], v20, s[32:35], s66 offen nt
    s_mov_b32 s66, 45056
    buffer_load_dwordx4 v[92:95], v20, s[32:35], s66 offen nt
    s_barrier
    s_add_u32 s36, s8, s67
    s_addc_u32 s37, s9, 0
    s_mov_b32 s38, 1048576
    s_mov_b32 s39, 0x20000
    s_mul_i32 s65, s29, 1152
    s_add_u32 s40, s4, s65
    s_addc_u32 s41, s5, 0
    s_mov_b32 s42, 1152
    s_mov_b32 s43, 0x20000
    s_add_u32 s56, s22, s65
    s_addc_u32 s57, s23, 0
    s_mov_b32 s58, 1152
    s_mov_b32 s59, 0x20000
    s_mov_b32 s60, s24
    s_mov_b32 s61, s25
    s_mov_b32 s62, 256
    s_mov_b32 s63, 0x20000
    s_mov_b32 s52, s26
    s_mov_b32 s53, s27
    s_mov_b32 s54, 679936
    s_mov_b32 s55, 0x20000
    v_mov_b32 v0, 0
    s_mov_b32 s64, 36864
    buffer_load_dword v0, v0, s[52:55], s64 offen
    s_getreg_b32 s78, hwreg(HW_REG_XCC_ID, 0, 4)
    s_lshl_b32 s78, s78, 8
    s_add_u32 s78, s78, 655360
    s_lshr_b32 s64, s2, 3
    s_lshl_b32 s64, s64, 2
    s_add_u32 s64, s64, s78
    s_cmp_eq_u32 s28, 0
    s_cselect_b32 s79, s64, 679936
    v_and_b32 v28, 1, v1
    v_lshlrev_b32 v28, 4, v28
    v_mov_b32 v29, 0xffff
    v_lshlrev_b32 v29, v28, v29
    v_bfe_u32 v28, v1, 1, 2
    v_cmp_eq_u32 vcc, 0, v28
    s_nop 1
    v_cndmask_b32 v4, 0, v29, vcc
    v_cmp_eq_u32 vcc, 1, v28
    s_nop 1
    v_cndmask_b32 v5, 0, v29, vcc
    v_cmp_eq_u32 vcc, 2, v28
    s_nop 1
    v_cndmask_b32 v6, 0, v29, vcc
    v_cmp_eq_u32 vcc, 3, v28
    s_nop 1
    v_cndmask_b32 v7, 0, v29, vcc
    s_mov_b32 s70, 0xcccccccc
    s_mov_b32 s71, 0xcccccccc
    s_mov_b32 s72, 0xaaaaaaaa
    s_mov_b32 s73, 0xaaaaaaaa
    v_and_b32 v28, 1, v2
    v_lshlrev_b32 v28, 4, v28
    v_lshl_add_u32 v31, v3, 5, v28
    s_lshl_b32 s64, s28, 9
    s_add_u32 s64, s64, 147456
    v_add_u32 v31, s64, v31
    v_lshlrev_b32 v28, 4, v3
    v_add_u32 v28, 154176, v28
    v_mov_b32 v30, 0xff800000
    s_waitcnt vmcnt(6)
    s_mov_b32 s66, 49152
    buffer_load_dwordx4 v[96:99], v20, s[32:35], s66 offen nt
    s_waitcnt vmcnt(6)
    s_mov_b32 s66, 53248
    buffer_load_dwordx4 v[100:103], v20, s[32:35], s66 offen nt
    s_waitcnt vmcnt(6)
    s_mov_b32 s66, 57344
    buffer_load_dwordx4 v[104:107], v20, s[32:35], s66 offen nt
    s_waitcnt vmcnt(6)
    s_mov_b32 s66, 61440
    buffer_load_dwordx4 v[108:111], v20, s[32:35], s66 offen nt
    s_waitcnt vmcnt(6)
    s_mov_b32 s66, 65536
    buffer_load_dwordx4 v[112:115], v20, s[32:35], s66 offen nt
    s_waitcnt vmcnt(6)
    s_mov_b32 s66, 69632
    buffer_load_dwordx4 v[116:119], v20, s[32:35], s66 offen nt
    s_waitcnt vmcnt(5)
    s_mov_b32 s66, 73728
    buffer_load_dwordx4 v[120:123], v20, s[32:35], s66 offen nt
    s_waitcnt vmcnt(5)
    s_mov_b32 s66, 77824
    buffer_load_dwordx4 v[124:127], v20, s[32:35], s66 offen nt
    s_waitcnt vmcnt(5)
    s_mov_b32 s66, 81920
    buffer_load_dwordx4 v[128:131], v20, s[32:35], s66 offen nt
    s_waitcnt vmcnt(5)
    s_mov_b32 s66, 86016
    buffer_load_dwordx4 v[132:135], v20, s[32:35], s66 offen nt
    s_waitcnt vmcnt(5)
    s_mov_b32 s66, 90112
    buffer_load_dwordx4 v[136:139], v20, s[32:35], s66 offen nt
    s_waitcnt vmcnt(5)
    s_mov_b32 s66, 94208
    buffer_load_dwordx4 v[140:143], v20, s[32:35], s66 offen nt
    s_waitcnt vmcnt(5)
    s_mov_b32 s66, 98304
    buffer_load_dwordx4 v[144:147], v20, s[32:35], s66 offen nt
    s_waitcnt vmcnt(5)
    s_mov_b32 s66, 102400
    buffer_load_dwordx4 v[148:151], v20, s[32:35], s66 offen nt
    s_waitcnt vmcnt(5)
    s_mov_b32 s66, 106496
    buffer_load_dwordx4 v[152:155], v20, s[32:35], s66 offen nt
    s_waitcnt vmcnt(5)
    s_mov_b32 s66, 110592
    buffer_load_dwordx4 v[156:159], v20, s[32:35], s66 offen nt
    s_waitcnt vmcnt(5)
    s_mov_b32 s66, 114688
    buffer_load_dwordx4 v[160:163], v20, s[32:35], s66 offen nt
    s_waitcnt vmcnt(5)
    s_mov_b32 s66, 118784
    buffer_load_dwordx4 v[164:167], v20, s[32:35], s66 offen nt
    s_waitcnt vmcnt(5)
    s_mov_b32 s66, 122880
    buffer_load_dwordx4 v[168:171], v20, s[32:35], s66 offen nt
    s_waitcnt vmcnt(5)
    s_mov_b32 s66, 126976
    buffer_load_dwordx4 v[172:175], v20, s[32:35], s66 offen nt
    s_waitcnt vmcnt(5)
    s_mov_b32 s66, 131072
    buffer_load_dwordx4 v[176:179], v20, s[32:35], s66 offen nt
    s_waitcnt vmcnt(5)
    s_mov_b32 s66, 135168
    buffer_load_dwordx4 v[180:183], v20, s[32:35], s66 offen nt
    s_waitcnt vmcnt(5)
    s_mov_b32 s66, 139264
    buffer_load_dwordx4 v[184:187], v20, s[32:35], s66 offen nt
    s_waitcnt vmcnt(5)
    s_mov_b32 s66, 143360
    buffer_load_dwordx4 v[188:191], v20, s[32:35], s66 offen nt
    s_waitcnt vmcnt(5)
    s_mov_b32 s66, 147456
    buffer_load_dwordx4 v[192:195], v20, s[32:35], s66 offen nt
    s_waitcnt vmcnt(5)
    s_mov_b32 s66, 151552
    buffer_load_dwordx4 v[196:199], v20, s[32:35], s66 offen nt
    s_waitcnt vmcnt(5)
    s_mov_b32 s66, 155648
    buffer_load_dwordx4 v[200:203], v20, s[32:35], s66 offen nt
    s_waitcnt vmcnt(5)
    s_mov_b32 s66, 159744
    buffer_load_dwordx4 v[204:207], v20, s[32:35], s66 offen nt
    s_waitcnt vmcnt(5)
    s_mov_b32 s66, 163840
    buffer_load_dwordx4 v[208:211], v20, s[32:35], s66 offen nt
    s_waitcnt vmcnt(5)
    s_mov_b32 s66, 167936
    buffer_load_dwordx4 v[212:215], v20, s[32:35], s66 offen nt
    s_waitcnt vmcnt(5)
    s_mov_b32 s66, 172032
    buffer_load_dwordx4 v[216:219], v20, s[32:35], s66 offen nt
    s_waitcnt vmcnt(5)
    s_mov_b32 s66, 176128
    buffer_load_dwordx4 v[220:223], v20, s[32:35], s66 offen nt
    s_waitcnt vmcnt(5)
    s_mov_b32 s66, 180224
    buffer_load_dwordx4 v[224:227], v20, s[32:35], s66 offen nt
    s_waitcnt vmcnt(5)
    s_mov_b32 s66, 184320
    buffer_load_dwordx4 v[228:231], v20, s[32:35], s66 offen nt
    s_waitcnt vmcnt(5)
    s_mov_b32 s66, 188416
    buffer_load_dwordx4 v[232:235], v20, s[32:35], s66 offen nt
    s_waitcnt vmcnt(5)
    s_mov_b32 s66, 192512
    buffer_load_dwordx4 v[236:239], v20, s[32:35], s66 offen nt
    v_readfirstlane_b32 s74, v0
    s_nop 0
    s_add_u32 s74, s74, 1
    s_lshl_b32 s74, s74, 6
    v_mov_b32 v0, s74
    v_mov_b32 v29, 154464
    s_nop 2
L_qwait:
    ds_read_b32 v23, v29
    s_waitcnt lgkmcnt(0)
    v_readfirstlane_b32 s64, v23
    s_nop 0
    s_cmp_lg_u32 s64, 0
    s_nop 2
    s_cbranch_scc1 L_qgo
    s_sleep 1
    s_branch L_qwait
L_qgo:
    ds_read_b128 v[16:19], v28
    s_waitcnt lgkmcnt(0)
    v_dot2_f32_bf16 v21, v48, v16, 0
    v_dot2_f32_bf16 v21, v49, v17, v21
    v_dot2_f32_bf16 v21, v50, v18, v21
    v_dot2_f32_bf16 v21, v51, v19, v21
    s_waitcnt vmcnt(5)
    s_mov_b32 s66, 196608
    buffer_load_dwordx4 v[48:51], v20, s[32:35], s66 offen nt
    v_dot2_f32_bf16 v23, v52, v16, 0
    v_dot2_f32_bf16 v23, v53, v17, v23
    v_dot2_f32_bf16 v23, v54, v18, v23
    v_dot2_f32_bf16 v23, v55, v19, v23
    v_add_f32_dpp v21, v21, v21 row_ror:8 row_mask:0xf bank_mask:0x3
    s_nop 1
    v_add_f32_dpp v21, v23, v23 row_ror:8 row_mask:0xf bank_mask:0xc
    v_dot2_f32_bf16 v22, v56, v16, 0
    v_dot2_f32_bf16 v22, v57, v17, v22
    v_dot2_f32_bf16 v22, v58, v18, v22
    v_dot2_f32_bf16 v22, v59, v19, v22
    s_waitcnt vmcnt(5)
    s_mov_b32 s66, 200704
    buffer_load_dwordx4 v[52:55], v20, s[32:35], s66 offen nt
    v_dot2_f32_bf16 v23, v60, v16, 0
    v_dot2_f32_bf16 v23, v61, v17, v23
    v_dot2_f32_bf16 v23, v62, v18, v23
    v_dot2_f32_bf16 v23, v63, v19, v23
    v_add_f32_dpp v22, v22, v22 row_ror:8 row_mask:0xf bank_mask:0x3
    s_nop 1
    v_add_f32_dpp v22, v23, v23 row_ror:8 row_mask:0xf bank_mask:0xc
    v_add_f32_dpp v24, v21, v21 row_ror:12 row_mask:0xf bank_mask:0x5
    s_nop 0
    v_add_f32_dpp v24, v22, v22 row_ror:4 row_mask:0xf bank_mask:0xa
    v_dot2_f32_bf16 v21, v64, v16, 0
    v_dot2_f32_bf16 v21, v65, v17, v21
    v_dot2_f32_bf16 v21, v66, v18, v21
    v_dot2_f32_bf16 v21, v67, v19, v21
    s_waitcnt vmcnt(5)
    s_mov_b32 s66, 204800
    buffer_load_dwordx4 v[56:59], v20, s[32:35], s66 offen nt
    v_dot2_f32_bf16 v23, v68, v16, 0
    v_dot2_f32_bf16 v23, v69, v17, v23
    v_dot2_f32_bf16 v23, v70, v18, v23
    v_dot2_f32_bf16 v23, v71, v19, v23
    v_add_f32_dpp v21, v21, v21 row_ror:8 row_mask:0xf bank_mask:0x3
    s_nop 1
    v_add_f32_dpp v21, v23, v23 row_ror:8 row_mask:0xf bank_mask:0xc
    v_dot2_f32_bf16 v22, v72, v16, 0
    v_dot2_f32_bf16 v22, v73, v17, v22
    v_dot2_f32_bf16 v22, v74, v18, v22
    v_dot2_f32_bf16 v22, v75, v19, v22
    s_waitcnt vmcnt(5)
    s_mov_b32 s66, 208896
    buffer_load_dwordx4 v[60:63], v20, s[32:35], s66 offen nt
    v_dot2_f32_bf16 v23, v76, v16, 0
    v_dot2_f32_bf16 v23, v77, v17, v23
    v_dot2_f32_bf16 v23, v78, v18, v23
    v_dot2_f32_bf16 v23, v79, v19, v23
    v_add_f32_dpp v22, v22, v22 row_ror:8 row_mask:0xf bank_mask:0x3
    s_nop 1
    v_add_f32_dpp v22, v23, v23 row_ror:8 row_mask:0xf bank_mask:0xc
    v_add_f32_dpp v25, v21, v21 row_ror:12 row_mask:0xf bank_mask:0x5
    s_nop 0
    v_add_f32_dpp v25, v22, v22 row_ror:4 row_mask:0xf bank_mask:0xa
    v_add_f32_dpp v28, v24, v24 quad_perm:[2,3,0,1] row_mask:0xf bank_mask:0xf
    s_nop 0
    v_add_f32_dpp v29, v25, v25 quad_perm:[2,3,0,1] row_mask:0xf bank_mask:0xf
    v_cndmask_b32 v26, v28, v29, s[70:71]
    v_dot2_f32_bf16 v21, v80, v16, 0
    v_dot2_f32_bf16 v21, v81, v17, v21
    v_dot2_f32_bf16 v21, v82, v18, v21
    v_dot2_f32_bf16 v21, v83, v19, v21
    s_waitcnt vmcnt(5)
    s_mov_b32 s66, 212992
    buffer_load_dwordx4 v[64:67], v20, s[32:35], s66 offen nt
    v_dot2_f32_bf16 v23, v84, v16, 0
    v_dot2_f32_bf16 v23, v85, v17, v23
    v_dot2_f32_bf16 v23, v86, v18, v23
    v_dot2_f32_bf16 v23, v87, v19, v23
    v_add_f32_dpp v21, v21, v21 row_ror:8 row_mask:0xf bank_mask:0x3
    s_nop 1
    v_add_f32_dpp v21, v23, v23 row_ror:8 row_mask:0xf bank_mask:0xc
    v_dot2_f32_bf16 v22, v88, v16, 0
    v_dot2_f32_bf16 v22, v89, v17, v22
    v_dot2_f32_bf16 v22, v90, v18, v22
    v_dot2_f32_bf16 v22, v91, v19, v22
    s_waitcnt vmcnt(5)
    s_mov_b32 s66, 217088
    buffer_load_dwordx4 v[68:71], v20, s[32:35], s66 offen nt
    v_dot2_f32_bf16 v23, v92, v16, 0
    v_dot2_f32_bf16 v23, v93, v17, v23
    v_dot2_f32_bf16 v23, v94, v18, v23
    v_dot2_f32_bf16 v23, v95, v19, v23
    v_add_f32_dpp v22, v22, v22 row_ror:8 row_mask:0xf bank_mask:0x3
    s_nop 1
    v_add_f32_dpp v22, v23, v23 row_ror:8 row_mask:0xf bank_mask:0xc
    v_add_f32_dpp v24, v21, v21 row_ror:12 row_mask:0xf bank_mask:0x5
    s_nop 0
    v_add_f32_dpp v24, v22, v22 row_ror:4 row_mask:0xf bank_mask:0xa
    v_dot2_f32_bf16 v21, v96, v16, 0
    v_dot2_f32_bf16 v21, v97, v17, v21
    v_dot2_f32_bf16 v21, v98, v18, v21
    v_dot2_f32_bf16 v21, v99, v19, v21
    s_waitcnt vmcnt(5)
    s_mov_b32 s66, 221184
    buffer_load_dwordx4 v[72:75], v20, s[32:35], s66 offen nt
    v_dot2_f32_bf16 v23, v100, v16, 0
    v_dot2_f32_bf16 v23, v101, v17, v23
    v_dot2_f32_bf16 v23, v102, v18, v23
    v_dot2_f32_bf16 v23, v103, v19, v23
    v_add_f32_dpp v21, v21, v21 row_ror:8 row_mask:0xf bank_mask:0x3
    s_nop 1
    v_add_f32_dpp v21, v23, v23 row_ror:8 row_mask:0xf bank_mask:0xc
    v_dot2_f32_bf16 v22, v104, v16, 0
    v_dot2_f32_bf16 v22, v105, v17, v22
    v_dot2_f32_bf16 v22, v106, v18, v22
    v_dot2_f32_bf16 v22, v107, v19, v22
    s_waitcnt vmcnt(5)
    s_mov_b32 s66, 225280
    buffer_load_dwordx4 v[76:79], v20, s[32:35], s66 offen nt
    v_dot2_f32_bf16 v23, v108, v16, 0
    v_dot2_f32_bf16 v23, v109, v17, v23
    v_dot2_f32_bf16 v23, v110, v18, v23
    v_dot2_f32_bf16 v23, v111, v19, v23
    v_add_f32_dpp v22, v22, v22 row_ror:8 row_mask:0xf bank_mask:0x3
    s_nop 1
    v_add_f32_dpp v22, v23, v23 row_ror:8 row_mask:0xf bank_mask:0xc
    v_add_f32_dpp v25, v21, v21 row_ror:12 row_mask:0xf bank_mask:0x5
    s_nop 0
    v_add_f32_dpp v25, v22, v22 row_ror:4 row_mask:0xf bank_mask:0xa
    v_add_f32_dpp v28, v24, v24 quad_perm:[2,3,0,1] row_mask:0xf bank_mask:0xf
    s_nop 0
    v_add_f32_dpp v29, v25, v25 quad_perm:[2,3,0,1] row_mask:0xf bank_mask:0xf
    v_cndmask_b32 v27, v28, v29, s[70:71]
    v_add_f32_dpp v28, v26, v26 quad_perm:[1,0,3,2] row_mask:0xf bank_mask:0xf
    s_nop 0
    v_add_f32_dpp v29, v27, v27 quad_perm:[1,0,3,2] row_mask:0xf bank_mask:0xf
    v_cndmask_b32 v28, v28, v29, s[72:73]
    v_mov_b32 v32, v33
    v_mov_b32 v33, v34
    v_mov_b32 v34, v35
    v_mov_b32 v35, v36
    v_mov_b32 v36, v37
    v_mov_b32 v37, v38
    v_mov_b32 v38, v39
    v_mov_b32 v39, v40
    v_mov_b32 v40, v41
    v_mov_b32 v41, v42
    v_mov_b32 v42, v43
    v_mov_b32 v43, v44
    v_mov_b32 v44, v45
    v_mov_b32 v45, v46
    v_mov_b32 v46, v47
    v_cvt_pk_bf16_f32 v28, v28, v28
    v_and_b32 v28, 0xffff0000, v28
    v_mul_f32 v28, 0x3db504f3, v28
    v_cvt_pk_bf16_f32 v47, v28, v28
    v_and_b32 v47, 0xffff0000, v47
    v_max_f32 v30, v30, v47
    v_dot2_f32_bf16 v21, v112, v16, 0
    v_dot2_f32_bf16 v21, v113, v17, v21
    v_dot2_f32_bf16 v21, v114, v18, v21
    v_dot2_f32_bf16 v21, v115, v19, v21
    s_waitcnt vmcnt(5)
    s_mov_b32 s66, 229376
    buffer_load_dwordx4 v[80:83], v20, s[32:35], s66 offen nt
    v_dot2_f32_bf16 v23, v116, v16, 0
    v_dot2_f32_bf16 v23, v117, v17, v23
    v_dot2_f32_bf16 v23, v118, v18, v23
    v_dot2_f32_bf16 v23, v119, v19, v23
    v_add_f32_dpp v21, v21, v21 row_ror:8 row_mask:0xf bank_mask:0x3
    s_nop 1
    v_add_f32_dpp v21, v23, v23 row_ror:8 row_mask:0xf bank_mask:0xc
    v_dot2_f32_bf16 v22, v120, v16, 0
    v_dot2_f32_bf16 v22, v121, v17, v22
    v_dot2_f32_bf16 v22, v122, v18, v22
    v_dot2_f32_bf16 v22, v123, v19, v22
    s_waitcnt vmcnt(5)
    s_mov_b32 s66, 233472
    buffer_load_dwordx4 v[84:87], v20, s[32:35], s66 offen nt
    v_dot2_f32_bf16 v23, v124, v16, 0
    v_dot2_f32_bf16 v23, v125, v17, v23
    v_dot2_f32_bf16 v23, v126, v18, v23
    v_dot2_f32_bf16 v23, v127, v19, v23
    v_add_f32_dpp v22, v22, v22 row_ror:8 row_mask:0xf bank_mask:0x3
    s_nop 1
    v_add_f32_dpp v22, v23, v23 row_ror:8 row_mask:0xf bank_mask:0xc
    v_add_f32_dpp v24, v21, v21 row_ror:12 row_mask:0xf bank_mask:0x5
    s_nop 0
    v_add_f32_dpp v24, v22, v22 row_ror:4 row_mask:0xf bank_mask:0xa
    v_dot2_f32_bf16 v21, v128, v16, 0
    v_dot2_f32_bf16 v21, v129, v17, v21
    v_dot2_f32_bf16 v21, v130, v18, v21
    v_dot2_f32_bf16 v21, v131, v19, v21
    s_waitcnt vmcnt(5)
    s_mov_b32 s66, 237568
    buffer_load_dwordx4 v[88:91], v20, s[32:35], s66 offen nt
    v_dot2_f32_bf16 v23, v132, v16, 0
    v_dot2_f32_bf16 v23, v133, v17, v23
    v_dot2_f32_bf16 v23, v134, v18, v23
    v_dot2_f32_bf16 v23, v135, v19, v23
    v_add_f32_dpp v21, v21, v21 row_ror:8 row_mask:0xf bank_mask:0x3
    s_nop 1
    v_add_f32_dpp v21, v23, v23 row_ror:8 row_mask:0xf bank_mask:0xc
    v_dot2_f32_bf16 v22, v136, v16, 0
    v_dot2_f32_bf16 v22, v137, v17, v22
    v_dot2_f32_bf16 v22, v138, v18, v22
    v_dot2_f32_bf16 v22, v139, v19, v22
    s_waitcnt vmcnt(5)
    s_mov_b32 s66, 241664
    buffer_load_dwordx4 v[92:95], v20, s[32:35], s66 offen nt
    v_dot2_f32_bf16 v23, v140, v16, 0
    v_dot2_f32_bf16 v23, v141, v17, v23
    v_dot2_f32_bf16 v23, v142, v18, v23
    v_dot2_f32_bf16 v23, v143, v19, v23
    v_add_f32_dpp v22, v22, v22 row_ror:8 row_mask:0xf bank_mask:0x3
    s_nop 1
    v_add_f32_dpp v22, v23, v23 row_ror:8 row_mask:0xf bank_mask:0xc
    v_add_f32_dpp v25, v21, v21 row_ror:12 row_mask:0xf bank_mask:0x5
    s_nop 0
    v_add_f32_dpp v25, v22, v22 row_ror:4 row_mask:0xf bank_mask:0xa
    v_add_f32_dpp v28, v24, v24 quad_perm:[2,3,0,1] row_mask:0xf bank_mask:0xf
    s_nop 0
    v_add_f32_dpp v29, v25, v25 quad_perm:[2,3,0,1] row_mask:0xf bank_mask:0xf
    v_cndmask_b32 v26, v28, v29, s[70:71]
    v_dot2_f32_bf16 v21, v144, v16, 0
    v_dot2_f32_bf16 v21, v145, v17, v21
    v_dot2_f32_bf16 v21, v146, v18, v21
    v_dot2_f32_bf16 v21, v147, v19, v21
    s_waitcnt vmcnt(5)
    s_mov_b32 s66, 245760
    buffer_load_dwordx4 v[96:99], v20, s[32:35], s66 offen nt
    v_dot2_f32_bf16 v23, v148, v16, 0
    v_dot2_f32_bf16 v23, v149, v17, v23
    v_dot2_f32_bf16 v23, v150, v18, v23
    v_dot2_f32_bf16 v23, v151, v19, v23
    v_add_f32_dpp v21, v21, v21 row_ror:8 row_mask:0xf bank_mask:0x3
    s_nop 1
    v_add_f32_dpp v21, v23, v23 row_ror:8 row_mask:0xf bank_mask:0xc
    v_dot2_f32_bf16 v22, v152, v16, 0
    v_dot2_f32_bf16 v22, v153, v17, v22
    v_dot2_f32_bf16 v22, v154, v18, v22
    v_dot2_f32_bf16 v22, v155, v19, v22
    s_waitcnt vmcnt(5)
    s_mov_b32 s66, 249856
    buffer_load_dwordx4 v[100:103], v20, s[32:35], s66 offen nt
    v_dot2_f32_bf16 v23, v156, v16, 0
    v_dot2_f32_bf16 v23, v157, v17, v23
    v_dot2_f32_bf16 v23, v158, v18, v23
    v_dot2_f32_bf16 v23, v159, v19, v23
    v_add_f32_dpp v22, v22, v22 row_ror:8 row_mask:0xf bank_mask:0x3
    s_nop 1
    v_add_f32_dpp v22, v23, v23 row_ror:8 row_mask:0xf bank_mask:0xc
    v_add_f32_dpp v24, v21, v21 row_ror:12 row_mask:0xf bank_mask:0x5
    s_nop 0
    v_add_f32_dpp v24, v22, v22 row_ror:4 row_mask:0xf bank_mask:0xa
    v_dot2_f32_bf16 v21, v160, v16, 0
    v_dot2_f32_bf16 v21, v161, v17, v21
    v_dot2_f32_bf16 v21, v162, v18, v21
    v_dot2_f32_bf16 v21, v163, v19, v21
    s_waitcnt vmcnt(5)
    s_mov_b32 s66, 253952
    buffer_load_dwordx4 v[104:107], v20, s[32:35], s66 offen nt
    v_dot2_f32_bf16 v23, v164, v16, 0
    v_dot2_f32_bf16 v23, v165, v17, v23
    v_dot2_f32_bf16 v23, v166, v18, v23
    v_dot2_f32_bf16 v23, v167, v19, v23
    v_add_f32_dpp v21, v21, v21 row_ror:8 row_mask:0xf bank_mask:0x3
    s_nop 1
    v_add_f32_dpp v21, v23, v23 row_ror:8 row_mask:0xf bank_mask:0xc
    v_dot2_f32_bf16 v22, v168, v16, 0
    v_dot2_f32_bf16 v22, v169, v17, v22
    v_dot2_f32_bf16 v22, v170, v18, v22
    v_dot2_f32_bf16 v22, v171, v19, v22
    s_waitcnt vmcnt(5)
    s_mov_b32 s66, 258048
    buffer_load_dwordx4 v[108:111], v20, s[32:35], s66 offen nt
    v_dot2_f32_bf16 v23, v172, v16, 0
    v_dot2_f32_bf16 v23, v173, v17, v23
    v_dot2_f32_bf16 v23, v174, v18, v23
    v_dot2_f32_bf16 v23, v175, v19, v23
    v_add_f32_dpp v22, v22, v22 row_ror:8 row_mask:0xf bank_mask:0x3
    s_nop 1
    v_add_f32_dpp v22, v23, v23 row_ror:8 row_mask:0xf bank_mask:0xc
    v_add_f32_dpp v25, v21, v21 row_ror:12 row_mask:0xf bank_mask:0x5
    s_nop 0
    v_add_f32_dpp v25, v22, v22 row_ror:4 row_mask:0xf bank_mask:0xa
    v_add_f32_dpp v28, v24, v24 quad_perm:[2,3,0,1] row_mask:0xf bank_mask:0xf
    s_nop 0
    v_add_f32_dpp v29, v25, v25 quad_perm:[2,3,0,1] row_mask:0xf bank_mask:0xf
    v_cndmask_b32 v27, v28, v29, s[70:71]
    v_add_f32_dpp v28, v26, v26 quad_perm:[1,0,3,2] row_mask:0xf bank_mask:0xf
    s_nop 0
    v_add_f32_dpp v29, v27, v27 quad_perm:[1,0,3,2] row_mask:0xf bank_mask:0xf
    v_cndmask_b32 v28, v28, v29, s[72:73]
    v_mov_b32 v32, v33
    v_mov_b32 v33, v34
    v_mov_b32 v34, v35
    v_mov_b32 v35, v36
    v_mov_b32 v36, v37
    v_mov_b32 v37, v38
    v_mov_b32 v38, v39
    v_mov_b32 v39, v40
    v_mov_b32 v40, v41
    v_mov_b32 v41, v42
    v_mov_b32 v42, v43
    v_mov_b32 v43, v44
    v_mov_b32 v44, v45
    v_mov_b32 v45, v46
    v_mov_b32 v46, v47
    v_cvt_pk_bf16_f32 v28, v28, v28
    v_and_b32 v28, 0xffff0000, v28
    v_mul_f32 v28, 0x3db504f3, v28
    v_cvt_pk_bf16_f32 v47, v28, v28
    v_and_b32 v47, 0xffff0000, v47
    v_max_f32 v30, v30, v47
    v_dot2_f32_bf16 v21, v176, v16, 0
    v_dot2_f32_bf16 v21, v177, v17, v21
    v_dot2_f32_bf16 v21, v178, v18, v21
    v_dot2_f32_bf16 v21, v179, v19, v21
    s_waitcnt vmcnt(5)
    s_mov_b32 s66, 262144
    buffer_load_dwordx4 v[112:115], v20, s[32:35], s66 offen nt
    v_dot2_f32_bf16 v23, v180, v16, 0
    v_dot2_f32_bf16 v23, v181, v17, v23
    v_dot2_f32_bf16 v23, v182, v18, v23
    v_dot2_f32_bf16 v23, v183, v19, v23
    v_add_f32_dpp v21, v21, v21 row_ror:8 row_mask:0xf bank_mask:0x3
    s_nop 1
    v_add_f32_dpp v21, v23, v23 row_ror:8 row_mask:0xf bank_mask:0xc
    v_dot2_f32_bf16 v22, v184, v16, 0
    v_dot2_f32_bf16 v22, v185, v17, v22
    v_dot2_f32_bf16 v22, v186, v18, v22
    v_dot2_f32_bf16 v22, v187, v19, v22
    s_waitcnt vmcnt(5)
    s_mov_b32 s66, 266240
    buffer_load_dwordx4 v[116:119], v20, s[32:35], s66 offen nt
    v_dot2_f32_bf16 v23, v188, v16, 0
    v_dot2_f32_bf16 v23, v189, v17, v23
    v_dot2_f32_bf16 v23, v190, v18, v23
    v_dot2_f32_bf16 v23, v191, v19, v23
    v_add_f32_dpp v22, v22, v22 row_ror:8 row_mask:0xf bank_mask:0x3
    s_nop 1
    v_add_f32_dpp v22, v23, v23 row_ror:8 row_mask:0xf bank_mask:0xc
    v_add_f32_dpp v24, v21, v21 row_ror:12 row_mask:0xf bank_mask:0x5
    s_nop 0
    v_add_f32_dpp v24, v22, v22 row_ror:4 row_mask:0xf bank_mask:0xa
    v_dot2_f32_bf16 v21, v192, v16, 0
    v_dot2_f32_bf16 v21, v193, v17, v21
    v_dot2_f32_bf16 v21, v194, v18, v21
    v_dot2_f32_bf16 v21, v195, v19, v21
    s_waitcnt vmcnt(5)
    s_mov_b32 s66, 270336
    buffer_load_dwordx4 v[120:123], v20, s[32:35], s66 offen nt
    v_dot2_f32_bf16 v23, v196, v16, 0
    v_dot2_f32_bf16 v23, v197, v17, v23
    v_dot2_f32_bf16 v23, v198, v18, v23
    v_dot2_f32_bf16 v23, v199, v19, v23
    v_add_f32_dpp v21, v21, v21 row_ror:8 row_mask:0xf bank_mask:0x3
    s_nop 1
    v_add_f32_dpp v21, v23, v23 row_ror:8 row_mask:0xf bank_mask:0xc
    v_dot2_f32_bf16 v22, v200, v16, 0
    v_dot2_f32_bf16 v22, v201, v17, v22
    v_dot2_f32_bf16 v22, v202, v18, v22
    v_dot2_f32_bf16 v22, v203, v19, v22
    s_waitcnt vmcnt(5)
    s_mov_b32 s66, 274432
    buffer_load_dwordx4 v[124:127], v20, s[32:35], s66 offen nt
    v_dot2_f32_bf16 v23, v204, v16, 0
    v_dot2_f32_bf16 v23, v205, v17, v23
    v_dot2_f32_bf16 v23, v206, v18, v23
    v_dot2_f32_bf16 v23, v207, v19, v23
    v_add_f32_dpp v22, v22, v22 row_ror:8 row_mask:0xf bank_mask:0x3
    s_nop 1
    v_add_f32_dpp v22, v23, v23 row_ror:8 row_mask:0xf bank_mask:0xc
    v_add_f32_dpp v25, v21, v21 row_ror:12 row_mask:0xf bank_mask:0x5
    s_nop 0
    v_add_f32_dpp v25, v22, v22 row_ror:4 row_mask:0xf bank_mask:0xa
    v_add_f32_dpp v28, v24, v24 quad_perm:[2,3,0,1] row_mask:0xf bank_mask:0xf
    s_nop 0
    v_add_f32_dpp v29, v25, v25 quad_perm:[2,3,0,1] row_mask:0xf bank_mask:0xf
    v_cndmask_b32 v26, v28, v29, s[70:71]
    v_dot2_f32_bf16 v21, v208, v16, 0
    v_dot2_f32_bf16 v21, v209, v17, v21
    v_dot2_f32_bf16 v21, v210, v18, v21
    v_dot2_f32_bf16 v21, v211, v19, v21
    v_dot2_f32_bf16 v23, v212, v16, 0
    v_dot2_f32_bf16 v23, v213, v17, v23
    v_dot2_f32_bf16 v23, v214, v18, v23
    v_dot2_f32_bf16 v23, v215, v19, v23
    s_waitcnt vmcnt(5)
    s_mov_b32 s66, 278528
    buffer_load_dwordx4 v[128:131], v20, s[32:35], s66 offen nt
    v_add_f32_dpp v21, v21, v21 row_ror:8 row_mask:0xf bank_mask:0x3
    v_add_f32_dpp v21, v23, v23 row_ror:8 row_mask:0xf bank_mask:0xc
    v_dot2_f32_bf16 v22, v216, v16, 0
    v_dot2_f32_bf16 v22, v217, v17, v22
    v_dot2_f32_bf16 v22, v218, v18, v22
    v_dot2_f32_bf16 v22, v219, v19, v22
    v_dot2_f32_bf16 v23, v220, v16, 0
    v_dot2_f32_bf16 v23, v221, v17, v23
    v_dot2_f32_bf16 v23, v222, v18, v23
    v_dot2_f32_bf16 v23, v223, v19, v23
    s_waitcnt vmcnt(5)
    s_mov_b32 s66, 282624
    buffer_load_dwordx4 v[132:135], v20, s[32:35], s66 offen nt
    v_add_f32_dpp v22, v22, v22 row_ror:8 row_mask:0xf bank_mask:0x3
    v_add_f32_dpp v22, v23, v23 row_ror:8 row_mask:0xf bank_mask:0xc
    v_add_f32_dpp v24, v21, v21 row_ror:12 row_mask:0xf bank_mask:0x5
    s_nop 0
    v_add_f32_dpp v24, v22, v22 row_ror:4 row_mask:0xf bank_mask:0xa
    v_dot2_f32_bf16 v21, v224, v16, 0
    v_dot2_f32_bf16 v21, v225, v17, v21
    v_dot2_f32_bf16 v21, v226, v18, v21
    v_dot2_f32_bf16 v21, v227, v19, v21
    v_dot2_f32_bf16 v23, v228, v16, 0
    v_dot2_f32_bf16 v23, v229, v17, v23
    v_dot2_f32_bf16 v23, v230, v18, v23
    v_dot2_f32_bf16 v23, v231, v19, v23
    s_waitcnt vmcnt(5)
    s_mov_b32 s66, 286720
    buffer_load_dwordx4 v[136:139], v20, s[32:35], s66 offen nt
    v_add_f32_dpp v21, v21, v21 row_ror:8 row_mask:0xf bank_mask:0x3
    v_add_f32_dpp v21, v23, v23 row_ror:8 row_mask:0xf bank_mask:0xc
    v_dot2_f32_bf16 v22, v232, v16, 0
    v_dot2_f32_bf16 v22, v233, v17, v22
    v_dot2_f32_bf16 v22, v234, v18, v22
    v_dot2_f32_bf16 v22, v235, v19, v22
    v_dot2_f32_bf16 v23, v236, v16, 0
    v_dot2_f32_bf16 v23, v237, v17, v23
    v_dot2_f32_bf16 v23, v238, v18, v23
    v_dot2_f32_bf16 v23, v239, v19, v23
    s_waitcnt vmcnt(5)
    s_mov_b32 s66, 290816
    buffer_load_dwordx4 v[140:143], v20, s[32:35], s66 offen nt
    v_add_f32_dpp v22, v22, v22 row_ror:8 row_mask:0xf bank_mask:0x3
    v_add_f32_dpp v22, v23, v23 row_ror:8 row_mask:0xf bank_mask:0xc
    v_add_f32_dpp v25, v21, v21 row_ror:12 row_mask:0xf bank_mask:0x5
    s_nop 0
    v_add_f32_dpp v25, v22, v22 row_ror:4 row_mask:0xf bank_mask:0xa
    v_add_f32_dpp v28, v24, v24 quad_perm:[2,3,0,1] row_mask:0xf bank_mask:0xf
    s_nop 0
    v_add_f32_dpp v29, v25, v25 quad_perm:[2,3,0,1] row_mask:0xf bank_mask:0xf
    v_cndmask_b32 v27, v28, v29, s[70:71]
    v_add_f32_dpp v28, v26, v26 quad_perm:[1,0,3,2] row_mask:0xf bank_mask:0xf
    s_nop 0
    v_add_f32_dpp v29, v27, v27 quad_perm:[1,0,3,2] row_mask:0xf bank_mask:0xf
    v_cndmask_b32 v28, v28, v29, s[72:73]
    v_mov_b32 v32, v33
    v_mov_b32 v33, v34
    v_mov_b32 v34, v35
    v_mov_b32 v35, v36
    v_mov_b32 v36, v37
    v_mov_b32 v37, v38
    v_mov_b32 v38, v39
    v_mov_b32 v39, v40
    v_mov_b32 v40, v41
    v_mov_b32 v41, v42
    v_mov_b32 v42, v43
    v_mov_b32 v43, v44
    v_mov_b32 v44, v45
    v_mov_b32 v45, v46
    v_mov_b32 v46, v47
    v_cvt_pk_bf16_f32 v28, v28, v28
    v_and_b32 v28, 0xffff0000, v28
    v_mul_f32 v28, 0x3db504f3, v28
    v_cvt_pk_bf16_f32 v47, v28, v28
    v_and_b32 v47, 0xffff0000, v47
    v_max_f32 v30, v30, v47
    v_dot2_f32_bf16 v21, v48, v16, 0
    v_dot2_f32_bf16 v21, v49, v17, v21
    v_dot2_f32_bf16 v21, v50, v18, v21
    v_dot2_f32_bf16 v21, v51, v19, v21
    v_dot2_f32_bf16 v23, v52, v16, 0
    v_dot2_f32_bf16 v23, v53, v17, v23
    v_dot2_f32_bf16 v23, v54, v18, v23
    v_dot2_f32_bf16 v23, v55, v19, v23
    s_waitcnt vmcnt(5)
    s_mov_b32 s66, 294912
    buffer_load_dwordx4 v[144:147], v20, s[32:35], s66 offen nt
    v_add_f32_dpp v21, v21, v21 row_ror:8 row_mask:0xf bank_mask:0x3
    v_add_f32_dpp v21, v23, v23 row_ror:8 row_mask:0xf bank_mask:0xc
    v_dot2_f32_bf16 v22, v56, v16, 0
    v_dot2_f32_bf16 v22, v57, v17, v22
    v_dot2_f32_bf16 v22, v58, v18, v22
    v_dot2_f32_bf16 v22, v59, v19, v22
    v_dot2_f32_bf16 v23, v60, v16, 0
    v_dot2_f32_bf16 v23, v61, v17, v23
    v_dot2_f32_bf16 v23, v62, v18, v23
    v_dot2_f32_bf16 v23, v63, v19, v23
    s_waitcnt vmcnt(5)
    s_mov_b32 s66, 299008
    buffer_load_dwordx4 v[148:151], v20, s[32:35], s66 offen nt
    v_add_f32_dpp v22, v22, v22 row_ror:8 row_mask:0xf bank_mask:0x3
    v_add_f32_dpp v22, v23, v23 row_ror:8 row_mask:0xf bank_mask:0xc
    v_add_f32_dpp v24, v21, v21 row_ror:12 row_mask:0xf bank_mask:0x5
    s_nop 0
    v_add_f32_dpp v24, v22, v22 row_ror:4 row_mask:0xf bank_mask:0xa
    v_dot2_f32_bf16 v21, v64, v16, 0
    v_dot2_f32_bf16 v21, v65, v17, v21
    v_dot2_f32_bf16 v21, v66, v18, v21
    v_dot2_f32_bf16 v21, v67, v19, v21
    v_dot2_f32_bf16 v23, v68, v16, 0
    v_dot2_f32_bf16 v23, v69, v17, v23
    v_dot2_f32_bf16 v23, v70, v18, v23
    v_dot2_f32_bf16 v23, v71, v19, v23
    s_waitcnt vmcnt(5)
    s_mov_b32 s66, 303104
    buffer_load_dwordx4 v[152:155], v20, s[32:35], s66 offen nt
    v_add_f32_dpp v21, v21, v21 row_ror:8 row_mask:0xf bank_mask:0x3
    v_add_f32_dpp v21, v23, v23 row_ror:8 row_mask:0xf bank_mask:0xc
    v_dot2_f32_bf16 v22, v72, v16, 0
    v_dot2_f32_bf16 v22, v73, v17, v22
    v_dot2_f32_bf16 v22, v74, v18, v22
    v_dot2_f32_bf16 v22, v75, v19, v22
    v_dot2_f32_bf16 v23, v76, v16, 0
    v_dot2_f32_bf16 v23, v77, v17, v23
    v_dot2_f32_bf16 v23, v78, v18, v23
    v_dot2_f32_bf16 v23, v79, v19, v23
    s_waitcnt vmcnt(5)
    s_mov_b32 s66, 307200
    buffer_load_dwordx4 v[156:159], v20, s[32:35], s66 offen nt
    v_add_f32_dpp v22, v22, v22 row_ror:8 row_mask:0xf bank_mask:0x3
    v_add_f32_dpp v22, v23, v23 row_ror:8 row_mask:0xf bank_mask:0xc
    v_add_f32_dpp v25, v21, v21 row_ror:12 row_mask:0xf bank_mask:0x5
    s_nop 0
    v_add_f32_dpp v25, v22, v22 row_ror:4 row_mask:0xf bank_mask:0xa
    v_add_f32_dpp v28, v24, v24 quad_perm:[2,3,0,1] row_mask:0xf bank_mask:0xf
    s_nop 0
    v_add_f32_dpp v29, v25, v25 quad_perm:[2,3,0,1] row_mask:0xf bank_mask:0xf
    v_cndmask_b32 v26, v28, v29, s[70:71]
    v_dot2_f32_bf16 v21, v80, v16, 0
    v_dot2_f32_bf16 v21, v81, v17, v21
    v_dot2_f32_bf16 v21, v82, v18, v21
    v_dot2_f32_bf16 v21, v83, v19, v21
    v_dot2_f32_bf16 v23, v84, v16, 0
    v_dot2_f32_bf16 v23, v85, v17, v23
    v_dot2_f32_bf16 v23, v86, v18, v23
    v_dot2_f32_bf16 v23, v87, v19, v23
    s_waitcnt vmcnt(5)
    s_mov_b32 s66, 311296
    buffer_load_dwordx4 v[160:163], v20, s[32:35], s66 offen nt
    v_add_f32_dpp v21, v21, v21 row_ror:8 row_mask:0xf bank_mask:0x3
    v_add_f32_dpp v21, v23, v23 row_ror:8 row_mask:0xf bank_mask:0xc
    v_dot2_f32_bf16 v22, v88, v16, 0
    v_dot2_f32_bf16 v22, v89, v17, v22
    v_dot2_f32_bf16 v22, v90, v18, v22
    v_dot2_f32_bf16 v22, v91, v19, v22
    v_dot2_f32_bf16 v23, v92, v16, 0
    v_dot2_f32_bf16 v23, v93, v17, v23
    v_dot2_f32_bf16 v23, v94, v18, v23
    v_dot2_f32_bf16 v23, v95, v19, v23
    s_waitcnt vmcnt(5)
    s_mov_b32 s66, 315392
    buffer_load_dwordx4 v[164:167], v20, s[32:35], s66 offen nt
    v_add_f32_dpp v22, v22, v22 row_ror:8 row_mask:0xf bank_mask:0x3
    v_add_f32_dpp v22, v23, v23 row_ror:8 row_mask:0xf bank_mask:0xc
    v_add_f32_dpp v24, v21, v21 row_ror:12 row_mask:0xf bank_mask:0x5
    s_nop 0
    v_add_f32_dpp v24, v22, v22 row_ror:4 row_mask:0xf bank_mask:0xa
    v_dot2_f32_bf16 v21, v96, v16, 0
    v_dot2_f32_bf16 v21, v97, v17, v21
    v_dot2_f32_bf16 v21, v98, v18, v21
    v_dot2_f32_bf16 v21, v99, v19, v21
    v_dot2_f32_bf16 v23, v100, v16, 0
    v_dot2_f32_bf16 v23, v101, v17, v23
    v_dot2_f32_bf16 v23, v102, v18, v23
    v_dot2_f32_bf16 v23, v103, v19, v23
    s_waitcnt vmcnt(5)
    s_mov_b32 s66, 319488
    buffer_load_dwordx4 v[168:171], v20, s[32:35], s66 offen nt
    v_add_f32_dpp v21, v21, v21 row_ror:8 row_mask:0xf bank_mask:0x3
    v_add_f32_dpp v21, v23, v23 row_ror:8 row_mask:0xf bank_mask:0xc
    v_dot2_f32_bf16 v22, v104, v16, 0
    v_dot2_f32_bf16 v22, v105, v17, v22
    v_dot2_f32_bf16 v22, v106, v18, v22
    v_dot2_f32_bf16 v22, v107, v19, v22
    v_dot2_f32_bf16 v23, v108, v16, 0
    v_dot2_f32_bf16 v23, v109, v17, v23
    v_dot2_f32_bf16 v23, v110, v18, v23
    v_dot2_f32_bf16 v23, v111, v19, v23
    s_waitcnt vmcnt(5)
    s_mov_b32 s66, 323584
    buffer_load_dwordx4 v[172:175], v20, s[32:35], s66 offen nt
    v_add_f32_dpp v22, v22, v22 row_ror:8 row_mask:0xf bank_mask:0x3
    v_add_f32_dpp v22, v23, v23 row_ror:8 row_mask:0xf bank_mask:0xc
    v_add_f32_dpp v25, v21, v21 row_ror:12 row_mask:0xf bank_mask:0x5
    s_nop 0
    v_add_f32_dpp v25, v22, v22 row_ror:4 row_mask:0xf bank_mask:0xa
    v_add_f32_dpp v28, v24, v24 quad_perm:[2,3,0,1] row_mask:0xf bank_mask:0xf
    s_nop 0
    v_add_f32_dpp v29, v25, v25 quad_perm:[2,3,0,1] row_mask:0xf bank_mask:0xf
    v_cndmask_b32 v27, v28, v29, s[70:71]
    v_add_f32_dpp v28, v26, v26 quad_perm:[1,0,3,2] row_mask:0xf bank_mask:0xf
    s_nop 0
    v_add_f32_dpp v29, v27, v27 quad_perm:[1,0,3,2] row_mask:0xf bank_mask:0xf
    v_cndmask_b32 v28, v28, v29, s[72:73]
    v_mov_b32 v32, v33
    v_mov_b32 v33, v34
    v_mov_b32 v34, v35
    v_mov_b32 v35, v36
    v_mov_b32 v36, v37
    v_mov_b32 v37, v38
    v_mov_b32 v38, v39
    v_mov_b32 v39, v40
    v_mov_b32 v40, v41
    v_mov_b32 v41, v42
    v_mov_b32 v42, v43
    v_mov_b32 v43, v44
    v_mov_b32 v44, v45
    v_mov_b32 v45, v46
    v_mov_b32 v46, v47
    v_cvt_pk_bf16_f32 v28, v28, v28
    v_and_b32 v28, 0xffff0000, v28
    v_mul_f32 v28, 0x3db504f3, v28
    v_cvt_pk_bf16_f32 v47, v28, v28
    v_and_b32 v47, 0xffff0000, v47
    v_max_f32 v30, v30, v47
    v_dot2_f32_bf16 v21, v112, v16, 0
    v_dot2_f32_bf16 v21, v113, v17, v21
    v_dot2_f32_bf16 v21, v114, v18, v21
    v_dot2_f32_bf16 v21, v115, v19, v21
    v_dot2_f32_bf16 v23, v116, v16, 0
    v_dot2_f32_bf16 v23, v117, v17, v23
    v_dot2_f32_bf16 v23, v118, v18, v23
    v_dot2_f32_bf16 v23, v119, v19, v23
    s_waitcnt vmcnt(5)
    s_mov_b32 s66, 327680
    buffer_load_dwordx4 v[48:51], v20, s[32:35], s66 offen nt
    v_add_f32_dpp v21, v21, v21 row_ror:8 row_mask:0xf bank_mask:0x3
    v_add_f32_dpp v21, v23, v23 row_ror:8 row_mask:0xf bank_mask:0xc
    v_dot2_f32_bf16 v22, v120, v16, 0
    v_dot2_f32_bf16 v22, v121, v17, v22
    v_dot2_f32_bf16 v22, v122, v18, v22
    v_dot2_f32_bf16 v22, v123, v19, v22
    v_dot2_f32_bf16 v23, v124, v16, 0
    v_dot2_f32_bf16 v23, v125, v17, v23
    v_dot2_f32_bf16 v23, v126, v18, v23
    v_dot2_f32_bf16 v23, v127, v19, v23
    s_waitcnt vmcnt(5)
    s_mov_b32 s66, 331776
    buffer_load_dwordx4 v[52:55], v20, s[32:35], s66 offen nt
    v_add_f32_dpp v22, v22, v22 row_ror:8 row_mask:0xf bank_mask:0x3
    v_add_f32_dpp v22, v23, v23 row_ror:8 row_mask:0xf bank_mask:0xc
    v_add_f32_dpp v24, v21, v21 row_ror:12 row_mask:0xf bank_mask:0x5
    s_nop 0
    v_add_f32_dpp v24, v22, v22 row_ror:4 row_mask:0xf bank_mask:0xa
    v_dot2_f32_bf16 v21, v128, v16, 0
    v_dot2_f32_bf16 v21, v129, v17, v21
    v_dot2_f32_bf16 v21, v130, v18, v21
    v_dot2_f32_bf16 v21, v131, v19, v21
    v_dot2_f32_bf16 v23, v132, v16, 0
    v_dot2_f32_bf16 v23, v133, v17, v23
    v_dot2_f32_bf16 v23, v134, v18, v23
    v_dot2_f32_bf16 v23, v135, v19, v23
    s_waitcnt vmcnt(5)
    s_mov_b32 s66, 335872
    buffer_load_dwordx4 v[56:59], v20, s[32:35], s66 offen nt
    v_add_f32_dpp v21, v21, v21 row_ror:8 row_mask:0xf bank_mask:0x3
    v_add_f32_dpp v21, v23, v23 row_ror:8 row_mask:0xf bank_mask:0xc
    v_dot2_f32_bf16 v22, v136, v16, 0
    v_dot2_f32_bf16 v22, v137, v17, v22
    v_dot2_f32_bf16 v22, v138, v18, v22
    v_dot2_f32_bf16 v22, v139, v19, v22
    v_dot2_f32_bf16 v23, v140, v16, 0
    v_dot2_f32_bf16 v23, v141, v17, v23
    v_dot2_f32_bf16 v23, v142, v18, v23
    v_dot2_f32_bf16 v23, v143, v19, v23
    s_waitcnt vmcnt(5)
    s_mov_b32 s66, 339968
    buffer_load_dwordx4 v[60:63], v20, s[32:35], s66 offen nt
    v_add_f32_dpp v22, v22, v22 row_ror:8 row_mask:0xf bank_mask:0x3
    v_add_f32_dpp v22, v23, v23 row_ror:8 row_mask:0xf bank_mask:0xc
    v_add_f32_dpp v25, v21, v21 row_ror:12 row_mask:0xf bank_mask:0x5
    s_nop 0
    v_add_f32_dpp v25, v22, v22 row_ror:4 row_mask:0xf bank_mask:0xa
    v_add_f32_dpp v28, v24, v24 quad_perm:[2,3,0,1] row_mask:0xf bank_mask:0xf
    s_nop 0
    v_add_f32_dpp v29, v25, v25 quad_perm:[2,3,0,1] row_mask:0xf bank_mask:0xf
    v_cndmask_b32 v26, v28, v29, s[70:71]
    v_dot2_f32_bf16 v21, v144, v16, 0
    v_dot2_f32_bf16 v21, v145, v17, v21
    v_dot2_f32_bf16 v21, v146, v18, v21
    v_dot2_f32_bf16 v21, v147, v19, v21
    v_dot2_f32_bf16 v23, v148, v16, 0
    v_dot2_f32_bf16 v23, v149, v17, v23
    v_dot2_f32_bf16 v23, v150, v18, v23
    v_dot2_f32_bf16 v23, v151, v19, v23
    s_waitcnt vmcnt(5)
    s_mov_b32 s66, 344064
    buffer_load_dwordx4 v[64:67], v20, s[32:35], s66 offen nt
    v_add_f32_dpp v21, v21, v21 row_ror:8 row_mask:0xf bank_mask:0x3
    v_add_f32_dpp v21, v23, v23 row_ror:8 row_mask:0xf bank_mask:0xc
    v_dot2_f32_bf16 v22, v152, v16, 0
    v_dot2_f32_bf16 v22, v153, v17, v22
    v_dot2_f32_bf16 v22, v154, v18, v22
    v_dot2_f32_bf16 v22, v155, v19, v22
    v_dot2_f32_bf16 v23, v156, v16, 0
    v_dot2_f32_bf16 v23, v157, v17, v23
    v_dot2_f32_bf16 v23, v158, v18, v23
    v_dot2_f32_bf16 v23, v159, v19, v23
    s_waitcnt vmcnt(5)
    s_mov_b32 s66, 348160
    buffer_load_dwordx4 v[68:71], v20, s[32:35], s66 offen nt
    v_add_f32_dpp v22, v22, v22 row_ror:8 row_mask:0xf bank_mask:0x3
    v_add_f32_dpp v22, v23, v23 row_ror:8 row_mask:0xf bank_mask:0xc
    v_add_f32_dpp v24, v21, v21 row_ror:12 row_mask:0xf bank_mask:0x5
    s_nop 0
    v_add_f32_dpp v24, v22, v22 row_ror:4 row_mask:0xf bank_mask:0xa
    v_dot2_f32_bf16 v21, v160, v16, 0
    v_dot2_f32_bf16 v21, v161, v17, v21
    v_dot2_f32_bf16 v21, v162, v18, v21
    v_dot2_f32_bf16 v21, v163, v19, v21
    v_dot2_f32_bf16 v23, v164, v16, 0
    v_dot2_f32_bf16 v23, v165, v17, v23
    v_dot2_f32_bf16 v23, v166, v18, v23
    v_dot2_f32_bf16 v23, v167, v19, v23
    s_waitcnt vmcnt(5)
    s_mov_b32 s66, 352256
    buffer_load_dwordx4 v[72:75], v20, s[32:35], s66 offen nt
    v_add_f32_dpp v21, v21, v21 row_ror:8 row_mask:0xf bank_mask:0x3
    v_add_f32_dpp v21, v23, v23 row_ror:8 row_mask:0xf bank_mask:0xc
    v_dot2_f32_bf16 v22, v168, v16, 0
    v_dot2_f32_bf16 v22, v169, v17, v22
    v_dot2_f32_bf16 v22, v170, v18, v22
    v_dot2_f32_bf16 v22, v171, v19, v22
    v_dot2_f32_bf16 v23, v172, v16, 0
    v_dot2_f32_bf16 v23, v173, v17, v23
    v_dot2_f32_bf16 v23, v174, v18, v23
    v_dot2_f32_bf16 v23, v175, v19, v23
    v_add_f32_dpp v22, v22, v22 row_ror:8 row_mask:0xf bank_mask:0x3
    s_nop 1
    v_add_f32_dpp v22, v23, v23 row_ror:8 row_mask:0xf bank_mask:0xc
    v_add_f32_dpp v25, v21, v21 row_ror:12 row_mask:0xf bank_mask:0x5
    s_nop 0
    v_add_f32_dpp v25, v22, v22 row_ror:4 row_mask:0xf bank_mask:0xa
    v_add_f32_dpp v28, v24, v24 quad_perm:[2,3,0,1] row_mask:0xf bank_mask:0xf
    s_nop 0
    v_add_f32_dpp v29, v25, v25 quad_perm:[2,3,0,1] row_mask:0xf bank_mask:0xf
    v_cndmask_b32 v27, v28, v29, s[70:71]
    v_add_f32_dpp v28, v26, v26 quad_perm:[1,0,3,2] row_mask:0xf bank_mask:0xf
    s_nop 0
    v_add_f32_dpp v29, v27, v27 quad_perm:[1,0,3,2] row_mask:0xf bank_mask:0xf
    v_cndmask_b32 v28, v28, v29, s[72:73]
    v_mov_b32 v32, v33
    v_mov_b32 v33, v34
    v_mov_b32 v34, v35
    v_mov_b32 v35, v36
    v_mov_b32 v36, v37
    v_mov_b32 v37, v38
    v_mov_b32 v38, v39
    v_mov_b32 v39, v40
    v_mov_b32 v40, v41
    v_mov_b32 v41, v42
    v_mov_b32 v42, v43
    v_mov_b32 v43, v44
    v_mov_b32 v44, v45
    v_mov_b32 v45, v46
    v_mov_b32 v46, v47
    v_cvt_pk_bf16_f32 v28, v28, v28
    v_and_b32 v28, 0xffff0000, v28
    v_mul_f32 v28, 0x3db504f3, v28
    v_cvt_pk_bf16_f32 v47, v28, v28
    v_and_b32 v47, 0xffff0000, v47
    v_max_f32 v30, v30, v47
    s_mov_b32 s67, 327680
    s_mov_b32 s68, 10
    s_add_u32 s75, s74, 5
    v_mov_b32 v0, s75
    s_nop 2
L_kloop:
    v_subrev_u32 v0, s75, v0
    v_cmp_gt_u32 vcc, 32, v0
    s_add_u32 s75, s75, 1
    s_bcnt1_i32_b32 s64, vcc_lo
    s_cmp_lt_u32 s64, 24
    s_nop 1
    s_cbranch_scc1 L_klo
    s_waitcnt vmcnt(6)
    s_add_u32 s66, s67, 28672
    buffer_load_dwordx4 v[76:79], v20, s[32:35], s66 offen nt
    v_dot2_f32_bf16 v21, v48, v16, 0
    v_dot2_f32_bf16 v21, v49, v17, v21
    v_dot2_f32_bf16 v21, v50, v18, v21
    v_dot2_f32_bf16 v21, v51, v19, v21
    s_waitcnt vmcnt(6)
    s_add_u32 s66, s67, 32768
    buffer_load_dwordx4 v[80:83], v20, s[32:35], s66 offen nt
    v_dot2_f32_bf16 v23, v52, v16, 0
    v_dot2_f32_bf16 v23, v53, v17, v23
    v_dot2_f32_bf16 v23, v54, v18, v23
    v_dot2_f32_bf16 v23, v55, v19, v23
    v_add_f32_dpp v21, v21, v21 row_ror:8 row_mask:0xf bank_mask:0x3
    s_nop 1
    v_add_f32_dpp v21, v23, v23 row_ror:8 row_mask:0xf bank_mask:0xc
    s_waitcnt vmcnt(6)
    s_add_u32 s66, s67, 36864
    buffer_load_dwordx4 v[84:87], v20, s[32:35], s66 offen nt
    v_dot2_f32_bf16 v22, v56, v16, 0
    v_dot2_f32_bf16 v22, v57, v17, v22
    v_dot2_f32_bf16 v22, v58, v18, v22
    v_dot2_f32_bf16 v22, v59, v19, v22
    s_waitcnt vmcnt(6)
    s_add_u32 s66, s67, 40960
    buffer_load_dwordx4 v[88:91], v20, s[32:35], s66 offen nt
    v_dot2_f32_bf16 v23, v60, v16, 0
    v_dot2_f32_bf16 v23, v61, v17, v23
    v_dot2_f32_bf16 v23, v62, v18, v23
    v_dot2_f32_bf16 v23, v63, v19, v23
    v_add_f32_dpp v22, v22, v22 row_ror:8 row_mask:0xf bank_mask:0x3
    s_nop 1
    v_add_f32_dpp v22, v23, v23 row_ror:8 row_mask:0xf bank_mask:0xc
    v_add_f32_dpp v24, v21, v21 row_ror:12 row_mask:0xf bank_mask:0x5
    s_nop 0
    v_add_f32_dpp v24, v22, v22 row_ror:4 row_mask:0xf bank_mask:0xa
    s_waitcnt vmcnt(6)
    s_add_u32 s66, s67, 45056
    buffer_load_dwordx4 v[92:95], v20, s[32:35], s66 offen nt
    v_dot2_f32_bf16 v21, v64, v16, 0
    v_dot2_f32_bf16 v21, v65, v17, v21
    v_dot2_f32_bf16 v21, v66, v18, v21
    v_dot2_f32_bf16 v21, v67, v19, v21
    s_waitcnt vmcnt(6)
    s_add_u32 s66, s67, 49152
    buffer_load_dwordx4 v[96:99], v20, s[32:35], s66 offen nt
    v_dot2_f32_bf16 v23, v68, v16, 0
    v_dot2_f32_bf16 v23, v69, v17, v23
    v_dot2_f32_bf16 v23, v70, v18, v23
    v_dot2_f32_bf16 v23, v71, v19, v23
    v_add_f32_dpp v21, v21, v21 row_ror:8 row_mask:0xf bank_mask:0x3
    s_nop 1
    v_add_f32_dpp v21, v23, v23 row_ror:8 row_mask:0xf bank_mask:0xc
    s_waitcnt vmcnt(6)
    s_add_u32 s66, s67, 53248
    buffer_load_dwordx4 v[100:103], v20, s[32:35], s66 offen nt
    v_dot2_f32_bf16 v22, v72, v16, 0
    v_dot2_f32_bf16 v22, v73, v17, v22
    v_dot2_f32_bf16 v22, v74, v18, v22
    v_dot2_f32_bf16 v22, v75, v19, v22
    v_lshlrev_b32 v28, 2, v1
    buffer_load_dword v0, v28, s[52:55], s78 offen sc1
    v_mov_b32 v28, s75
    v_mov_b32 v29, 0
    s_mov_b64 exec, 1
    buffer_store_dword v28, v29, s[52:55], s79 offen
    s_mov_b64 exec, -1
    s_waitcnt vmcnt(8)
    s_add_u32 s66, s67, 57344
    buffer_load_dwordx4 v[104:107], v20, s[32:35], s66 offen nt
    v_dot2_f32_bf16 v23, v76, v16, 0
    v_dot2_f32_bf16 v23, v77, v17, v23
    v_dot2_f32_bf16 v23, v78, v18, v23
    v_dot2_f32_bf16 v23, v79, v19, v23
    v_add_f32_dpp v22, v22, v22 row_ror:8 row_mask:0xf bank_mask:0x3
    s_nop 1
    v_add_f32_dpp v22, v23, v23 row_ror:8 row_mask:0xf bank_mask:0xc
    v_add_f32_dpp v25, v21, v21 row_ror:12 row_mask:0xf bank_mask:0x5
    s_nop 0
    v_add_f32_dpp v25, v22, v22 row_ror:4 row_mask:0xf bank_mask:0xa
    v_add_f32_dpp v28, v24, v24 quad_perm:[2,3,0,1] row_mask:0xf bank_mask:0xf
    s_nop 0
    v_add_f32_dpp v29, v25, v25 quad_perm:[2,3,0,1] row_mask:0xf bank_mask:0xf
    v_cndmask_b32 v26, v28, v29, s[70:71]
    s_waitcnt vmcnt(8)
    s_add_u32 s66, s67, 61440
    buffer_load_dwordx4 v[108:111], v20, s[32:35], s66 offen nt
    v_dot2_f32_bf16 v21, v80, v16, 0
    v_dot2_f32_bf16 v21, v81, v17, v21
    v_dot2_f32_bf16 v21, v82, v18, v21
    v_dot2_f32_bf16 v21, v83, v19, v21
    s_waitcnt vmcnt(8)
    s_add_u32 s66, s67, 65536
    buffer_load_dwordx4 v[48:51], v20, s[32:35], s66 offen nt
    v_dot2_f32_bf16 v23, v84, v16, 0
    v_dot2_f32_bf16 v23, v85, v17, v23
    v_dot2_f32_bf16 v23, v86, v18, v23
    v_dot2_f32_bf16 v23, v87, v19, v23
    v_add_f32_dpp v21, v21, v21 row_ror:8 row_mask:0xf bank_mask:0x3
    s_nop 1
    v_add_f32_dpp v21, v23, v23 row_ror:8 row_mask:0xf bank_mask:0xc
    s_waitcnt vmcnt(8)
    s_add_u32 s66, s67, 69632
    buffer_load_dwordx4 v[52:55], v20, s[32:35], s66 offen nt
    v_dot2_f32_bf16 v22, v88, v16, 0
    v_dot2_f32_bf16 v22, v89, v17, v22
    v_dot2_f32_bf16 v22, v90, v18, v22
    v_dot2_f32_bf16 v22, v91, v19, v22
    s_waitcnt vmcnt(8)
    s_add_u32 s66, s67, 73728
    buffer_load_dwordx4 v[56:59], v20, s[32:35], s66 offen nt
    v_dot2_f32_bf16 v23, v92, v16, 0
    v_dot2_f32_bf16 v23, v93, v17, v23
    v_dot2_f32_bf16 v23, v94, v18, v23
    v_dot2_f32_bf16 v23, v95, v19, v23
    v_add_f32_dpp v22, v22, v22 row_ror:8 row_mask:0xf bank_mask:0x3
    s_nop 1
    v_add_f32_dpp v22, v23, v23 row_ror:8 row_mask:0xf bank_mask:0xc
    v_add_f32_dpp v24, v21, v21 row_ror:12 row_mask:0xf bank_mask:0x5
    s_nop 0
    v_add_f32_dpp v24, v22, v22 row_ror:4 row_mask:0xf bank_mask:0xa
    s_waitcnt vmcnt(8)
    s_add_u32 s66, s67, 77824
    buffer_load_dwordx4 v[60:63], v20, s[32:35], s66 offen nt
    v_dot2_f32_bf16 v21, v96, v16, 0
    v_dot2_f32_bf16 v21, v97, v17, v21
    v_dot2_f32_bf16 v21, v98, v18, v21
    v_dot2_f32_bf16 v21, v99, v19, v21
    s_waitcnt vmcnt(8)
    s_add_u32 s66, s67, 81920
    buffer_load_dwordx4 v[64:67], v20, s[32:35], s66 offen nt
    v_dot2_f32_bf16 v23, v100, v16, 0
    v_dot2_f32_bf16 v23, v101, v17, v23
    v_dot2_f32_bf16 v23, v102, v18, v23
    v_dot2_f32_bf16 v23, v103, v19, v23
    v_add_f32_dpp v21, v21, v21 row_ror:8 row_mask:0xf bank_mask:0x3
    s_nop 1
    v_add_f32_dpp v21, v23, v23 row_ror:8 row_mask:0xf bank_mask:0xc
    s_waitcnt vmcnt(6)
    s_add_u32 s66, s67, 86016
    buffer_load_dwordx4 v[68:71], v20, s[32:35], s66 offen nt
    v_dot2_f32_bf16 v22, v104, v16, 0
    v_dot2_f32_bf16 v22, v105, v17, v22
    v_dot2_f32_bf16 v22, v106, v18, v22
    v_dot2_f32_bf16 v22, v107, v19, v22
    s_waitcnt vmcnt(6)
    s_add_u32 s66, s67, 90112
    buffer_load_dwordx4 v[72:75], v20, s[32:35], s66 offen nt
    v_dot2_f32_bf16 v23, v108, v16, 0
    v_dot2_f32_bf16 v23, v109, v17, v23
    v_dot2_f32_bf16 v23, v110, v18, v23
    v_dot2_f32_bf16 v23, v111, v19, v23
    v_add_f32_dpp v22, v22, v22 row_ror:8 row_mask:0xf bank_mask:0x3
    s_nop 1
    v_add_f32_dpp v22, v23, v23 row_ror:8 row_mask:0xf bank_mask:0xc
    v_add_f32_dpp v25, v21, v21 row_ror:12 row_mask:0xf bank_mask:0x5
    s_nop 0
    v_add_f32_dpp v25, v22, v22 row_ror:4 row_mask:0xf bank_mask:0xa
    v_add_f32_dpp v28, v24, v24 quad_perm:[2,3,0,1] row_mask:0xf bank_mask:0xf
    s_nop 0
    v_add_f32_dpp v29, v25, v25 quad_perm:[2,3,0,1] row_mask:0xf bank_mask:0xf
    v_cndmask_b32 v27, v28, v29, s[70:71]
    v_add_f32_dpp v28, v26, v26 quad_perm:[1,0,3,2] row_mask:0xf bank_mask:0xf
    s_nop 0
    v_add_f32_dpp v29, v27, v27 quad_perm:[1,0,3,2] row_mask:0xf bank_mask:0xf
    v_cndmask_b32 v28, v28, v29, s[72:73]
    v_mov_b32 v32, v33
    v_mov_b32 v33, v34
    v_mov_b32 v34, v35
    v_mov_b32 v35, v36
    v_mov_b32 v36, v37
    v_mov_b32 v37, v38
    v_mov_b32 v38, v39
    v_mov_b32 v39, v40
    v_mov_b32 v40, v41
    v_mov_b32 v41, v42
    v_mov_b32 v42, v43
    v_mov_b32 v43, v44
    v_mov_b32 v44, v45
    v_mov_b32 v45, v46
    v_mov_b32 v46, v47
    v_cvt_pk_bf16_f32 v28, v28, v28
    v_and_b32 v28, 0xffff0000, v28
    v_mul_f32 v28, 0x3db504f3, v28
    v_cvt_pk_bf16_f32 v47, v28, v28
    v_and_b32 v47, 0xffff0000, v47
    v_max_f32 v30, v30, v47
    s_nop 2
    s_branch L_kjoin
L_klo:
    s_waitcnt vmcnt(6)
    s_waitcnt vmcnt(4)
    s_add_u32 s66, s67, 28672
    buffer_load_dwordx4 v[76:79], v20, s[32:35], s66 offen nt
    v_dot2_f32_bf16 v21, v48, v16, 0
    v_dot2_f32_bf16 v21, v49, v17, v21
    v_dot2_f32_bf16 v21, v50, v18, v21
    v_dot2_f32_bf16 v21, v51, v19, v21
    s_waitcnt vmcnt(6)
    s_waitcnt vmcnt(4)
    s_add_u32 s66, s67, 32768
    buffer_load_dwordx4 v[80:83], v20, s[32:35], s66 offen nt
    v_dot2_f32_bf16 v23, v52, v16, 0
    v_dot2_f32_bf16 v23, v53, v17, v23
    v_dot2_f32_bf16 v23, v54, v18, v23
    v_dot2_f32_bf16 v23, v55, v19, v23
    v_add_f32_dpp v21, v21, v21 row_ror:8 row_mask:0xf bank_mask:0x3
    s_nop 1
    v_add_f32_dpp v21, v23, v23 row_ror:8 row_mask:0xf bank_mask:0xc
    s_waitcnt vmcnt(6)
    s_waitcnt vmcnt(4)
    s_add_u32 s66, s67, 36864
    buffer_load_dwordx4 v[84:87], v20, s[32:35], s66 offen nt
    v_dot2_f32_bf16 v22, v56, v16, 0
    v_dot2_f32_bf16 v22, v57, v17, v22
    v_dot2_f32_bf16 v22, v58, v18, v22
    v_dot2_f32_bf16 v22, v59, v19, v22
    s_waitcnt vmcnt(6)
    s_waitcnt vmcnt(4)
    s_add_u32 s66, s67, 40960
    buffer_load_dwordx4 v[88:91], v20, s[32:35], s66 offen nt
    v_dot2_f32_bf16 v23, v60, v16, 0
    v_dot2_f32_bf16 v23, v61, v17, v23
    v_dot2_f32_bf16 v23, v62, v18, v23
    v_dot2_f32_bf16 v23, v63, v19, v23
    v_add_f32_dpp v22, v22, v22 row_ror:8 row_mask:0xf bank_mask:0x3
    s_nop 1
    v_add_f32_dpp v22, v23, v23 row_ror:8 row_mask:0xf bank_mask:0xc
    v_add_f32_dpp v24, v21, v21 row_ror:12 row_mask:0xf bank_mask:0x5
    s_nop 0
    v_add_f32_dpp v24, v22, v22 row_ror:4 row_mask:0xf bank_mask:0xa
    s_waitcnt vmcnt(6)
    s_waitcnt vmcnt(4)
    s_add_u32 s66, s67, 45056
    buffer_load_dwordx4 v[92:95], v20, s[32:35], s66 offen nt
    v_dot2_f32_bf16 v21, v64, v16, 0
    v_dot2_f32_bf16 v21, v65, v17, v21
    v_dot2_f32_bf16 v21, v66, v18, v21
    v_dot2_f32_bf16 v21, v67, v19, v21
    s_waitcnt vmcnt(6)
    s_waitcnt vmcnt(4)
    s_add_u32 s66, s67, 49152
    buffer_load_dwordx4 v[96:99], v20, s[32:35], s66 offen nt
    v_dot2_f32_bf16 v23, v68, v16, 0
    v_dot2_f32_bf16 v23, v69, v17, v23
    v_dot2_f32_bf16 v23, v70, v18, v23
    v_dot2_f32_bf16 v23, v71, v19, v23
    v_add_f32_dpp v21, v21, v21 row_ror:8 row_mask:0xf bank_mask:0x3
    s_nop 1
    v_add_f32_dpp v21, v23, v23 row_ror:8 row_mask:0xf bank_mask:0xc
    s_waitcnt vmcnt(6)
    s_waitcnt vmcnt(4)
    s_add_u32 s66, s67, 53248
    buffer_load_dwordx4 v[100:103], v20, s[32:35], s66 offen nt
    v_dot2_f32_bf16 v22, v72, v16, 0
    v_dot2_f32_bf16 v22, v73, v17, v22
    v_dot2_f32_bf16 v22, v74, v18, v22
    v_dot2_f32_bf16 v22, v75, v19, v22
    v_lshlrev_b32 v28, 2, v1
    buffer_load_dword v0, v28, s[52:55], s78 offen sc1
    v_mov_b32 v28, s75
    v_mov_b32 v29, 0
    s_mov_b64 exec, 1
    buffer_store_dword v28, v29, s[52:55], s79 offen
    s_mov_b64 exec, -1
    s_waitcnt vmcnt(8)
    s_waitcnt vmcnt(4)
    s_add_u32 s66, s67, 57344
    buffer_load_dwordx4 v[104:107], v20, s[32:35], s66 offen nt
    v_dot2_f32_bf16 v23, v76, v16, 0
    v_dot2_f32_bf16 v23, v77, v17, v23
    v_dot2_f32_bf16 v23, v78, v18, v23
    v_dot2_f32_bf16 v23, v79, v19, v23
    v_add_f32_dpp v22, v22, v22 row_ror:8 row_mask:0xf bank_mask:0x3
    s_nop 1
    v_add_f32_dpp v22, v23, v23 row_ror:8 row_mask:0xf bank_mask:0xc
    v_add_f32_dpp v25, v21, v21 row_ror:12 row_mask:0xf bank_mask:0x5
    s_nop 0
    v_add_f32_dpp v25, v22, v22 row_ror:4 row_mask:0xf bank_mask:0xa
    v_add_f32_dpp v28, v24, v24 quad_perm:[2,3,0,1] row_mask:0xf bank_mask:0xf
    s_nop 0
    v_add_f32_dpp v29, v25, v25 quad_perm:[2,3,0,1] row_mask:0xf bank_mask:0xf
    v_cndmask_b32 v26, v28, v29, s[70:71]
    s_waitcnt vmcnt(8)
    s_waitcnt vmcnt(4)
    s_add_u32 s66, s67, 61440
    buffer_load_dwordx4 v[108:111], v20, s[32:35], s66 offen nt
    v_dot2_f32_bf16 v21, v80, v16, 0
    v_dot2_f32_bf16 v21, v81, v17, v21
    v_dot2_f32_bf16 v21, v82, v18, v21
    v_dot2_f32_bf16 v21, v83, v19, v21
    s_waitcnt vmcnt(8)
    s_waitcnt vmcnt(4)
    s_add_u32 s66, s67, 65536
    buffer_load_dwordx4 v[48:51], v20, s[32:35], s66 offen nt
    v_dot2_f32_bf16 v23, v84, v16, 0
    v_dot2_f32_bf16 v23, v85, v17, v23
    v_dot2_f32_bf16 v23, v86, v18, v23
    v_dot2_f32_bf16 v23, v87, v19, v23
    v_add_f32_dpp v21, v21, v21 row_ror:8 row_mask:0xf bank_mask:0x3
    s_nop 1
    v_add_f32_dpp v21, v23, v23 row_ror:8 row_mask:0xf bank_mask:0xc
    s_waitcnt vmcnt(8)
    s_waitcnt vmcnt(4)
    s_add_u32 s66, s67, 69632
    buffer_load_dwordx4 v[52:55], v20, s[32:35], s66 offen nt
    v_dot2_f32_bf16 v22, v88, v16, 0
    v_dot2_f32_bf16 v22, v89, v17, v22
    v_dot2_f32_bf16 v22, v90, v18, v22
    v_dot2_f32_bf16 v22, v91, v19, v22
    s_waitcnt vmcnt(8)
    s_waitcnt vmcnt(4)
    s_add_u32 s66, s67, 73728
    buffer_load_dwordx4 v[56:59], v20, s[32:35], s66 offen nt
    v_dot2_f32_bf16 v23, v92, v16, 0
    v_dot2_f32_bf16 v23, v93, v17, v23
    v_dot2_f32_bf16 v23, v94, v18, v23
    v_dot2_f32_bf16 v23, v95, v19, v23
    v_add_f32_dpp v22, v22, v22 row_ror:8 row_mask:0xf bank_mask:0x3
    s_nop 1
    v_add_f32_dpp v22, v23, v23 row_ror:8 row_mask:0xf bank_mask:0xc
    v_add_f32_dpp v24, v21, v21 row_ror:12 row_mask:0xf bank_mask:0x5
    s_nop 0
    v_add_f32_dpp v24, v22, v22 row_ror:4 row_mask:0xf bank_mask:0xa
    s_waitcnt vmcnt(8)
    s_waitcnt vmcnt(4)
    s_add_u32 s66, s67, 77824
    buffer_load_dwordx4 v[60:63], v20, s[32:35], s66 offen nt
    v_dot2_f32_bf16 v21, v96, v16, 0
    v_dot2_f32_bf16 v21, v97, v17, v21
    v_dot2_f32_bf16 v21, v98, v18, v21
    v_dot2_f32_bf16 v21, v99, v19, v21
    s_waitcnt vmcnt(8)
    s_waitcnt vmcnt(4)
    s_add_u32 s66, s67, 81920
    buffer_load_dwordx4 v[64:67], v20, s[32:35], s66 offen nt
    v_dot2_f32_bf16 v23, v100, v16, 0
    v_dot2_f32_bf16 v23, v101, v17, v23
    v_dot2_f32_bf16 v23, v102, v18, v23
    v_dot2_f32_bf16 v23, v103, v19, v23
    v_add_f32_dpp v21, v21, v21 row_ror:8 row_mask:0xf bank_mask:0x3
    s_nop 1
    v_add_f32_dpp v21, v23, v23 row_ror:8 row_mask:0xf bank_mask:0xc
    s_waitcnt vmcnt(6)
    s_waitcnt vmcnt(4)
    s_add_u32 s66, s67, 86016
    buffer_load_dwordx4 v[68:71], v20, s[32:35], s66 offen nt
    v_dot2_f32_bf16 v22, v104, v16, 0
    v_dot2_f32_bf16 v22, v105, v17, v22
    v_dot2_f32_bf16 v22, v106, v18, v22
    v_dot2_f32_bf16 v22, v107, v19, v22
    s_waitcnt vmcnt(6)
    s_waitcnt vmcnt(4)
    s_add_u32 s66, s67, 90112
    buffer_load_dwordx4 v[72:75], v20, s[32:35], s66 offen nt
    v_dot2_f32_bf16 v23, v108, v16, 0
    v_dot2_f32_bf16 v23, v109, v17, v23
    v_dot2_f32_bf16 v23, v110, v18, v23
    v_dot2_f32_bf16 v23, v111, v19, v23
    v_add_f32_dpp v22, v22, v22 row_ror:8 row_mask:0xf bank_mask:0x3
    s_nop 1
    v_add_f32_dpp v22, v23, v23 row_ror:8 row_mask:0xf bank_mask:0xc
    v_add_f32_dpp v25, v21, v21 row_ror:12 row_mask:0xf bank_mask:0x5
    s_nop 0
    v_add_f32_dpp v25, v22, v22 row_ror:4 row_mask:0xf bank_mask:0xa
    v_add_f32_dpp v28, v24, v24 quad_perm:[2,3,0,1] row_mask:0xf bank_mask:0xf
    s_nop 0
    v_add_f32_dpp v29, v25, v25 quad_perm:[2,3,0,1] row_mask:0xf bank_mask:0xf
    v_cndmask_b32 v27, v28, v29, s[70:71]
    v_add_f32_dpp v28, v26, v26 quad_perm:[1,0,3,2] row_mask:0xf bank_mask:0xf
    s_nop 0
    v_add_f32_dpp v29, v27, v27 quad_perm:[1,0,3,2] row_mask:0xf bank_mask:0xf
    v_cndmask_b32 v28, v28, v29, s[72:73]
    v_mov_b32 v32, v33
    v_mov_b32 v33, v34
    v_mov_b32 v34, v35
    v_mov_b32 v35, v36
    v_mov_b32 v36, v37
    v_mov_b32 v37, v38
    v_mov_b32 v38, v39
    v_mov_b32 v39, v40
    v_mov_b32 v40, v41
    v_mov_b32 v41, v42
    v_mov_b32 v42, v43
    v_mov_b32 v43, v44
    v_mov_b32 v44, v45
    v_mov_b32 v45, v46
    v_mov_b32 v46, v47
    v_cvt_pk_bf16_f32 v28, v28, v28
    v_and_b32 v28, 0xffff0000, v28
    v_mul_f32 v28, 0x3db504f3, v28
    v_cvt_pk_bf16_f32 v47, v28, v28
    v_and_b32 v47, 0xffff0000, v47
    v_max_f32 v30, v30, v47
    s_nop 2
L_kjoin:
    s_add_u32 s67, s67, 65536
    s_sub_u32 s68, s68, 1
    s_cmp_lg_u32 s68, 0
    s_cbranch_scc1 L_kloop
    s_waitcnt vmcnt(6)
    v_dot2_f32_bf16 v21, v48, v16, 0
    v_dot2_f32_bf16 v21, v49, v17, v21
    v_dot2_f32_bf16 v21, v50, v18, v21
    v_dot2_f32_bf16 v21, v51, v19, v21
    s_mov_b32 s66, 1011712
    buffer_load_dwordx4 v[76:79], v20, s[32:35], s66 offen nt
    s_waitcnt vmcnt(6)
    v_dot2_f32_bf16 v23, v52, v16, 0
    v_dot2_f32_bf16 v23, v53, v17, v23
    v_dot2_f32_bf16 v23, v54, v18, v23
    v_dot2_f32_bf16 v23, v55, v19, v23
    s_mov_b32 s66, 1015808
    buffer_load_dwordx4 v[80:83], v20, s[32:35], s66 offen nt
    v_add_f32_dpp v21, v21, v21 row_ror:8 row_mask:0xf bank_mask:0x3
    v_add_f32_dpp v21, v23, v23 row_ror:8 row_mask:0xf bank_mask:0xc
    s_waitcnt vmcnt(6)
    v_dot2_f32_bf16 v22, v56, v16, 0
    v_dot2_f32_bf16 v22, v57, v17, v22
    v_dot2_f32_bf16 v22, v58, v18, v22
    v_dot2_f32_bf16 v22, v59, v19, v22
    s_mov_b32 s66, 1019904
    buffer_load_dwordx4 v[84:87], v20, s[32:35], s66 offen nt
    s_waitcnt vmcnt(6)
    v_dot2_f32_bf16 v23, v60, v16, 0
    v_dot2_f32_bf16 v23, v61, v17, v23
    v_dot2_f32_bf16 v23, v62, v18, v23
    v_dot2_f32_bf16 v23, v63, v19, v23
    s_mov_b32 s66, 1024000
    buffer_load_dwordx4 v[88:91], v20, s[32:35], s66 offen nt
    v_add_f32_dpp v22, v22, v22 row_ror:8 row_mask:0xf bank_mask:0x3
    v_add_f32_dpp v22, v23, v23 row_ror:8 row_mask:0xf bank_mask:0xc
    v_add_f32_dpp v24, v21, v21 row_ror:12 row_mask:0xf bank_mask:0x5
    s_nop 0
    v_add_f32_dpp v24, v22, v22 row_ror:4 row_mask:0xf bank_mask:0xa
    s_waitcnt vmcnt(6)
    v_dot2_f32_bf16 v21, v64, v16, 0
    v_dot2_f32_bf16 v21, v65, v17, v21
    v_dot2_f32_bf16 v21, v66, v18, v21
    v_dot2_f32_bf16 v21, v67, v19, v21
    s_mov_b32 s66, 1028096
    buffer_load_dwordx4 v[92:95], v20, s[32:35], s66 offen nt
    s_waitcnt vmcnt(6)
    v_dot2_f32_bf16 v23, v68, v16, 0
    v_dot2_f32_bf16 v23, v69, v17, v23
    v_dot2_f32_bf16 v23, v70, v18, v23
    v_dot2_f32_bf16 v23, v71, v19, v23
    s_mov_b32 s66, 1032192
    buffer_load_dwordx4 v[96:99], v20, s[32:35], s66 offen nt
    v_add_f32_dpp v21, v21, v21 row_ror:8 row_mask:0xf bank_mask:0x3
    v_add_f32_dpp v21, v23, v23 row_ror:8 row_mask:0xf bank_mask:0xc
    s_waitcnt vmcnt(6)
    v_dot2_f32_bf16 v22, v72, v16, 0
    v_dot2_f32_bf16 v22, v73, v17, v22
    v_dot2_f32_bf16 v22, v74, v18, v22
    v_dot2_f32_bf16 v22, v75, v19, v22
    s_mov_b32 s66, 1036288
    buffer_load_dwordx4 v[100:103], v20, s[32:35], s66 offen nt
    s_mov_b32 s66, 0
    buffer_load_dwordx4 v[48:51], v20, s[36:39], s66 offen nt
    s_waitcnt vmcnt(7)
    v_dot2_f32_bf16 v23, v76, v16, 0
    v_dot2_f32_bf16 v23, v77, v17, v23
    v_dot2_f32_bf16 v23, v78, v18, v23
    v_dot2_f32_bf16 v23, v79, v19, v23
    s_mov_b32 s66, 1040384
    buffer_load_dwordx4 v[104:107], v20, s[32:35], s66 offen nt
    v_add_f32_dpp v22, v22, v22 row_ror:8 row_mask:0xf bank_mask:0x3
    v_add_f32_dpp v22, v23, v23 row_ror:8 row_mask:0xf bank_mask:0xc
    v_add_f32_dpp v25, v21, v21 row_ror:12 row_mask:0xf bank_mask:0x5
    s_nop 0
    v_add_f32_dpp v25, v22, v22 row_ror:4 row_mask:0xf bank_mask:0xa
    v_add_f32_dpp v28, v24, v24 quad_perm:[2,3,0,1] row_mask:0xf bank_mask:0xf
    s_nop 0
    v_add_f32_dpp v29, v25, v25 quad_perm:[2,3,0,1] row_mask:0xf bank_mask:0xf
    v_cndmask_b32 v26, v28, v29, s[70:71]
    s_mov_b32 s66, 4096
    buffer_load_dwordx4 v[52:55], v20, s[36:39], s66 offen nt
    s_waitcnt vmcnt(8)
    v_dot2_f32_bf16 v21, v80, v16, 0
    v_dot2_f32_bf16 v21, v81, v17, v21
    v_dot2_f32_bf16 v21, v82, v18, v21
    v_dot2_f32_bf16 v21, v83, v19, v21
    s_mov_b32 s66, 1044480
    buffer_load_dwordx4 v[108:111], v20, s[32:35], s66 offen nt
    s_mov_b32 s66, 8192
    buffer_load_dwordx4 v[56:59], v20, s[36:39], s66 offen nt
    s_waitcnt vmcnt(9)
    v_dot2_f32_bf16 v23, v84, v16, 0
    v_dot2_f32_bf16 v23, v85, v17, v23
    v_dot2_f32_bf16 v23, v86, v18, v23
    v_dot2_f32_bf16 v23, v87, v19, v23
    v_add_f32_dpp v21, v21, v21 row_ror:8 row_mask:0xf bank_mask:0x3
    s_nop 1
    v_add_f32_dpp v21, v23, v23 row_ror:8 row_mask:0xf bank_mask:0xc
    s_mov_b32 s66, 12288
    buffer_load_dwordx4 v[60:63], v20, s[36:39], s66 offen nt
    s_waitcnt vmcnt(9)
    v_dot2_f32_bf16 v22, v88, v16, 0
    v_dot2_f32_bf16 v22, v89, v17, v22
    v_dot2_f32_bf16 v22, v90, v18, v22
    v_dot2_f32_bf16 v22, v91, v19, v22
    s_mov_b32 s66, 16384
    buffer_load_dwordx4 v[64:67], v20, s[36:39], s66 offen nt
    s_waitcnt vmcnt(9)
    v_dot2_f32_bf16 v23, v92, v16, 0
    v_dot2_f32_bf16 v23, v93, v17, v23
    v_dot2_f32_bf16 v23, v94, v18, v23
    v_dot2_f32_bf16 v23, v95, v19, v23
    v_add_f32_dpp v22, v22, v22 row_ror:8 row_mask:0xf bank_mask:0x3
    s_nop 1
    v_add_f32_dpp v22, v23, v23 row_ror:8 row_mask:0xf bank_mask:0xc
    v_add_f32_dpp v24, v21, v21 row_ror:12 row_mask:0xf bank_mask:0x5
    s_nop 0
    v_add_f32_dpp v24, v22, v22 row_ror:4 row_mask:0xf bank_mask:0xa
    s_mov_b32 s66, 20480
    buffer_load_dwordx4 v[68:71], v20, s[36:39], s66 offen nt
    s_waitcnt vmcnt(9)
    v_dot2_f32_bf16 v21, v96, v16, 0
    v_dot2_f32_bf16 v21, v97, v17, v21
    v_dot2_f32_bf16 v21, v98, v18, v21
    v_dot2_f32_bf16 v21, v99, v19, v21
    s_mov_b32 s66, 24576
    buffer_load_dwordx4 v[72:75], v20, s[36:39], s66 offen nt
    s_waitcnt vmcnt(9)
    v_dot2_f32_bf16 v23, v100, v16, 0
    v_dot2_f32_bf16 v23, v101, v17, v23
    v_dot2_f32_bf16 v23, v102, v18, v23
    v_dot2_f32_bf16 v23, v103, v19, v23
    v_add_f32_dpp v21, v21, v21 row_ror:8 row_mask:0xf bank_mask:0x3
    s_nop 1
    v_add_f32_dpp v21, v23, v23 row_ror:8 row_mask:0xf bank_mask:0xc
    s_mov_b32 s66, 28672
    buffer_load_dwordx4 v[76:79], v20, s[36:39], s66 offen nt
    s_waitcnt vmcnt(8)
    v_dot2_f32_bf16 v22, v104, v16, 0
    v_dot2_f32_bf16 v22, v105, v17, v22
    v_dot2_f32_bf16 v22, v106, v18, v22
    v_dot2_f32_bf16 v22, v107, v19, v22
    s_mov_b32 s66, 32768
    buffer_load_dwordx4 v[80:83], v20, s[36:39], s66 offen nt
    s_waitcnt vmcnt(7)
    v_dot2_f32_bf16 v23, v108, v16, 0
    v_dot2_f32_bf16 v23, v109, v17, v23
    v_dot2_f32_bf16 v23, v110, v18, v23
    v_dot2_f32_bf16 v23, v111, v19, v23
    v_add_f32_dpp v22, v22, v22 row_ror:8 row_mask:0xf bank_mask:0x3
    s_nop 1
    v_add_f32_dpp v22, v23, v23 row_ror:8 row_mask:0xf bank_mask:0xc
    v_add_f32_dpp v25, v21, v21 row_ror:12 row_mask:0xf bank_mask:0x5
    s_nop 0
    v_add_f32_dpp v25, v22, v22 row_ror:4 row_mask:0xf bank_mask:0xa
    v_add_f32_dpp v28, v24, v24 quad_perm:[2,3,0,1] row_mask:0xf bank_mask:0xf
    s_nop 0
    v_add_f32_dpp v29, v25, v25 quad_perm:[2,3,0,1] row_mask:0xf bank_mask:0xf
    v_cndmask_b32 v27, v28, v29, s[70:71]
    v_add_f32_dpp v28, v26, v26 quad_perm:[1,0,3,2] row_mask:0xf bank_mask:0xf
    s_nop 0
    v_add_f32_dpp v29, v27, v27 quad_perm:[1,0,3,2] row_mask:0xf bank_mask:0xf
    v_cndmask_b32 v28, v28, v29, s[72:73]
    v_mov_b32 v32, v33
    v_mov_b32 v33, v34
    v_mov_b32 v34, v35
    v_mov_b32 v35, v36
    v_mov_b32 v36, v37
    v_mov_b32 v37, v38
    v_mov_b32 v38, v39
    v_mov_b32 v39, v40
    v_mov_b32 v40, v41
    v_mov_b32 v41, v42
    v_mov_b32 v42, v43
    v_mov_b32 v43, v44
    v_mov_b32 v44, v45
    v_mov_b32 v45, v46
    v_mov_b32 v46, v47
    v_cvt_pk_bf16_f32 v28, v28, v28
    v_and_b32 v28, 0xffff0000, v28
    v_mul_f32 v28, 0x3db504f3, v28
    v_cvt_pk_bf16_f32 v47, v28, v28
    v_and_b32 v47, 0xffff0000, v47
    v_max_f32 v30, v30, v47
    s_mov_b32 s66, 36864
    buffer_load_dwordx4 v[84:87], v20, s[36:39], s66 offen nt
    v_max_f32_dpp v30, v30, v30 row_ror:8 row_mask:0xf bank_mask:0xf
    s_nop 1
    v_max_f32_dpp v30, v30, v30 row_ror:4 row_mask:0xf bank_mask:0xf
    s_nop 1
    v_max_f32_dpp v30, v30, v30 row_ror:2 row_mask:0xf bank_mask:0xf
    s_nop 1
    v_max_f32_dpp v30, v30, v30 row_ror:1 row_mask:0xf bank_mask:0xf
    s_nop 1
    v_max_f32_dpp v30, v30, v30 row_bcast:15 row_mask:0xa bank_mask:0xf
    s_nop 1
    v_max_f32_dpp v30, v30, v30 row_bcast:31 row_mask:0xc bank_mask:0xf
    s_nop 0
    v_readlane_b32 s80, v30, 63
    s_mov_b32 s65, 0x3fb8aa3b
    s_nop 0
    v_subrev_f32 v32, s80, v32
    v_mul_f32 v32, s65, v32
    v_subrev_f32 v33, s80, v33
    v_mul_f32 v33, s65, v33
    v_subrev_f32 v34, s80, v34
    v_mul_f32 v34, s65, v34
    v_subrev_f32 v35, s80, v35
    v_mul_f32 v35, s65, v35
    v_subrev_f32 v36, s80, v36
    v_mul_f32 v36, s65, v36
    v_subrev_f32 v37, s80, v37
    v_mul_f32 v37, s65, v37
    v_subrev_f32 v38, s80, v38
    v_mul_f32 v38, s65, v38
    v_subrev_f32 v39, s80, v39
    v_mul_f32 v39, s65, v39
    v_subrev_f32 v40, s80, v40
    v_mul_f32 v40, s65, v40
    v_subrev_f32 v41, s80, v41
    v_mul_f32 v41, s65, v41
    v_subrev_f32 v42, s80, v42
    v_mul_f32 v42, s65, v42
    v_subrev_f32 v43, s80, v43
    v_mul_f32 v43, s65, v43
    v_subrev_f32 v44, s80, v44
    v_mul_f32 v44, s65, v44
    v_subrev_f32 v45, s80, v45
    v_mul_f32 v45, s65, v45
    v_subrev_f32 v46, s80, v46
    v_mul_f32 v46, s65, v46
    v_subrev_f32 v47, s80, v47
    v_mul_f32 v47, s65, v47
    v_exp_f32 v32, v32
    v_exp_f32 v33, v33
    v_exp_f32 v34, v34
    v_exp_f32 v35, v35
    v_exp_f32 v36, v36
    v_exp_f32 v37, v37
    v_exp_f32 v38, v38
    v_exp_f32 v39, v39
    v_exp_f32 v40, v40
    v_exp_f32 v41, v41
    v_exp_f32 v42, v42
    v_exp_f32 v43, v43
    v_exp_f32 v44, v44
    v_exp_f32 v45, v45
    v_exp_f32 v46, v46
    v_exp_f32 v47, v47
    v_add_f32 v28, v32, v33
    v_add_f32 v29, v34, v35
    v_add_f32 v28, v28, v36
    v_add_f32 v29, v29, v37
    v_add_f32 v28, v28, v38
    v_add_f32 v29, v29, v39
    v_add_f32 v28, v28, v40
    v_add_f32 v29, v29, v41
    v_add_f32 v28, v28, v42
    v_add_f32 v29, v29, v43
    v_add_f32 v28, v28, v44
    v_add_f32 v29, v29, v45
    v_add_f32 v28, v28, v46
    v_add_f32 v29, v29, v47
    v_add_f32 v28, v28, v29
    s_nop 1
    v_add_f32_dpp v28, v28, v28 row_ror:8 row_mask:0xf bank_mask:0xf
    s_nop 1
    v_add_f32_dpp v28, v28, v28 row_ror:4 row_mask:0xf bank_mask:0xf
    s_nop 1
    v_add_f32_dpp v28, v28, v28 row_ror:2 row_mask:0xf bank_mask:0xf
    s_nop 1
    v_add_f32_dpp v28, v28, v28 row_ror:1 row_mask:0xf bank_mask:0xf
    s_nop 1
    v_add_f32_dpp v28, v28, v28 row_bcast:15 row_mask:0xa bank_mask:0xf
    s_nop 1
    v_add_f32_dpp v28, v28, v28 row_bcast:31 row_mask:0xc bank_mask:0xf
    s_nop 0
    v_readlane_b32 s81, v28, 63
    v_mov_b32 v24, s80
    s_nop 0
    v_mov_b32 v25, s81
    s_lshl_b32 s64, s28, 3
    s_add_u32 s64, s64, 149504
    v_mov_b32 v28, s64
    ds_write_b64 v28, v[24:25]
    v_mov_b32 v29, 149504
    s_waitcnt lgkmcnt(0)
    s_barrier
    ds_read_b128 v[8:11], v29
    ds_read_b128 v[12:15], v29 offset:16
    s_mul_i32 s64, s28, 36864
    v_lshlrev_b32 v28, 4, v1
    v_add_u32 v28, s64, v28
    s_waitcnt lgkmcnt(0)
    v_mov_b32 v30, v28
    v_max3_f32 v26, v8, v10, v12
    v_max_f32 v26, v26, v14
    v_sub_f32 v8, v8, v26
    v_mul_f32 v8, s65, v8
    v_sub_f32 v10, v10, v26
    v_mul_f32 v10, s65, v10
    v_sub_f32 v12, v12, v26
    v_mul_f32 v12, s65, v12
    v_sub_f32 v14, v14, v26
    v_mul_f32 v14, s65, v14
    v_sub_f32 v24, v24, v26
    v_mul_f32 v24, s65, v24
    v_exp_f32 v8, v8
    v_exp_f32 v10, v10
    v_exp_f32 v12, v12
    v_exp_f32 v14, v14
    v_exp_f32 v24, v24
    v_mul_f32 v27, v8, v9
    v_fmac_f32 v27, v10, v11
    v_fmac_f32 v27, v12, v13
    v_fmac_f32 v27, v14, v15
    v_rcp_f32 v27, v27
    s_nop 0
    v_mul_f32 v24, v24, v27
    v_mul_f32 v32, v32, v24
    v_cvt_pk_bf16_f32 v32, v32, v32
    v_mul_f32 v33, v33, v24
    v_cvt_pk_bf16_f32 v33, v33, v33
    v_mul_f32 v34, v34, v24
    v_cvt_pk_bf16_f32 v34, v34, v34
    v_mul_f32 v35, v35, v24
    v_cvt_pk_bf16_f32 v35, v35, v35
    v_mul_f32 v36, v36, v24
    v_cvt_pk_bf16_f32 v36, v36, v36
    v_mul_f32 v37, v37, v24
    v_cvt_pk_bf16_f32 v37, v37, v37
    v_mul_f32 v38, v38, v24
    v_cvt_pk_bf16_f32 v38, v38, v38
    v_mul_f32 v39, v39, v24
    v_cvt_pk_bf16_f32 v39, v39, v39
    v_mul_f32 v40, v40, v24
    v_cvt_pk_bf16_f32 v40, v40, v40
    v_mul_f32 v41, v41, v24
    v_cvt_pk_bf16_f32 v41, v41, v41
    v_mul_f32 v42, v42, v24
    v_cvt_pk_bf16_f32 v42, v42, v42
    v_mul_f32 v43, v43, v24
    v_cvt_pk_bf16_f32 v43, v43, v43
    v_mul_f32 v44, v44, v24
    v_cvt_pk_bf16_f32 v44, v44, v44
    v_mul_f32 v45, v45, v24
    v_cvt_pk_bf16_f32 v45, v45, v45
    v_mul_f32 v46, v46, v24
    v_cvt_pk_bf16_f32 v46, v46, v46
    v_mul_f32 v47, v47, v24
    v_cvt_pk_bf16_f32 v47, v47, v47
    v_mov_b32 v12, 0
    v_mov_b32 v13, 0
    v_mov_b32 v14, 0
    v_mov_b32 v15, 0
    v_and_b32_dpp v8, v32, v4 row_newbcast:0 row_mask:0xf bank_mask:0xf
    v_and_b32_dpp v9, v32, v5 row_newbcast:0 row_mask:0xf bank_mask:0xf
    v_and_b32_dpp v10, v32, v6 row_newbcast:0 row_mask:0xf bank_mask:0xf
    v_and_b32_dpp v11, v32, v7 row_newbcast:0 row_mask:0xf bank_mask:0xf
    s_nop 1
    v_mfma_f32_16x16x32_bf16 v[12:15], v[8:11], v[48:51], v[12:15]
    s_waitcnt vmcnt(7)
    s_mov_b32 s66, 40960
    buffer_load_dwordx4 v[88:91], v20, s[36:39], s66 offen nt
    v_and_b32_dpp v8, v32, v4 row_newbcast:8 row_mask:0xf bank_mask:0xf
    v_and_b32_dpp v9, v32, v5 row_newbcast:8 row_mask:0xf bank_mask:0xf
    v_and_b32_dpp v10, v32, v6 row_newbcast:8 row_mask:0xf bank_mask:0xf
    v_and_b32_dpp v11, v32, v7 row_newbcast:8 row_mask:0xf bank_mask:0xf
    s_nop 1
    v_mfma_f32_16x16x32_bf16 v[12:15], v[8:11], v[52:55], v[12:15]
    s_waitcnt vmcnt(7)
    s_mov_b32 s66, 45056
    buffer_load_dwordx4 v[92:95], v20, s[36:39], s66 offen nt
    v_and_b32_dpp v8, v32, v4 row_newbcast:4 row_mask:0xf bank_mask:0xf
    v_and_b32_dpp v9, v32, v5 row_newbcast:4 row_mask:0xf bank_mask:0xf
    v_and_b32_dpp v10, v32, v6 row_newbcast:4 row_mask:0xf bank_mask:0xf
    v_and_b32_dpp v11, v32, v7 row_newbcast:4 row_mask:0xf bank_mask:0xf
    s_nop 1
    v_mfma_f32_16x16x32_bf16 v[12:15], v[8:11], v[56:59], v[12:15]
    s_waitcnt vmcnt(7)
    s_mov_b32 s66, 49152
    buffer_load_dwordx4 v[96:99], v20, s[36:39], s66 offen nt
    v_and_b32_dpp v8, v32, v4 row_newbcast:12 row_mask:0xf bank_mask:0xf
    v_and_b32_dpp v9, v32, v5 row_newbcast:12 row_mask:0xf bank_mask:0xf
    v_and_b32_dpp v10, v32, v6 row_newbcast:12 row_mask:0xf bank_mask:0xf
    v_and_b32_dpp v11, v32, v7 row_newbcast:12 row_mask:0xf bank_mask:0xf
    s_nop 1
    v_mfma_f32_16x16x32_bf16 v[12:15], v[8:11], v[60:63], v[12:15]
    s_waitcnt vmcnt(7)
    s_mov_b32 s66, 53248
    buffer_load_dwordx4 v[100:103], v20, s[36:39], s66 offen nt
    v_and_b32_dpp v8, v32, v4 row_newbcast:2 row_mask:0xf bank_mask:0xf
    v_and_b32_dpp v9, v32, v5 row_newbcast:2 row_mask:0xf bank_mask:0xf
    v_and_b32_dpp v10, v32, v6 row_newbcast:2 row_mask:0xf bank_mask:0xf
    v_and_b32_dpp v11, v32, v7 row_newbcast:2 row_mask:0xf bank_mask:0xf
    s_nop 1
    v_mfma_f32_16x16x32_bf16 v[12:15], v[8:11], v[64:67], v[12:15]
    s_waitcnt vmcnt(7)
    s_mov_b32 s66, 57344
    buffer_load_dwordx4 v[104:107], v20, s[36:39], s66 offen nt
    ds_read_b128 v[112:115], v30 offset:0
    ds_read_b128 v[116:119], v30 offset:1024
    ds_read_b128 v[120:123], v30 offset:2048
    v_and_b32_dpp v8, v32, v4 row_newbcast:10 row_mask:0xf bank_mask:0xf
    v_and_b32_dpp v9, v32, v5 row_newbcast:10 row_mask:0xf bank_mask:0xf
    v_and_b32_dpp v10, v32, v6 row_newbcast:10 row_mask:0xf bank_mask:0xf
    v_and_b32_dpp v11, v32, v7 row_newbcast:10 row_mask:0xf bank_mask:0xf
    s_nop 1
    v_mfma_f32_16x16x32_bf16 v[12:15], v[8:11], v[68:71], v[12:15]
    s_waitcnt vmcnt(7)
    s_mov_b32 s66, 61440
    buffer_load_dwordx4 v[108:111], v20, s[36:39], s66 offen nt
    ds_read_b128 v[124:127], v30 offset:3072
    ds_read_b128 v[128:131], v30 offset:4096
    ds_read_b128 v[132:135], v30 offset:5120
    v_and_b32_dpp v8, v32, v4 row_newbcast:6 row_mask:0xf bank_mask:0xf
    v_and_b32_dpp v9, v32, v5 row_newbcast:6 row_mask:0xf bank_mask:0xf
    v_and_b32_dpp v10, v32, v6 row_newbcast:6 row_mask:0xf bank_mask:0xf
    v_and_b32_dpp v11, v32, v7 row_newbcast:6 row_mask:0xf bank_mask:0xf
    s_nop 1
    v_mfma_f32_16x16x32_bf16 v[12:15], v[8:11], v[72:75], v[12:15]
    s_waitcnt vmcnt(7)
    s_mov_b32 s66, 65536
    buffer_load_dwordx4 v[48:51], v20, s[36:39], s66 offen nt
    ds_read_b128 v[136:139], v30 offset:6144
    ds_read_b128 v[140:143], v30 offset:7168
    ds_read_b128 v[144:147], v30 offset:8192
    v_and_b32_dpp v8, v32, v4 row_newbcast:14 row_mask:0xf bank_mask:0xf
    v_and_b32_dpp v9, v32, v5 row_newbcast:14 row_mask:0xf bank_mask:0xf
    v_and_b32_dpp v10, v32, v6 row_newbcast:14 row_mask:0xf bank_mask:0xf
    v_and_b32_dpp v11, v32, v7 row_newbcast:14 row_mask:0xf bank_mask:0xf
    s_nop 1
    v_mfma_f32_16x16x32_bf16 v[12:15], v[8:11], v[76:79], v[12:15]
    s_waitcnt vmcnt(7)
    s_mov_b32 s66, 69632
    buffer_load_dwordx4 v[52:55], v20, s[36:39], s66 offen nt
    ds_read_b128 v[148:151], v30 offset:9216
    ds_read_b128 v[152:155], v30 offset:10240
    ds_read_b128 v[156:159], v30 offset:11264
    v_and_b32_dpp v8, v32, v4 row_newbcast:1 row_mask:0xf bank_mask:0xf
    v_and_b32_dpp v9, v32, v5 row_newbcast:1 row_mask:0xf bank_mask:0xf
    v_and_b32_dpp v10, v32, v6 row_newbcast:1 row_mask:0xf bank_mask:0xf
    v_and_b32_dpp v11, v32, v7 row_newbcast:1 row_mask:0xf bank_mask:0xf
    s_nop 1
    v_mfma_f32_16x16x32_bf16 v[12:15], v[8:11], v[80:83], v[12:15]
    s_waitcnt vmcnt(7)
    s_mov_b32 s66, 73728
    buffer_load_dwordx4 v[56:59], v20, s[36:39], s66 offen nt
    ds_read_b128 v[160:163], v30 offset:12288
    ds_read_b128 v[164:167], v30 offset:13312
    ds_read_b128 v[168:171], v30 offset:14336
    v_and_b32_dpp v8, v32, v4 row_newbcast:9 row_mask:0xf bank_mask:0xf
    v_and_b32_dpp v9, v32, v5 row_newbcast:9 row_mask:0xf bank_mask:0xf
    v_and_b32_dpp v10, v32, v6 row_newbcast:9 row_mask:0xf bank_mask:0xf
    v_and_b32_dpp v11, v32, v7 row_newbcast:9 row_mask:0xf bank_mask:0xf
    s_nop 1
    v_mfma_f32_16x16x32_bf16 v[12:15], v[8:11], v[84:87], v[12:15]
    s_waitcnt vmcnt(7)
    s_mov_b32 s66, 77824
    buffer_load_dwordx4 v[60:63], v20, s[36:39], s66 offen nt
    ds_read_b128 v[172:175], v30 offset:15360
    ds_read_b128 v[176:179], v30 offset:16384
    ds_read_b128 v[180:183], v30 offset:17408
    v_and_b32_dpp v8, v32, v4 row_newbcast:5 row_mask:0xf bank_mask:0xf
    v_and_b32_dpp v9, v32, v5 row_newbcast:5 row_mask:0xf bank_mask:0xf
    v_and_b32_dpp v10, v32, v6 row_newbcast:5 row_mask:0xf bank_mask:0xf
    v_and_b32_dpp v11, v32, v7 row_newbcast:5 row_mask:0xf bank_mask:0xf
    s_nop 1
    v_mfma_f32_16x16x32_bf16 v[12:15], v[8:11], v[88:91], v[12:15]
    s_waitcnt vmcnt(7)
    s_mov_b32 s66, 81920
    buffer_load_dwordx4 v[64:67], v20, s[36:39], s66 offen nt
    ds_read_b128 v[184:187], v30 offset:18432
    ds_read_b128 v[188:191], v30 offset:19456
    ds_read_b128 v[192:195], v30 offset:20480
    v_and_b32_dpp v8, v32, v4 row_newbcast:13 row_mask:0xf bank_mask:0xf
    v_and_b32_dpp v9, v32, v5 row_newbcast:13 row_mask:0xf bank_mask:0xf
    v_and_b32_dpp v10, v32, v6 row_newbcast:13 row_mask:0xf bank_mask:0xf
    v_and_b32_dpp v11, v32, v7 row_newbcast:13 row_mask:0xf bank_mask:0xf
    s_nop 1
    v_mfma_f32_16x16x32_bf16 v[12:15], v[8:11], v[92:95], v[12:15]
    s_waitcnt vmcnt(7)
    s_mov_b32 s66, 86016
    buffer_load_dwordx4 v[68:71], v20, s[36:39], s66 offen nt
    ds_read_b128 v[196:199], v30 offset:21504
    ds_read_b128 v[200:203], v30 offset:22528
    ds_read_b128 v[204:207], v30 offset:23552
    v_and_b32_dpp v8, v32, v4 row_newbcast:3 row_mask:0xf bank_mask:0xf
    v_and_b32_dpp v9, v32, v5 row_newbcast:3 row_mask:0xf bank_mask:0xf
    v_and_b32_dpp v10, v32, v6 row_newbcast:3 row_mask:0xf bank_mask:0xf
    v_and_b32_dpp v11, v32, v7 row_newbcast:3 row_mask:0xf bank_mask:0xf
    s_nop 1
    v_mfma_f32_16x16x32_bf16 v[12:15], v[8:11], v[96:99], v[12:15]
    s_waitcnt vmcnt(7)
    s_mov_b32 s66, 90112
    buffer_load_dwordx4 v[72:75], v20, s[36:39], s66 offen nt
    ds_read_b128 v[208:211], v30 offset:24576
    ds_read_b128 v[212:215], v30 offset:25600
    ds_read_b128 v[216:219], v30 offset:26624
    v_and_b32_dpp v8, v32, v4 row_newbcast:11 row_mask:0xf bank_mask:0xf
    v_and_b32_dpp v9, v32, v5 row_newbcast:11 row_mask:0xf bank_mask:0xf
    v_and_b32_dpp v10, v32, v6 row_newbcast:11 row_mask:0xf bank_mask:0xf
    v_and_b32_dpp v11, v32, v7 row_newbcast:11 row_mask:0xf bank_mask:0xf
    s_nop 1
    v_mfma_f32_16x16x32_bf16 v[12:15], v[8:11], v[100:103], v[12:15]
    s_waitcnt vmcnt(7)
    s_mov_b32 s66, 94208
    buffer_load_dwordx4 v[76:79], v20, s[36:39], s66 offen nt
    ds_read_b128 v[220:223], v30 offset:27648
    ds_read_b128 v[224:227], v30 offset:28672
    ds_read_b128 v[228:231], v30 offset:29696
    v_and_b32_dpp v8, v32, v4 row_newbcast:7 row_mask:0xf bank_mask:0xf
    v_and_b32_dpp v9, v32, v5 row_newbcast:7 row_mask:0xf bank_mask:0xf
    v_and_b32_dpp v10, v32, v6 row_newbcast:7 row_mask:0xf bank_mask:0xf
    v_and_b32_dpp v11, v32, v7 row_newbcast:7 row_mask:0xf bank_mask:0xf
    s_nop 1
    v_mfma_f32_16x16x32_bf16 v[12:15], v[8:11], v[104:107], v[12:15]
    ds_read_b128 v[232:235], v30 offset:30720
    ds_read_b128 v[236:239], v30 offset:31744
    ds_read_b128 v[240:243], v30 offset:32768
    v_and_b32_dpp v8, v32, v4 row_newbcast:15 row_mask:0xf bank_mask:0xf
    v_and_b32_dpp v9, v32, v5 row_newbcast:15 row_mask:0xf bank_mask:0xf
    v_and_b32_dpp v10, v32, v6 row_newbcast:15 row_mask:0xf bank_mask:0xf
    v_and_b32_dpp v11, v32, v7 row_newbcast:15 row_mask:0xf bank_mask:0xf
    s_nop 1
    v_mfma_f32_16x16x32_bf16 v[12:15], v[8:11], v[108:111], v[12:15]
    ds_read_b128 v[244:247], v30 offset:33792
    ds_read_b128 v[248:251], v30 offset:34816
    ds_read_b128 v[252:255], v30 offset:35840
    v_mov_b32 v32, v33
    v_mov_b32 v33, v34
    v_mov_b32 v34, v35
    v_mov_b32 v35, v36
    v_mov_b32 v36, v37
    v_mov_b32 v37, v38
    v_mov_b32 v38, v39
    v_mov_b32 v39, v40
    v_mov_b32 v40, v41
    v_mov_b32 v41, v42
    v_mov_b32 v42, v43
    v_mov_b32 v43, v44
    v_mov_b32 v44, v45
    v_mov_b32 v45, v46
    v_mov_b32 v46, v47
    s_mov_b32 s67, 65536
    s_mov_b32 s68, 14
    s_add_u32 s75, s74, 17
    v_mov_b32 v0, s75
    s_nop 2
L_vloop:
    v_subrev_u32 v0, s75, v0
    v_cmp_gt_u32 vcc, 32, v0
    s_add_u32 s75, s75, 1
    s_bcnt1_i32_b32 s64, vcc_lo
    s_cmp_lt_u32 s64, 24
    s_nop 1
    s_cbranch_scc1 L_vlo
    v_and_b32_dpp v8, v32, v4 row_newbcast:0 row_mask:0xf bank_mask:0xf
    v_and_b32_dpp v9, v32, v5 row_newbcast:0 row_mask:0xf bank_mask:0xf
    v_and_b32_dpp v10, v32, v6 row_newbcast:0 row_mask:0xf bank_mask:0xf
    v_and_b32_dpp v11, v32, v7 row_newbcast:0 row_mask:0xf bank_mask:0xf
    s_waitcnt vmcnt(7)
    s_add_u32 s66, s67, 32768
    buffer_load_dwordx4 v[80:83], v20, s[36:39], s66 offen nt
    v_mfma_f32_16x16x32_bf16 v[12:15], v[8:11], v[48:51], v[12:15]
    v_and_b32_dpp v8, v32, v4 row_newbcast:8 row_mask:0xf bank_mask:0xf
    v_and_b32_dpp v9, v32, v5 row_newbcast:8 row_mask:0xf bank_mask:0xf
    v_and_b32_dpp v10, v32, v6 row_newbcast:8 row_mask:0xf bank_mask:0xf
    v_and_b32_dpp v11, v32, v7 row_newbcast:8 row_mask:0xf bank_mask:0xf
    s_waitcnt vmcnt(7)
    s_add_u32 s66, s67, 36864
    buffer_load_dwordx4 v[84:87], v20, s[36:39], s66 offen nt
    v_mfma_f32_16x16x32_bf16 v[12:15], v[8:11], v[52:55], v[12:15]
    v_and_b32_dpp v8, v32, v4 row_newbcast:4 row_mask:0xf bank_mask:0xf
    v_and_b32_dpp v9, v32, v5 row_newbcast:4 row_mask:0xf bank_mask:0xf
    v_and_b32_dpp v10, v32, v6 row_newbcast:4 row_mask:0xf bank_mask:0xf
    v_and_b32_dpp v11, v32, v7 row_newbcast:4 row_mask:0xf bank_mask:0xf
    s_waitcnt vmcnt(7)
    s_add_u32 s66, s67, 40960
    buffer_load_dwordx4 v[88:91], v20, s[36:39], s66 offen nt
    v_mfma_f32_16x16x32_bf16 v[12:15], v[8:11], v[56:59], v[12:15]
    v_and_b32_dpp v8, v32, v4 row_newbcast:12 row_mask:0xf bank_mask:0xf
    v_and_b32_dpp v9, v32, v5 row_newbcast:12 row_mask:0xf bank_mask:0xf
    v_and_b32_dpp v10, v32, v6 row_newbcast:12 row_mask:0xf bank_mask:0xf
    v_and_b32_dpp v11, v32, v7 row_newbcast:12 row_mask:0xf bank_mask:0xf
    s_waitcnt vmcnt(7)
    s_add_u32 s66, s67, 45056
    buffer_load_dwordx4 v[92:95], v20, s[36:39], s66 offen nt
    v_mfma_f32_16x16x32_bf16 v[12:15], v[8:11], v[60:63], v[12:15]
    v_and_b32_dpp v8, v32, v4 row_newbcast:2 row_mask:0xf bank_mask:0xf
    v_and_b32_dpp v9, v32, v5 row_newbcast:2 row_mask:0xf bank_mask:0xf
    v_and_b32_dpp v10, v32, v6 row_newbcast:2 row_mask:0xf bank_mask:0xf
    v_and_b32_dpp v11, v32, v7 row_newbcast:2 row_mask:0xf bank_mask:0xf
    s_waitcnt vmcnt(7)
    s_add_u32 s66, s67, 49152
    buffer_load_dwordx4 v[96:99], v20, s[36:39], s66 offen nt
    v_mfma_f32_16x16x32_bf16 v[12:15], v[8:11], v[64:67], v[12:15]
    v_and_b32_dpp v8, v32, v4 row_newbcast:10 row_mask:0xf bank_mask:0xf
    v_and_b32_dpp v9, v32, v5 row_newbcast:10 row_mask:0xf bank_mask:0xf
    v_and_b32_dpp v10, v32, v6 row_newbcast:10 row_mask:0xf bank_mask:0xf
    v_and_b32_dpp v11, v32, v7 row_newbcast:10 row_mask:0xf bank_mask:0xf
    s_waitcnt vmcnt(7)
    s_add_u32 s66, s67, 53248
    buffer_load_dwordx4 v[100:103], v20, s[36:39], s66 offen nt
    v_mfma_f32_16x16x32_bf16 v[12:15], v[8:11], v[68:71], v[12:15]
    v_and_b32_dpp v8, v32, v4 row_newbcast:6 row_mask:0xf bank_mask:0xf
    v_and_b32_dpp v9, v32, v5 row_newbcast:6 row_mask:0xf bank_mask:0xf
    v_and_b32_dpp v10, v32, v6 row_newbcast:6 row_mask:0xf bank_mask:0xf
    v_and_b32_dpp v11, v32, v7 row_newbcast:6 row_mask:0xf bank_mask:0xf
    s_waitcnt vmcnt(7)
    s_add_u32 s66, s67, 57344
    buffer_load_dwordx4 v[104:107], v20, s[36:39], s66 offen nt
    v_mfma_f32_16x16x32_bf16 v[12:15], v[8:11], v[72:75], v[12:15]
    v_lshlrev_b32 v28, 2, v1
    buffer_load_dword v0, v28, s[52:55], s78 offen sc1
    v_mov_b32 v28, s75
    v_mov_b32 v29, 0
    s_mov_b64 exec, 1
    buffer_store_dword v28, v29, s[52:55], s79 offen
    s_mov_b64 exec, -1
    v_and_b32_dpp v8, v32, v4 row_newbcast:14 row_mask:0xf bank_mask:0xf
    v_and_b32_dpp v9, v32, v5 row_newbcast:14 row_mask:0xf bank_mask:0xf
    v_and_b32_dpp v10, v32, v6 row_newbcast:14 row_mask:0xf bank_mask:0xf
    v_and_b32_dpp v11, v32, v7 row_newbcast:14 row_mask:0xf bank_mask:0xf
    s_waitcnt vmcnt(9)
    s_add_u32 s66, s67, 61440
    buffer_load_dwordx4 v[108:111], v20, s[36:39], s66 offen nt
    v_mfma_f32_16x16x32_bf16 v[12:15], v[8:11], v[76:79], v[12:15]
    v_and_b32_dpp v8, v32, v4 row_newbcast:1 row_mask:0xf bank_mask:0xf
    v_and_b32_dpp v9, v32, v5 row_newbcast:1 row_mask:0xf bank_mask:0xf
    v_and_b32_dpp v10, v32, v6 row_newbcast:1 row_mask:0xf bank_mask:0xf
    v_and_b32_dpp v11, v32, v7 row_newbcast:1 row_mask:0xf bank_mask:0xf
    s_waitcnt vmcnt(9)
    s_add_u32 s66, s67, 65536
    buffer_load_dwordx4 v[48:51], v20, s[36:39], s66 offen nt
    v_mfma_f32_16x16x32_bf16 v[12:15], v[8:11], v[80:83], v[12:15]
    v_and_b32_dpp v8, v32, v4 row_newbcast:9 row_mask:0xf bank_mask:0xf
    v_and_b32_dpp v9, v32, v5 row_newbcast:9 row_mask:0xf bank_mask:0xf
    v_and_b32_dpp v10, v32, v6 row_newbcast:9 row_mask:0xf bank_mask:0xf
    v_and_b32_dpp v11, v32, v7 row_newbcast:9 row_mask:0xf bank_mask:0xf
    s_waitcnt vmcnt(9)
    s_add_u32 s66, s67, 69632
    buffer_load_dwordx4 v[52:55], v20, s[36:39], s66 offen nt
    v_mfma_f32_16x16x32_bf16 v[12:15], v[8:11], v[84:87], v[12:15]
    v_and_b32_dpp v8, v32, v4 row_newbcast:5 row_mask:0xf bank_mask:0xf
    v_and_b32_dpp v9, v32, v5 row_newbcast:5 row_mask:0xf bank_mask:0xf
    v_and_b32_dpp v10, v32, v6 row_newbcast:5 row_mask:0xf bank_mask:0xf
    v_and_b32_dpp v11, v32, v7 row_newbcast:5 row_mask:0xf bank_mask:0xf
    s_waitcnt vmcnt(9)
    s_add_u32 s66, s67, 73728
    buffer_load_dwordx4 v[56:59], v20, s[36:39], s66 offen nt
    v_mfma_f32_16x16x32_bf16 v[12:15], v[8:11], v[88:91], v[12:15]
    v_and_b32_dpp v8, v32, v4 row_newbcast:13 row_mask:0xf bank_mask:0xf
    v_and_b32_dpp v9, v32, v5 row_newbcast:13 row_mask:0xf bank_mask:0xf
    v_and_b32_dpp v10, v32, v6 row_newbcast:13 row_mask:0xf bank_mask:0xf
    v_and_b32_dpp v11, v32, v7 row_newbcast:13 row_mask:0xf bank_mask:0xf
    s_waitcnt vmcnt(9)
    s_add_u32 s66, s67, 77824
    buffer_load_dwordx4 v[60:63], v20, s[36:39], s66 offen nt
    v_mfma_f32_16x16x32_bf16 v[12:15], v[8:11], v[92:95], v[12:15]
    v_and_b32_dpp v8, v32, v4 row_newbcast:3 row_mask:0xf bank_mask:0xf
    v_and_b32_dpp v9, v32, v5 row_newbcast:3 row_mask:0xf bank_mask:0xf
    v_and_b32_dpp v10, v32, v6 row_newbcast:3 row_mask:0xf bank_mask:0xf
    v_and_b32_dpp v11, v32, v7 row_newbcast:3 row_mask:0xf bank_mask:0xf
    s_waitcnt vmcnt(9)
    s_add_u32 s66, s67, 81920
    buffer_load_dwordx4 v[64:67], v20, s[36:39], s66 offen nt
    v_mfma_f32_16x16x32_bf16 v[12:15], v[8:11], v[96:99], v[12:15]
    v_and_b32_dpp v8, v32, v4 row_newbcast:11 row_mask:0xf bank_mask:0xf
    v_and_b32_dpp v9, v32, v5 row_newbcast:11 row_mask:0xf bank_mask:0xf
    v_and_b32_dpp v10, v32, v6 row_newbcast:11 row_mask:0xf bank_mask:0xf
    v_and_b32_dpp v11, v32, v7 row_newbcast:11 row_mask:0xf bank_mask:0xf
    s_waitcnt vmcnt(9)
    s_add_u32 s66, s67, 86016
    buffer_load_dwordx4 v[68:71], v20, s[36:39], s66 offen nt
    v_mfma_f32_16x16x32_bf16 v[12:15], v[8:11], v[100:103], v[12:15]
    v_and_b32_dpp v8, v32, v4 row_newbcast:7 row_mask:0xf bank_mask:0xf
    v_and_b32_dpp v9, v32, v5 row_newbcast:7 row_mask:0xf bank_mask:0xf
    v_and_b32_dpp v10, v32, v6 row_newbcast:7 row_mask:0xf bank_mask:0xf
    v_and_b32_dpp v11, v32, v7 row_newbcast:7 row_mask:0xf bank_mask:0xf
    s_waitcnt vmcnt(9)
    s_add_u32 s66, s67, 90112
    buffer_load_dwordx4 v[72:75], v20, s[36:39], s66 offen nt
    v_mfma_f32_16x16x32_bf16 v[12:15], v[8:11], v[104:107], v[12:15]
    v_and_b32_dpp v8, v32, v4 row_newbcast:15 row_mask:0xf bank_mask:0xf
    v_and_b32_dpp v9, v32, v5 row_newbcast:15 row_mask:0xf bank_mask:0xf
    v_and_b32_dpp v10, v32, v6 row_newbcast:15 row_mask:0xf bank_mask:0xf
    v_and_b32_dpp v11, v32, v7 row_newbcast:15 row_mask:0xf bank_mask:0xf
    s_waitcnt vmcnt(7)
    s_add_u32 s66, s67, 94208
    buffer_load_dwordx4 v[76:79], v20, s[36:39], s66 offen nt
    v_mfma_f32_16x16x32_bf16 v[12:15], v[8:11], v[108:111], v[12:15]
    s_nop 7
    s_branch L_vjoin
L_vlo:
    v_and_b32_dpp v8, v32, v4 row_newbcast:0 row_mask:0xf bank_mask:0xf
    v_and_b32_dpp v9, v32, v5 row_newbcast:0 row_mask:0xf bank_mask:0xf
    v_and_b32_dpp v10, v32, v6 row_newbcast:0 row_mask:0xf bank_mask:0xf
    v_and_b32_dpp v11, v32, v7 row_newbcast:0 row_mask:0xf bank_mask:0xf
    s_waitcnt vmcnt(7)
    s_waitcnt vmcnt(5)
    s_add_u32 s66, s67, 32768
    buffer_load_dwordx4 v[80:83], v20, s[36:39], s66 offen nt
    v_mfma_f32_16x16x32_bf16 v[12:15], v[8:11], v[48:51], v[12:15]
    v_and_b32_dpp v8, v32, v4 row_newbcast:8 row_mask:0xf bank_mask:0xf
    v_and_b32_dpp v9, v32, v5 row_newbcast:8 row_mask:0xf bank_mask:0xf
    v_and_b32_dpp v10, v32, v6 row_newbcast:8 row_mask:0xf bank_mask:0xf
    v_and_b32_dpp v11, v32, v7 row_newbcast:8 row_mask:0xf bank_mask:0xf
    s_waitcnt vmcnt(7)
    s_waitcnt vmcnt(5)
    s_add_u32 s66, s67, 36864
    buffer_load_dwordx4 v[84:87], v20, s[36:39], s66 offen nt
    v_mfma_f32_16x16x32_bf16 v[12:15], v[8:11], v[52:55], v[12:15]
    v_and_b32_dpp v8, v32, v4 row_newbcast:4 row_mask:0xf bank_mask:0xf
    v_and_b32_dpp v9, v32, v5 row_newbcast:4 row_mask:0xf bank_mask:0xf
    v_and_b32_dpp v10, v32, v6 row_newbcast:4 row_mask:0xf bank_mask:0xf
    v_and_b32_dpp v11, v32, v7 row_newbcast:4 row_mask:0xf bank_mask:0xf
    s_waitcnt vmcnt(7)
    s_waitcnt vmcnt(5)
    s_add_u32 s66, s67, 40960
    buffer_load_dwordx4 v[88:91], v20, s[36:39], s66 offen nt
    v_mfma_f32_16x16x32_bf16 v[12:15], v[8:11], v[56:59], v[12:15]
    v_and_b32_dpp v8, v32, v4 row_newbcast:12 row_mask:0xf bank_mask:0xf
    v_and_b32_dpp v9, v32, v5 row_newbcast:12 row_mask:0xf bank_mask:0xf
    v_and_b32_dpp v10, v32, v6 row_newbcast:12 row_mask:0xf bank_mask:0xf
    v_and_b32_dpp v11, v32, v7 row_newbcast:12 row_mask:0xf bank_mask:0xf
    s_waitcnt vmcnt(7)
    s_waitcnt vmcnt(5)
    s_add_u32 s66, s67, 45056
    buffer_load_dwordx4 v[92:95], v20, s[36:39], s66 offen nt
    v_mfma_f32_16x16x32_bf16 v[12:15], v[8:11], v[60:63], v[12:15]
    v_and_b32_dpp v8, v32, v4 row_newbcast:2 row_mask:0xf bank_mask:0xf
    v_and_b32_dpp v9, v32, v5 row_newbcast:2 row_mask:0xf bank_mask:0xf
    v_and_b32_dpp v10, v32, v6 row_newbcast:2 row_mask:0xf bank_mask:0xf
    v_and_b32_dpp v11, v32, v7 row_newbcast:2 row_mask:0xf bank_mask:0xf
    s_waitcnt vmcnt(7)
    s_waitcnt vmcnt(5)
    s_add_u32 s66, s67, 49152
    buffer_load_dwordx4 v[96:99], v20, s[36:39], s66 offen nt
    v_mfma_f32_16x16x32_bf16 v[12:15], v[8:11], v[64:67], v[12:15]
    v_and_b32_dpp v8, v32, v4 row_newbcast:10 row_mask:0xf bank_mask:0xf
    v_and_b32_dpp v9, v32, v5 row_newbcast:10 row_mask:0xf bank_mask:0xf
    v_and_b32_dpp v10, v32, v6 row_newbcast:10 row_mask:0xf bank_mask:0xf
    v_and_b32_dpp v11, v32, v7 row_newbcast:10 row_mask:0xf bank_mask:0xf
    s_waitcnt vmcnt(7)
    s_waitcnt vmcnt(5)
    s_add_u32 s66, s67, 53248
    buffer_load_dwordx4 v[100:103], v20, s[36:39], s66 offen nt
    v_mfma_f32_16x16x32_bf16 v[12:15], v[8:11], v[68:71], v[12:15]
    v_and_b32_dpp v8, v32, v4 row_newbcast:6 row_mask:0xf bank_mask:0xf
    v_and_b32_dpp v9, v32, v5 row_newbcast:6 row_mask:0xf bank_mask:0xf
    v_and_b32_dpp v10, v32, v6 row_newbcast:6 row_mask:0xf bank_mask:0xf
    v_and_b32_dpp v11, v32, v7 row_newbcast:6 row_mask:0xf bank_mask:0xf
    s_waitcnt vmcnt(7)
    s_waitcnt vmcnt(5)
    s_add_u32 s66, s67, 57344
    buffer_load_dwordx4 v[104:107], v20, s[36:39], s66 offen nt
    v_mfma_f32_16x16x32_bf16 v[12:15], v[8:11], v[72:75], v[12:15]
    v_lshlrev_b32 v28, 2, v1
    buffer_load_dword v0, v28, s[52:55], s78 offen sc1
    v_mov_b32 v28, s75
    v_mov_b32 v29, 0
    s_mov_b64 exec, 1
    buffer_store_dword v28, v29, s[52:55], s79 offen
    s_mov_b64 exec, -1
    v_and_b32_dpp v8, v32, v4 row_newbcast:14 row_mask:0xf bank_mask:0xf
    v_and_b32_dpp v9, v32, v5 row_newbcast:14 row_mask:0xf bank_mask:0xf
    v_and_b32_dpp v10, v32, v6 row_newbcast:14 row_mask:0xf bank_mask:0xf
    v_and_b32_dpp v11, v32, v7 row_newbcast:14 row_mask:0xf bank_mask:0xf
    s_waitcnt vmcnt(9)
    s_waitcnt vmcnt(5)
    s_add_u32 s66, s67, 61440
    buffer_load_dwordx4 v[108:111], v20, s[36:39], s66 offen nt
    v_mfma_f32_16x16x32_bf16 v[12:15], v[8:11], v[76:79], v[12:15]
    v_and_b32_dpp v8, v32, v4 row_newbcast:1 row_mask:0xf bank_mask:0xf
    v_and_b32_dpp v9, v32, v5 row_newbcast:1 row_mask:0xf bank_mask:0xf
    v_and_b32_dpp v10, v32, v6 row_newbcast:1 row_mask:0xf bank_mask:0xf
    v_and_b32_dpp v11, v32, v7 row_newbcast:1 row_mask:0xf bank_mask:0xf
    s_waitcnt vmcnt(9)
    s_waitcnt vmcnt(5)
    s_add_u32 s66, s67, 65536
    buffer_load_dwordx4 v[48:51], v20, s[36:39], s66 offen nt
    v_mfma_f32_16x16x32_bf16 v[12:15], v[8:11], v[80:83], v[12:15]
    v_and_b32_dpp v8, v32, v4 row_newbcast:9 row_mask:0xf bank_mask:0xf
    v_and_b32_dpp v9, v32, v5 row_newbcast:9 row_mask:0xf bank_mask:0xf
    v_and_b32_dpp v10, v32, v6 row_newbcast:9 row_mask:0xf bank_mask:0xf
    v_and_b32_dpp v11, v32, v7 row_newbcast:9 row_mask:0xf bank_mask:0xf
    s_waitcnt vmcnt(9)
    s_waitcnt vmcnt(5)
    s_add_u32 s66, s67, 69632
    buffer_load_dwordx4 v[52:55], v20, s[36:39], s66 offen nt
    v_mfma_f32_16x16x32_bf16 v[12:15], v[8:11], v[84:87], v[12:15]
    v_and_b32_dpp v8, v32, v4 row_newbcast:5 row_mask:0xf bank_mask:0xf
    v_and_b32_dpp v9, v32, v5 row_newbcast:5 row_mask:0xf bank_mask:0xf
    v_and_b32_dpp v10, v32, v6 row_newbcast:5 row_mask:0xf bank_mask:0xf
    v_and_b32_dpp v11, v32, v7 row_newbcast:5 row_mask:0xf bank_mask:0xf
    s_waitcnt vmcnt(9)
    s_waitcnt vmcnt(5)
    s_add_u32 s66, s67, 73728
    buffer_load_dwordx4 v[56:59], v20, s[36:39], s66 offen nt
    v_mfma_f32_16x16x32_bf16 v[12:15], v[8:11], v[88:91], v[12:15]
    v_and_b32_dpp v8, v32, v4 row_newbcast:13 row_mask:0xf bank_mask:0xf
    v_and_b32_dpp v9, v32, v5 row_newbcast:13 row_mask:0xf bank_mask:0xf
    v_and_b32_dpp v10, v32, v6 row_newbcast:13 row_mask:0xf bank_mask:0xf
    v_and_b32_dpp v11, v32, v7 row_newbcast:13 row_mask:0xf bank_mask:0xf
    s_waitcnt vmcnt(9)
    s_waitcnt vmcnt(5)
    s_add_u32 s66, s67, 77824
    buffer_load_dwordx4 v[60:63], v20, s[36:39], s66 offen nt
    v_mfma_f32_16x16x32_bf16 v[12:15], v[8:11], v[92:95], v[12:15]
    v_and_b32_dpp v8, v32, v4 row_newbcast:3 row_mask:0xf bank_mask:0xf
    v_and_b32_dpp v9, v32, v5 row_newbcast:3 row_mask:0xf bank_mask:0xf
    v_and_b32_dpp v10, v32, v6 row_newbcast:3 row_mask:0xf bank_mask:0xf
    v_and_b32_dpp v11, v32, v7 row_newbcast:3 row_mask:0xf bank_mask:0xf
    s_waitcnt vmcnt(9)
    s_waitcnt vmcnt(5)
    s_add_u32 s66, s67, 81920
    buffer_load_dwordx4 v[64:67], v20, s[36:39], s66 offen nt
    v_mfma_f32_16x16x32_bf16 v[12:15], v[8:11], v[96:99], v[12:15]
    v_and_b32_dpp v8, v32, v4 row_newbcast:11 row_mask:0xf bank_mask:0xf
    v_and_b32_dpp v9, v32, v5 row_newbcast:11 row_mask:0xf bank_mask:0xf
    v_and_b32_dpp v10, v32, v6 row_newbcast:11 row_mask:0xf bank_mask:0xf
    v_and_b32_dpp v11, v32, v7 row_newbcast:11 row_mask:0xf bank_mask:0xf
    s_waitcnt vmcnt(9)
    s_waitcnt vmcnt(5)
    s_add_u32 s66, s67, 86016
    buffer_load_dwordx4 v[68:71], v20, s[36:39], s66 offen nt
    v_mfma_f32_16x16x32_bf16 v[12:15], v[8:11], v[100:103], v[12:15]
    v_and_b32_dpp v8, v32, v4 row_newbcast:7 row_mask:0xf bank_mask:0xf
    v_and_b32_dpp v9, v32, v5 row_newbcast:7 row_mask:0xf bank_mask:0xf
    v_and_b32_dpp v10, v32, v6 row_newbcast:7 row_mask:0xf bank_mask:0xf
    v_and_b32_dpp v11, v32, v7 row_newbcast:7 row_mask:0xf bank_mask:0xf
    s_waitcnt vmcnt(9)
    s_waitcnt vmcnt(5)
    s_add_u32 s66, s67, 90112
    buffer_load_dwordx4 v[72:75], v20, s[36:39], s66 offen nt
    v_mfma_f32_16x16x32_bf16 v[12:15], v[8:11], v[104:107], v[12:15]
    v_and_b32_dpp v8, v32, v4 row_newbcast:15 row_mask:0xf bank_mask:0xf
    v_and_b32_dpp v9, v32, v5 row_newbcast:15 row_mask:0xf bank_mask:0xf
    v_and_b32_dpp v10, v32, v6 row_newbcast:15 row_mask:0xf bank_mask:0xf
    v_and_b32_dpp v11, v32, v7 row_newbcast:15 row_mask:0xf bank_mask:0xf
    s_waitcnt vmcnt(7)
    s_waitcnt vmcnt(5)
    s_add_u32 s66, s67, 94208
    buffer_load_dwordx4 v[76:79], v20, s[36:39], s66 offen nt
    v_mfma_f32_16x16x32_bf16 v[12:15], v[8:11], v[108:111], v[12:15]
    s_nop 7
L_vjoin:
    v_mov_b32 v32, v33
    v_mov_b32 v33, v34
    v_mov_b32 v34, v35
    v_mov_b32 v35, v36
    v_mov_b32 v36, v37
    v_mov_b32 v37, v38
    v_mov_b32 v38, v39
    v_mov_b32 v39, v40
    v_mov_b32 v40, v41
    v_mov_b32 v41, v42
    v_mov_b32 v42, v43
    v_mov_b32 v43, v44
    v_mov_b32 v44, v45
    v_mov_b32 v45, v46
    v_mov_b32 v46, v47
    s_add_u32 s67, s67, 65536
    s_sub_u32 s68, s68, 1
    s_cmp_lg_u32 s68, 0
    s_cbranch_scc1 L_vloop
    v_subrev_u32 v0, s75, v0
    v_cmp_gt_u32 vcc, 32, v0
    s_nop 0
    s_bcnt1_i32_b32 s68, vcc_lo
    v_mov_b32 v23, 0
    buffer_load_dword v23, v23, s[60:63], 0 offen offset:192
    v_lshrrev_b32 v16, 3, v3
    v_lshlrev_b32 v16, 6, v16
    v_lshl_add_u32 v16, v2, 4, v16
    s_lshl_b32 s64, s28, 7
    s_add_u32 s64, s64, 147456
    v_add_u32 v16, s64, v16
    v_lshrrev_b32 v17, 1, v2
    s_lshl_b32 s64, s28, 1
    v_add_u32 v17, s64, v17
    v_mul_u32_u24 v17, 2304, v17
    v_and_b32 v28, 7, v3
    v_lshl_add_u32 v17, v28, 5, v17
    v_and_b32 v28, 1, v2
    v_lshl_add_u32 v17, v28, 4, v17
    v_lshlrev_b32 v28, 4, v1
    v_add_u32 v28, 32768, v28
    s_mov_b32 s72, 0x00ff00ff
    s_mov_b32 s73, 0xff00ff00
    v_cndmask_b32 v17, v28, v17, s[72:73]
    v_and_b32 v28, 7, v1
    v_lshrrev_b32 v29, 3, v1
    v_cmp_eq_u32 vcc, 6, v28
    s_nop 1
    v_cndmask_b32 v22, 0, 1.0, vcc
    v_min_u32 v28, 5, v28
    v_mad_u32_u24 v19, v29, 6, v28
    s_mov_b32 s70, 0x3f3f3f3f
    s_mov_b32 s71, 0x3f3f3f3f
    s_mul_i32 s64, s28, 144
    v_add_u32 v19, s64, v19
    v_lshlrev_b32 v18, 2, v19
    v_lshlrev_b32 v19, 1, v19
    s_mul_i32 s64, s28, 768
    v_lshlrev_b32 v21, 2, v1
    v_add_u32 v21, s64, v21
    s_mul_i32 s85, s29, 1152
    s_add_u32 s85, s85, 26624
    buffer_load_ushort v27, v19, s[40:43], 0 offen offset:0
    buffer_load_ushort v28, v19, s[40:43], 0 offen offset:96
    buffer_load_ushort v29, v19, s[40:43], 0 offen offset:192
    v_and_b32_dpp v8, v32, v4 row_newbcast:0 row_mask:0xf bank_mask:0xf
    v_and_b32_dpp v9, v32, v5 row_newbcast:0 row_mask:0xf bank_mask:0xf
    v_and_b32_dpp v10, v32, v6 row_newbcast:0 row_mask:0xf bank_mask:0xf
    v_and_b32_dpp v11, v32, v7 row_newbcast:0 row_mask:0xf bank_mask:0xf
    s_waitcnt vmcnt(11)
    s_nop 0
    v_mfma_f32_16x16x32_bf16 v[12:15], v[8:11], v[48:51], v[12:15]
    s_cmp_ge_u32 s68, 24
    s_nop 6
    s_cbranch_scc1 L_vl0
    s_waitcnt vmcnt(5)
L_vl0:
    s_mov_b32 s66, 1015808
    buffer_load_dwordx4 v[80:83], v20, s[36:39], s66 offen nt
    v_and_b32_dpp v8, v32, v4 row_newbcast:8 row_mask:0xf bank_mask:0xf
    v_and_b32_dpp v9, v32, v5 row_newbcast:8 row_mask:0xf bank_mask:0xf
    v_and_b32_dpp v10, v32, v6 row_newbcast:8 row_mask:0xf bank_mask:0xf
    v_and_b32_dpp v11, v32, v7 row_newbcast:8 row_mask:0xf bank_mask:0xf
    s_waitcnt vmcnt(11)
    s_nop 0
    v_mfma_f32_16x16x32_bf16 v[12:15], v[8:11], v[52:55], v[12:15]
    s_cmp_ge_u32 s68, 24
    s_nop 6
    s_cbranch_scc1 L_vl1
    s_waitcnt vmcnt(5)
L_vl1:
    s_mov_b32 s66, 1019904
    buffer_load_dwordx4 v[84:87], v20, s[36:39], s66 offen nt
    v_and_b32_dpp v8, v32, v4 row_newbcast:4 row_mask:0xf bank_mask:0xf
    v_and_b32_dpp v9, v32, v5 row_newbcast:4 row_mask:0xf bank_mask:0xf
    v_and_b32_dpp v10, v32, v6 row_newbcast:4 row_mask:0xf bank_mask:0xf
    v_and_b32_dpp v11, v32, v7 row_newbcast:4 row_mask:0xf bank_mask:0xf
    s_waitcnt vmcnt(11)
    s_nop 0
    v_mfma_f32_16x16x32_bf16 v[12:15], v[8:11], v[56:59], v[12:15]
    s_cmp_ge_u32 s68, 24
    s_nop 6
    s_cbranch_scc1 L_vl2
    s_waitcnt vmcnt(5)
L_vl2:
    s_mov_b32 s66, 1024000
    buffer_load_dwordx4 v[88:91], v20, s[36:39], s66 offen nt
    v_and_b32_dpp v8, v32, v4 row_newbcast:12 row_mask:0xf bank_mask:0xf
    v_and_b32_dpp v9, v32, v5 row_newbcast:12 row_mask:0xf bank_mask:0xf
    v_and_b32_dpp v10, v32, v6 row_newbcast:12 row_mask:0xf bank_mask:0xf
    v_and_b32_dpp v11, v32, v7 row_newbcast:12 row_mask:0xf bank_mask:0xf
    s_waitcnt vmcnt(11)
    s_nop 0
    v_mfma_f32_16x16x32_bf16 v[12:15], v[8:11], v[60:63], v[12:15]
    s_cmp_ge_u32 s68, 24
    s_nop 6
    s_cbranch_scc1 L_vl3
    s_waitcnt vmcnt(5)
L_vl3:
    s_mov_b32 s66, 1028096
    buffer_load_dwordx4 v[92:95], v20, s[36:39], s66 offen nt
    v_and_b32_dpp v8, v32, v4 row_newbcast:2 row_mask:0xf bank_mask:0xf
    v_and_b32_dpp v9, v32, v5 row_newbcast:2 row_mask:0xf bank_mask:0xf
    v_and_b32_dpp v10, v32, v6 row_newbcast:2 row_mask:0xf bank_mask:0xf
    v_and_b32_dpp v11, v32, v7 row_newbcast:2 row_mask:0xf bank_mask:0xf
    s_waitcnt vmcnt(11)
    s_nop 0
    v_mfma_f32_16x16x32_bf16 v[12:15], v[8:11], v[64:67], v[12:15]
    s_cmp_ge_u32 s68, 24
    s_nop 6
    s_cbranch_scc1 L_vl4
    s_waitcnt vmcnt(5)
L_vl4:
    s_mov_b32 s66, 1032192
    buffer_load_dwordx4 v[96:99], v20, s[36:39], s66 offen nt
    v_and_b32_dpp v8, v32, v4 row_newbcast:10 row_mask:0xf bank_mask:0xf
    v_and_b32_dpp v9, v32, v5 row_newbcast:10 row_mask:0xf bank_mask:0xf
    v_and_b32_dpp v10, v32, v6 row_newbcast:10 row_mask:0xf bank_mask:0xf
    v_and_b32_dpp v11, v32, v7 row_newbcast:10 row_mask:0xf bank_mask:0xf
    s_waitcnt vmcnt(11)
    s_nop 0
    v_mfma_f32_16x16x32_bf16 v[12:15], v[8:11], v[68:71], v[12:15]
    s_cmp_ge_u32 s68, 24
    s_nop 6
    s_cbranch_scc1 L_vl5
    s_waitcnt vmcnt(5)
L_vl5:
    s_mov_b32 s66, 1036288
    buffer_load_dwordx4 v[100:103], v20, s[36:39], s66 offen nt
    v_and_b32_dpp v8, v32, v4 row_newbcast:6 row_mask:0xf bank_mask:0xf
    v_and_b32_dpp v9, v32, v5 row_newbcast:6 row_mask:0xf bank_mask:0xf
    v_and_b32_dpp v10, v32, v6 row_newbcast:6 row_mask:0xf bank_mask:0xf
    v_and_b32_dpp v11, v32, v7 row_newbcast:6 row_mask:0xf bank_mask:0xf
    s_waitcnt vmcnt(11)
    s_nop 0
    v_mfma_f32_16x16x32_bf16 v[12:15], v[8:11], v[72:75], v[12:15]
    s_cmp_ge_u32 s68, 24
    s_nop 6
    s_cbranch_scc1 L_vl6
    s_waitcnt vmcnt(5)
L_vl6:
    s_mov_b32 s66, 1040384
    buffer_load_dwordx4 v[104:107], v20, s[36:39], s66 offen nt
    v_and_b32_dpp v8, v32, v4 row_newbcast:14 row_mask:0xf bank_mask:0xf
    v_and_b32_dpp v9, v32, v5 row_newbcast:14 row_mask:0xf bank_mask:0xf
    v_and_b32_dpp v10, v32, v6 row_newbcast:14 row_mask:0xf bank_mask:0xf
    v_and_b32_dpp v11, v32, v7 row_newbcast:14 row_mask:0xf bank_mask:0xf
    s_waitcnt vmcnt(11)
    s_nop 0
    v_mfma_f32_16x16x32_bf16 v[12:15], v[8:11], v[76:79], v[12:15]
    s_cmp_ge_u32 s68, 24
    s_nop 6
    s_cbranch_scc1 L_vl7
    s_waitcnt vmcnt(5)
L_vl7:
    s_mov_b32 s66, 1044480
    buffer_load_dwordx4 v[108:111], v20, s[36:39], s66 offen nt
    v_and_b32_dpp v8, v32, v4 row_newbcast:1 row_mask:0xf bank_mask:0xf
    v_and_b32_dpp v9, v32, v5 row_newbcast:1 row_mask:0xf bank_mask:0xf
    v_and_b32_dpp v10, v32, v6 row_newbcast:1 row_mask:0xf bank_mask:0xf
    v_and_b32_dpp v11, v32, v7 row_newbcast:1 row_mask:0xf bank_mask:0xf
    s_waitcnt vmcnt(7)
    s_nop 0
    v_mfma_f32_16x16x32_bf16 v[12:15], v[8:11], v[80:83], v[12:15]
    v_readfirstlane_b32 s69, v23
    s_nop 0
    s_cmp_lg_u32 s69, 0
    s_cselect_b32 s64, s85, 679936
    buffer_load_ushort v24, v19, s[52:55], s64 offen offset:0
    buffer_load_ushort v25, v19, s[52:55], s64 offen offset:96
    buffer_load_ushort v26, v19, s[52:55], s64 offen offset:192
    v_and_b32_dpp v8, v32, v4 row_newbcast:9 row_mask:0xf bank_mask:0xf
    v_and_b32_dpp v9, v32, v5 row_newbcast:9 row_mask:0xf bank_mask:0xf
    v_and_b32_dpp v10, v32, v6 row_newbcast:9 row_mask:0xf bank_mask:0xf
    v_and_b32_dpp v11, v32, v7 row_newbcast:9 row_mask:0xf bank_mask:0xf
    s_waitcnt vmcnt(9)
    s_nop 0
    v_mfma_f32_16x16x32_bf16 v[12:15], v[8:11], v[84:87], v[12:15]
    v_and_b32_dpp v8, v32, v4 row_newbcast:5 row_mask:0xf bank_mask:0xf
    v_and_b32_dpp v9, v32, v5 row_newbcast:5 row_mask:0xf bank_mask:0xf
    v_and_b32_dpp v10, v32, v6 row_newbcast:5 row_mask:0xf bank_mask:0xf
    v_and_b32_dpp v11, v32, v7 row_newbcast:5 row_mask:0xf bank_mask:0xf
    s_waitcnt vmcnt(8)
    s_nop 0
    v_mfma_f32_16x16x32_bf16 v[12:15], v[8:11], v[88:91], v[12:15]
    v_and_b32_dpp v8, v32, v4 row_newbcast:13 row_mask:0xf bank_mask:0xf
    v_and_b32_dpp v9, v32, v5 row_newbcast:13 row_mask:0xf bank_mask:0xf
    v_and_b32_dpp v10, v32, v6 row_newbcast:13 row_mask:0xf bank_mask:0xf
    v_and_b32_dpp v11, v32, v7 row_newbcast:13 row_mask:0xf bank_mask:0xf
    s_waitcnt vmcnt(7)
    s_nop 0
    v_mfma_f32_16x16x32_bf16 v[12:15], v[8:11], v[92:95], v[12:15]
    v_and_b32_dpp v8, v32, v4 row_newbcast:3 row_mask:0xf bank_mask:0xf
    v_and_b32_dpp v9, v32, v5 row_newbcast:3 row_mask:0xf bank_mask:0xf
    v_and_b32_dpp v10, v32, v6 row_newbcast:3 row_mask:0xf bank_mask:0xf
    v_and_b32_dpp v11, v32, v7 row_newbcast:3 row_mask:0xf bank_mask:0xf
    s_waitcnt vmcnt(6)
    s_nop 0
    v_mfma_f32_16x16x32_bf16 v[12:15], v[8:11], v[96:99], v[12:15]
    v_and_b32_dpp v8, v32, v4 row_newbcast:11 row_mask:0xf bank_mask:0xf
    v_and_b32_dpp v9, v32, v5 row_newbcast:11 row_mask:0xf bank_mask:0xf
    v_and_b32_dpp v10, v32, v6 row_newbcast:11 row_mask:0xf bank_mask:0xf
    v_and_b32_dpp v11, v32, v7 row_newbcast:11 row_mask:0xf bank_mask:0xf
    s_waitcnt vmcnt(5)
    s_nop 0
    v_mfma_f32_16x16x32_bf16 v[12:15], v[8:11], v[100:103], v[12:15]
    v_and_b32_dpp v8, v32, v4 row_newbcast:7 row_mask:0xf bank_mask:0xf
    v_and_b32_dpp v9, v32, v5 row_newbcast:7 row_mask:0xf bank_mask:0xf
    v_and_b32_dpp v10, v32, v6 row_newbcast:7 row_mask:0xf bank_mask:0xf
    v_and_b32_dpp v11, v32, v7 row_newbcast:7 row_mask:0xf bank_mask:0xf
    s_waitcnt vmcnt(4)
    s_nop 0
    v_mfma_f32_16x16x32_bf16 v[12:15], v[8:11], v[104:107], v[12:15]
    v_and_b32_dpp v8, v32, v4 row_newbcast:15 row_mask:0xf bank_mask:0xf
    v_and_b32_dpp v9, v32, v5 row_newbcast:15 row_mask:0xf bank_mask:0xf
    v_and_b32_dpp v10, v32, v6 row_newbcast:15 row_mask:0xf bank_mask:0xf
    v_and_b32_dpp v11, v32, v7 row_newbcast:15 row_mask:0xf bank_mask:0xf
    s_waitcnt vmcnt(3)
    s_nop 0
    v_mfma_f32_16x16x32_bf16 v[12:15], v[8:11], v[108:111], v[12:15]
    s_waitcnt vmcnt(0)
    s_nop 6
    ds_write_b128 v31, v[12:15]
    s_waitcnt lgkmcnt(0)
    s_barrier
    ds_read_b128 v[48:51], v16 offset:0
    ds_read_b128 v[52:55], v16 offset:512
    ds_read_b128 v[56:59], v16 offset:1024
    ds_read_b128 v[60:63], v16 offset:1536
    s_waitcnt lgkmcnt(0)
    v_add_f32 v48, v48, v52
    v_add_f32 v56, v56, v60
    v_add_f32 v49, v49, v53
    v_add_f32 v57, v57, v61
    v_add_f32 v50, v50, v54
    v_add_f32 v58, v58, v62
    v_add_f32 v51, v51, v55
    v_add_f32 v59, v59, v63
    v_add_f32 v48, v48, v56
    v_add_f32 v49, v49, v57
    v_add_f32 v50, v50, v58
    v_add_f32 v51, v51, v59
    v_cvt_pk_bf16_f32 v48, v48, v48
    v_cvt_pk_bf16_f32 v49, v49, v49
    v_cvt_pk_bf16_f32 v50, v50, v50
    v_cvt_pk_bf16_f32 v51, v51, v51
    v_and_b32 v32, v48, v4
    v_and_b32 v33, v48, v5
    v_and_b32 v34, v48, v6
    v_and_b32 v35, v48, v7
    s_nop 1
    v_mfma_f32_16x16x32_bf16 v[64:67], v[32:35], v[112:115], 0
    v_and_b32 v36, v49, v4
    v_and_b32 v37, v49, v5
    v_mfma_f32_16x16x32_bf16 v[68:71], v[32:35], v[116:119], 0
    v_and_b32 v38, v49, v6
    v_and_b32 v39, v49, v7
    v_mfma_f32_16x16x32_bf16 v[72:75], v[32:35], v[120:123], 0
    v_and_b32 v40, v50, v4
    v_and_b32 v41, v50, v5
    v_mfma_f32_16x16x32_bf16 v[76:79], v[32:35], v[124:127], 0
    v_and_b32 v42, v50, v6
    v_and_b32 v43, v50, v7
    v_mfma_f32_16x16x32_bf16 v[80:83], v[32:35], v[128:131], 0
    v_and_b32 v44, v51, v4
    v_and_b32 v45, v51, v5
    v_mfma_f32_16x16x32_bf16 v[84:87], v[32:35], v[132:135], 0
    v_and_b32 v46, v51, v6
    v_and_b32 v47, v51, v7
    v_mfma_f32_16x16x32_bf16 v[64:67], v[36:39], v[148:151], v[64:67]
    v_mfma_f32_16x16x32_bf16 v[64:67], v[40:43], v[184:187], v[64:67]
    v_mfma_f32_16x16x32_bf16 v[64:67], v[44:47], v[220:223], v[64:67]
    v_mfma_f32_16x16x32_bf16 v[68:71], v[36:39], v[152:155], v[68:71]
    v_mfma_f32_16x16x32_bf16 v[68:71], v[40:43], v[188:191], v[68:71]
    v_mfma_f32_16x16x32_bf16 v[68:71], v[44:47], v[224:227], v[68:71]
    v_mfma_f32_16x16x32_bf16 v[72:75], v[36:39], v[156:159], v[72:75]
    v_mfma_f32_16x16x32_bf16 v[72:75], v[40:43], v[192:195], v[72:75]
    v_mfma_f32_16x16x32_bf16 v[72:75], v[44:47], v[228:231], v[72:75]
    v_mfma_f32_16x16x32_bf16 v[76:79], v[36:39], v[160:163], v[76:79]
    v_mfma_f32_16x16x32_bf16 v[76:79], v[40:43], v[196:199], v[76:79]
    v_mfma_f32_16x16x32_bf16 v[76:79], v[44:47], v[232:235], v[76:79]
    ds_write_b128 v17, v[64:67] offset:0
    v_mfma_f32_16x16x32_bf16 v[80:83], v[36:39], v[164:167], v[80:83]
    v_mfma_f32_16x16x32_bf16 v[80:83], v[40:43], v[200:203], v[80:83]
    v_mfma_f32_16x16x32_bf16 v[80:83], v[44:47], v[236:239], v[80:83]
    ds_write_b128 v17, v[68:71] offset:256
    v_mfma_f32_16x16x32_bf16 v[84:87], v[36:39], v[168:171], v[84:87]
    v_mfma_f32_16x16x32_bf16 v[84:87], v[40:43], v[204:207], v[84:87]
    v_mfma_f32_16x16x32_bf16 v[84:87], v[44:47], v[240:243], v[84:87]
    ds_write_b128 v17, v[72:75] offset:512
    v_mfma_f32_16x16x32_bf16 v[88:91], v[32:35], v[136:139], 0
    v_mfma_f32_16x16x32_bf16 v[88:91], v[36:39], v[172:175], v[88:91]
    v_mfma_f32_16x16x32_bf16 v[88:91], v[40:43], v[208:211], v[88:91]
    v_mfma_f32_16x16x32_bf16 v[88:91], v[44:47], v[244:247], v[88:91]
    ds_write_b128 v17, v[76:79] offset:768
    v_mfma_f32_16x16x32_bf16 v[92:95], v[32:35], v[140:143], 0
    v_mfma_f32_16x16x32_bf16 v[92:95], v[36:39], v[176:179], v[92:95]
    v_mfma_f32_16x16x32_bf16 v[92:95], v[40:43], v[212:215], v[92:95]
    v_mfma_f32_16x16x32_bf16 v[92:95], v[44:47], v[248:251], v[92:95]
    ds_write_b128 v17, v[80:83] offset:1024
    v_mfma_f32_16x16x32_bf16 v[96:99], v[32:35], v[144:147], 0
    v_mfma_f32_16x16x32_bf16 v[96:99], v[36:39], v[180:183], v[96:99]
    v_mfma_f32_16x16x32_bf16 v[96:99], v[40:43], v[216:219], v[96:99]
    v_mfma_f32_16x16x32_bf16 v[96:99], v[44:47], v[252:255], v[96:99]
    ds_write_b128 v17, v[84:87] offset:1280
    ds_write_b128 v17, v[88:91] offset:1536
    s_nop 0
    ds_write_b128 v17, v[92:95] offset:1792
    s_nop 3
    ds_write_b128 v17, v[96:99] offset:2048
    s_mul_i32 s66, s29, 3072
    s_waitcnt lgkmcnt(0)
    s_barrier
    ds_read_b32 v112, v18 offset:0
    ds_read_b32 v113, v18 offset:2304
    ds_read_b32 v114, v18 offset:4608
    ds_read_b32 v115, v18 offset:6912
    ds_read_b32 v116, v18 offset:9216
    ds_read_b32 v117, v18 offset:11520
    ds_read_b32 v118, v18 offset:13824
    ds_read_b32 v119, v18 offset:16128
    ds_read_b32 v120, v18 offset:192
    ds_read_b32 v121, v18 offset:2496
    ds_read_b32 v122, v18 offset:4800
    ds_read_b32 v123, v18 offset:7104
    ds_read_b32 v124, v18 offset:9408
    ds_read_b32 v125, v18 offset:11712
    ds_read_b32 v126, v18 offset:14016
    ds_read_b32 v127, v18 offset:16320
    ds_read_b32 v128, v18 offset:384
    ds_read_b32 v129, v18 offset:2688
    ds_read_b32 v130, v18 offset:4992
    ds_read_b32 v131, v18 offset:7296
    ds_read_b32 v132, v18 offset:9600
    ds_read_b32 v133, v18 offset:11904
    ds_read_b32 v134, v18 offset:14208
    ds_read_b32 v135, v18 offset:16512
    s_waitcnt lgkmcnt(15)
    v_add_f32 v112, v112, v116
    v_add_f32 v113, v113, v117
    v_add_f32 v114, v114, v118
    v_add_f32 v115, v115, v119
    v_add_f32 v112, v112, v113
    v_add_f32 v114, v114, v115
    v_add_f32 v112, v112, v114
    v_cndmask_b32 v112, v22, v112, s[70:71]
    v_mov_b32 v113, v112
    buffer_atomic_add_f32 v113, v21, s[52:55], s66 offen offset:0 sc0 sc1
    s_waitcnt lgkmcnt(8)
    v_add_f32 v120, v120, v124
    v_add_f32 v121, v121, v125
    v_add_f32 v122, v122, v126
    v_add_f32 v123, v123, v127
    v_add_f32 v120, v120, v121
    v_add_f32 v122, v122, v123
    v_add_f32 v120, v120, v122
    v_cndmask_b32 v120, v22, v120, s[70:71]
    v_mov_b32 v121, v120
    buffer_atomic_add_f32 v121, v21, s[52:55], s66 offen offset:256 sc0 sc1
    s_waitcnt lgkmcnt(0)
    v_add_f32 v128, v128, v132
    v_add_f32 v129, v129, v133
    v_add_f32 v130, v130, v134
    v_add_f32 v131, v131, v135
    v_add_f32 v128, v128, v129
    v_add_f32 v130, v130, v131
    v_add_f32 v128, v128, v130
    v_cndmask_b32 v128, v22, v128, s[70:71]
    v_mov_b32 v129, v128
    buffer_atomic_add_f32 v129, v21, s[52:55], s66 offen offset:512 sc0 sc1
    s_cmp_lg_u32 s69, 0
    s_nop 0
    s_cbranch_scc1 L_grdy
    s_waitcnt vmcnt(0)
    buffer_load_ushort v24, v19, s[52:55], s85 offen offset:0 sc1
    buffer_load_ushort v25, v19, s[52:55], s85 offen offset:96 sc1
    buffer_load_ushort v26, v19, s[52:55], s85 offen offset:192 sc1
    s_waitcnt vmcnt(0)
L_grdy:
    s_waitcnt vmcnt(2)
    v_mov_b32_dpp v30, v113 row_newbcast:6 row_mask:0xf bank_mask:0x3
    v_mov_b32_dpp v30, v113 row_newbcast:14 row_mask:0xf bank_mask:0xc
    v_add_f32 v112, v112, v113
    v_cmp_eq_f32 vcc, 0x42000000, v30
    v_cvt_pk_bf16_f32 v112, v112, v112
    v_and_b32 v112, 0xffff0000, v112
    v_lshlrev_b32 v20, 16, v24
    s_and_b64 vcc, vcc, s[70:71]
    v_mul_f32 v112, v112, v20
    v_cvt_pk_bf16_f32 v112, v112, v112
    v_and_b32 v112, 0xffff0000, v112
    v_lshlrev_b32 v20, 16, v27
    v_add_f32 v112, v112, v20
    v_cvt_pk_bf16_f32 v112, v112, v112
    s_and_saveexec_b64 s[82:83], vcc
    s_nop 1
    s_cbranch_execz L_fin0
    buffer_store_short v112, v19, s[56:59], 0 offen offset:0
L_fin0:
    s_mov_b64 exec, s[82:83]
    s_waitcnt vmcnt(1)
    v_mov_b32_dpp v30, v121 row_newbcast:6 row_mask:0xf bank_mask:0x3
    v_mov_b32_dpp v30, v121 row_newbcast:14 row_mask:0xf bank_mask:0xc
    v_add_f32 v120, v120, v121
    v_cmp_eq_f32 vcc, 0x42000000, v30
    v_cvt_pk_bf16_f32 v120, v120, v120
    v_and_b32 v120, 0xffff0000, v120
    v_lshlrev_b32 v20, 16, v25
    s_and_b64 vcc, vcc, s[70:71]
    v_mul_f32 v120, v120, v20
    v_cvt_pk_bf16_f32 v120, v120, v120
    v_and_b32 v120, 0xffff0000, v120
    v_lshlrev_b32 v20, 16, v28
    v_add_f32 v120, v120, v20
    v_cvt_pk_bf16_f32 v120, v120, v120
    s_and_saveexec_b64 s[82:83], vcc
    s_nop 1
    s_cbranch_execz L_fin1
    buffer_store_short v120, v19, s[56:59], 0 offen offset:96
L_fin1:
    s_mov_b64 exec, s[82:83]
    s_waitcnt vmcnt(0)
    v_mov_b32_dpp v30, v129 row_newbcast:6 row_mask:0xf bank_mask:0x3
    v_mov_b32_dpp v30, v129 row_newbcast:14 row_mask:0xf bank_mask:0xc
    v_add_f32 v128, v128, v129
    v_cmp_eq_f32 vcc, 0x42000000, v30
    v_cvt_pk_bf16_f32 v128, v128, v128
    v_and_b32 v128, 0xffff0000, v128
    v_lshlrev_b32 v20, 16, v26
    s_and_b64 vcc, vcc, s[70:71]
    v_mul_f32 v128, v128, v20
    v_cvt_pk_bf16_f32 v128, v128, v128
    v_and_b32 v128, 0xffff0000, v128
    v_lshlrev_b32 v20, 16, v29
    v_add_f32 v128, v128, v20
    v_cvt_pk_bf16_f32 v128, v128, v128
    s_and_saveexec_b64 s[82:83], vcc
    s_nop 1
    s_cbranch_execz L_fin2
    buffer_store_short v128, v19, s[56:59], 0 offen offset:192
L_fin2:
    s_mov_b64 exec, s[82:83]
    s_endpgm
L_helper:
    s_setprio 3
    s_mov_b32 s74, 0x05040100
    s_mov_b32 s75, 0x07060302
    v_mov_b32 v7, 0
    v_and_b32 v8, 7, v3
    v_mul_u32_u24 v8, 1152, v8
    v_lshl_add_u32 v8, v2, 4, v8
    v_lshrrev_b32 v9, 3, v3
    v_lshl_add_u32 v9, v9, 6, v8
    v_lshrrev_b32 v128, 1, v1
    v_lshlrev_b32 v128, 13, v128
    v_and_b32 v11, 1, v1
    v_lshl_add_u32 v128, v11, 4, v128
    s_lshl_b32 s64, s30, 8
    v_add_u32 v128, s64, v128
    v_lshrrev_b32 v129, 2, v3
    v_lshl_add_u32 v129, v2, 3, v129
    v_lshlrev_b32 v129, 5, v129
    v_and_b32 v11, 3, v3
    v_lshl_add_u32 v129, v11, 3, v129
    s_lshl_b32 s85, s30, 6
    s_add_u32 s65, s85, 36864
    s_lshl_b32 s67, s29, 5
    s_waitcnt lgkmcnt(0)
    s_mov_b32 s40, s4
    s_mov_b32 s41, s5
    s_mov_b32 s42, 9216
    s_mov_b32 s43, 0x20000
    buffer_load_dwordx4 v[172:175], v9, s[40:43], 0 offen offset:0
    buffer_load_dwordx4 v[176:179], v9, s[40:43], 0 offen offset:128
    buffer_load_dwordx4 v[180:183], v9, s[40:43], 0 offen offset:256
    buffer_load_dwordx4 v[184:187], v9, s[40:43], 0 offen offset:384
    buffer_load_dwordx4 v[188:191], v9, s[40:43], 0 offen offset:512
    buffer_load_dwordx4 v[192:195], v9, s[40:43], 0 offen offset:640
    buffer_load_dwordx4 v[196:199], v9, s[40:43], 0 offen offset:768
    buffer_load_dwordx4 v[200:203], v9, s[40:43], 0 offen offset:896
    buffer_load_dwordx4 v[204:207], v9, s[40:43], 0 offen offset:1024
    v_mov_b32 v11, 154464
    ds_write_b32 v11, v7
    s_waitcnt lgkmcnt(0)
    s_barrier
    s_mov_b32 s44, s10
    s_mov_b32 s45, s11
    s_mov_b32 s46, 4718592
    s_mov_b32 s47, 0x20000
    s_and_b32 s79, s29, 3
    s_mul_i32 s79, s79, 9
    s_lshr_b32 s79, s79, 1
    s_lshl_b32 m0, s79, 10
    s_lshl_b32 s66, s79, 18
    s_add_u32 s66, s66, s67
    buffer_load_dwordx4 v128, s[44:47], s66 offen lds
    s_add_u32 s79, s79, 1
    s_cmp_eq_u32 s79, 18
    s_cselect_b32 s79, 0, s79
    s_lshl_b32 m0, s79, 10
    s_lshl_b32 s66, s79, 18
    s_add_u32 s66, s66, s67
    buffer_load_dwordx4 v128, s[44:47], s66 offen lds
    s_add_u32 s79, s79, 1
    s_cmp_eq_u32 s79, 18
    s_cselect_b32 s79, 0, s79
    s_lshl_b32 m0, s79, 10
    s_lshl_b32 s66, s79, 18
    s_add_u32 s66, s66, s67
    buffer_load_dwordx4 v128, s[44:47], s66 offen lds
    s_add_u32 s79, s79, 1
    s_cmp_eq_u32 s79, 18
    s_cselect_b32 s79, 0, s79
    s_lshl_b32 m0, s79, 10
    s_lshl_b32 s66, s79, 18
    s_add_u32 s66, s66, s67
    buffer_load_dwordx4 v128, s[44:47], s66 offen lds
    s_add_u32 s79, s79, 1
    s_cmp_eq_u32 s79, 18
    s_cselect_b32 s79, 0, s79
    s_lshl_b32 m0, s79, 10
    s_lshl_b32 s66, s79, 18
    s_add_u32 s66, s66, s67
    buffer_load_dwordx4 v128, s[44:47], s66 offen lds
    s_add_u32 s79, s79, 1
    s_cmp_eq_u32 s79, 18
    s_cselect_b32 s79, 0, s79
    s_lshl_b32 m0, s79, 10
    s_lshl_b32 s66, s79, 18
    s_add_u32 s66, s66, s67
    buffer_load_dwordx4 v128, s[44:47], s66 offen lds
    s_add_u32 s79, s79, 1
    s_cmp_eq_u32 s79, 18
    s_cselect_b32 s79, 0, s79
    s_lshl_b32 m0, s79, 10
    s_lshl_b32 s66, s79, 18
    s_add_u32 s66, s66, s67
    buffer_load_dwordx4 v128, s[44:47], s66 offen lds
    s_add_u32 s79, s79, 1
    s_cmp_eq_u32 s79, 18
    s_cselect_b32 s79, 0, s79
    s_lshl_b32 m0, s79, 10
    s_lshl_b32 s66, s79, 18
    s_add_u32 s66, s66, s67
    buffer_load_dwordx4 v128, s[44:47], s66 offen lds
    s_add_u32 s79, s79, 1
    s_cmp_eq_u32 s79, 18
    s_cselect_b32 s79, 0, s79
    s_lshl_b32 m0, s79, 10
    s_lshl_b32 s66, s79, 18
    s_add_u32 s66, s66, s67
    buffer_load_dwordx4 v128, s[44:47], s66 offen lds
    s_add_u32 s79, s79, 1
    s_cmp_eq_u32 s79, 18
    s_cselect_b32 s79, 0, s79
    s_lshl_b32 m0, s79, 10
    s_lshl_b32 s66, s79, 18
    s_add_u32 s66, s66, s67
    buffer_load_dwordx4 v128, s[44:47], s66 offen lds
    s_add_u32 s79, s79, 1
    s_cmp_eq_u32 s79, 18
    s_cselect_b32 s79, 0, s79
    s_lshl_b32 m0, s79, 10
    s_lshl_b32 s66, s79, 18
    s_add_u32 s66, s66, s67
    buffer_load_dwordx4 v128, s[44:47], s66 offen lds
    s_add_u32 s79, s79, 1
    s_cmp_eq_u32 s79, 18
    s_cselect_b32 s79, 0, s79
    s_lshl_b32 m0, s79, 10
    s_lshl_b32 s66, s79, 18
    s_add_u32 s66, s66, s67
    buffer_load_dwordx4 v128, s[44:47], s66 offen lds
    s_add_u32 s79, s79, 1
    s_cmp_eq_u32 s79, 18
    s_cselect_b32 s79, 0, s79
    s_lshl_b32 m0, s79, 10
    s_lshl_b32 s66, s79, 18
    s_add_u32 s66, s66, s67
    buffer_load_dwordx4 v128, s[44:47], s66 offen lds
    s_add_u32 s79, s79, 1
    s_cmp_eq_u32 s79, 18
    s_cselect_b32 s79, 0, s79
    s_lshl_b32 m0, s79, 10
    s_lshl_b32 s66, s79, 18
    s_add_u32 s66, s66, s67
    buffer_load_dwordx4 v128, s[44:47], s66 offen lds
    s_add_u32 s79, s79, 1
    s_cmp_eq_u32 s79, 18
    s_cselect_b32 s79, 0, s79
    s_lshl_b32 m0, s79, 10
    s_lshl_b32 s66, s79, 18
    s_add_u32 s66, s66, s67
    buffer_load_dwordx4 v128, s[44:47], s66 offen lds
    s_add_u32 s79, s79, 1
    s_cmp_eq_u32 s79, 18
    s_cselect_b32 s79, 0, s79
    s_lshl_b32 m0, s79, 10
    s_lshl_b32 s66, s79, 18
    s_add_u32 s66, s66, s67
    buffer_load_dwordx4 v128, s[44:47], s66 offen lds
    s_add_u32 s79, s79, 1
    s_cmp_eq_u32 s79, 18
    s_cselect_b32 s79, 0, s79
    s_lshl_b32 m0, s79, 10
    s_lshl_b32 s66, s79, 18
    s_add_u32 s66, s66, s67
    buffer_load_dwordx4 v128, s[44:47], s66 offen lds
    s_add_u32 s79, s79, 1
    s_cmp_eq_u32 s79, 18
    s_cselect_b32 s79, 0, s79
    s_lshl_b32 m0, s79, 10
    s_lshl_b32 s66, s79, 18
    s_add_u32 s66, s66, s67
    buffer_load_dwordx4 v128, s[44:47], s66 offen lds
    s_add_u32 s79, s79, 1
    s_cmp_eq_u32 s79, 18
    s_cselect_b32 s79, 0, s79
    s_mov_b32 s52, s26
    s_mov_b32 s53, s27
    s_mov_b32 s54, 679936
    s_mov_b32 s55, 0x20000
    s_mov_b32 s60, s24
    s_mov_b32 s61, s25
    s_mov_b32 s62, 256
    s_mov_b32 s63, 0x20000
    buffer_load_dword v126, v7, s[52:55], s65 offen sc1
    v_xor_b32 v244, 16, v1
    v_lshlrev_b32 v244, 2, v244
    v_xor_b32 v245, 32, v1
    v_lshlrev_b32 v245, 2, v245
    s_mov_b32 s64, 0x3f803f80
    s_waitcnt vmcnt(19)
    v_dot2_f32_bf16 v242, v172, s64, 0
    v_dot2_f32_bf16 v243, v173, s64, 0
    v_dot2_f32_bf16 v242, v174, s64, v242
    v_dot2_f32_bf16 v243, v175, s64, v243
    v_dot2_f32_bf16 v242, v176, s64, v242
    v_dot2_f32_bf16 v243, v177, s64, v243
    v_dot2_f32_bf16 v242, v178, s64, v242
    v_dot2_f32_bf16 v243, v179, s64, v243
    v_dot2_f32_bf16 v242, v180, s64, v242
    v_dot2_f32_bf16 v243, v181, s64, v243
    v_dot2_f32_bf16 v242, v182, s64, v242
    v_dot2_f32_bf16 v243, v183, s64, v243
    v_dot2_f32_bf16 v242, v184, s64, v242
    v_dot2_f32_bf16 v243, v185, s64, v243
    v_dot2_f32_bf16 v242, v186, s64, v242
    v_dot2_f32_bf16 v243, v187, s64, v243
    v_dot2_f32_bf16 v242, v188, s64, v242
    v_dot2_f32_bf16 v243, v189, s64, v243
    v_dot2_f32_bf16 v242, v190, s64, v242
    v_dot2_f32_bf16 v243, v191, s64, v243
    v_dot2_f32_bf16 v242, v192, s64, v242
    v_dot2_f32_bf16 v243, v193, s64, v243
    v_dot2_f32_bf16 v242, v194, s64, v242
    v_dot2_f32_bf16 v243, v195, s64, v243
    v_dot2_f32_bf16 v242, v196, s64, v242
    v_dot2_f32_bf16 v243, v197, s64, v243
    v_dot2_f32_bf16 v242, v198, s64, v242
    v_dot2_f32_bf16 v243, v199, s64, v243
    v_dot2_f32_bf16 v242, v200, s64, v242
    v_dot2_f32_bf16 v243, v201, s64, v243
    v_dot2_f32_bf16 v242, v202, s64, v242
    v_dot2_f32_bf16 v243, v203, s64, v243
    v_dot2_f32_bf16 v242, v204, s64, v242
    v_dot2_f32_bf16 v243, v205, s64, v243
    v_dot2_f32_bf16 v242, v206, s64, v242
    v_dot2_f32_bf16 v243, v207, s64, v243
    s_nop 2
    v_add_f32 v242, v242, v243
    s_nop 1
    v_add_f32_dpp v242, v242, v242 row_ror:8 row_mask:0xf bank_mask:0xf
    ds_bpermute_b32 v240, v244, v242
    s_waitcnt lgkmcnt(0)
    v_add_f32 v242, v242, v240
    ds_bpermute_b32 v240, v245, v242
    s_waitcnt lgkmcnt(0)
    v_add_f32 v242, v242, v240
    v_mul_f32 v4, 0x3ae38e39, v242
    v_lshlrev_b32 v240, 16, v172
    v_and_b32 v241, 0xffff0000, v172
    v_sub_f32 v240, v240, v4
    v_sub_f32 v241, v241, v4
    v_mul_f32 v242, v240, v240
    v_mul_f32 v243, v241, v241
    v_lshlrev_b32 v240, 16, v173
    v_and_b32 v241, 0xffff0000, v173
    v_sub_f32 v240, v240, v4
    v_sub_f32 v241, v241, v4
    v_fmac_f32 v242, v240, v240
    v_fmac_f32 v243, v241, v241
    v_lshlrev_b32 v240, 16, v174
    v_and_b32 v241, 0xffff0000, v174
    v_sub_f32 v240, v240, v4
    v_sub_f32 v241, v241, v4
    v_fmac_f32 v242, v240, v240
    v_fmac_f32 v243, v241, v241
    v_lshlrev_b32 v240, 16, v175
    v_and_b32 v241, 0xffff0000, v175
    v_sub_f32 v240, v240, v4
    v_sub_f32 v241, v241, v4
    v_fmac_f32 v242, v240, v240
    v_fmac_f32 v243, v241, v241
    v_lshlrev_b32 v240, 16, v176
    v_and_b32 v241, 0xffff0000, v176
    v_sub_f32 v240, v240, v4
    v_sub_f32 v241, v241, v4
    v_fmac_f32 v242, v240, v240
    v_fmac_f32 v243, v241, v241
    v_lshlrev_b32 v240, 16, v177
    v_and_b32 v241, 0xffff0000, v177
    v_sub_f32 v240, v240, v4
    v_sub_f32 v241, v241, v4
    v_fmac_f32 v242, v240, v240
    v_fmac_f32 v243, v241, v241
    v_lshlrev_b32 v240, 16, v178
    v_and_b32 v241, 0xffff0000, v178
    v_sub_f32 v240, v240, v4
    v_sub_f32 v241, v241, v4
    v_fmac_f32 v242, v240, v240
    v_fmac_f32 v243, v241, v241
    v_lshlrev_b32 v240, 16, v179
    v_and_b32 v241, 0xffff0000, v179
    v_sub_f32 v240, v240, v4
    v_sub_f32 v241, v241, v4
    v_fmac_f32 v242, v240, v240
    v_fmac_f32 v243, v241, v241
    v_lshlrev_b32 v240, 16, v180
    v_and_b32 v241, 0xffff0000, v180
    v_sub_f32 v240, v240, v4
    v_sub_f32 v241, v241, v4
    v_fmac_f32 v242, v240, v240
    v_fmac_f32 v243, v241, v241
    v_lshlrev_b32 v240, 16, v181
    v_and_b32 v241, 0xffff0000, v181
    v_sub_f32 v240, v240, v4
    v_sub_f32 v241, v241, v4
    v_fmac_f32 v242, v240, v240
    v_fmac_f32 v243, v241, v241
    v_lshlrev_b32 v240, 16, v182
    v_and_b32 v241, 0xffff0000, v182
    v_sub_f32 v240, v240, v4
    v_sub_f32 v241, v241, v4
    v_fmac_f32 v242, v240, v240
    v_fmac_f32 v243, v241, v241
    v_lshlrev_b32 v240, 16, v183
    v_and_b32 v241, 0xffff0000, v183
    v_sub_f32 v240, v240, v4
    v_sub_f32 v241, v241, v4
    v_fmac_f32 v242, v240, v240
    v_fmac_f32 v243, v241, v241
    v_lshlrev_b32 v240, 16, v184
    v_and_b32 v241, 0xffff0000, v184
    v_sub_f32 v240, v240, v4
    v_sub_f32 v241, v241, v4
    v_fmac_f32 v242, v240, v240
    v_fmac_f32 v243, v241, v241
    v_lshlrev_b32 v240, 16, v185
    v_and_b32 v241, 0xffff0000, v185
    v_sub_f32 v240, v240, v4
    v_sub_f32 v241, v241, v4
    v_fmac_f32 v242, v240, v240
    v_fmac_f32 v243, v241, v241
    v_lshlrev_b32 v240, 16, v186
    v_and_b32 v241, 0xffff0000, v186
    v_sub_f32 v240, v240, v4
    v_sub_f32 v241, v241, v4
    v_fmac_f32 v242, v240, v240
    v_fmac_f32 v243, v241, v241
    v_lshlrev_b32 v240, 16, v187
    v_and_b32 v241, 0xffff0000, v187
    v_sub_f32 v240, v240, v4
    v_sub_f32 v241, v241, v4
    v_fmac_f32 v242, v240, v240
    v_fmac_f32 v243, v241, v241
    v_lshlrev_b32 v240, 16, v188
    v_and_b32 v241, 0xffff0000, v188
    v_sub_f32 v240, v240, v4
    v_sub_f32 v241, v241, v4
    v_fmac_f32 v242, v240, v240
    v_fmac_f32 v243, v241, v241
    v_lshlrev_b32 v240, 16, v189
    v_and_b32 v241, 0xffff0000, v189
    v_sub_f32 v240, v240, v4
    v_sub_f32 v241, v241, v4
    v_fmac_f32 v242, v240, v240
    v_fmac_f32 v243, v241, v241
    v_lshlrev_b32 v240, 16, v190
    v_and_b32 v241, 0xffff0000, v190
    v_sub_f32 v240, v240, v4
    v_sub_f32 v241, v241, v4
    v_fmac_f32 v242, v240, v240
    v_fmac_f32 v243, v241, v241
    v_lshlrev_b32 v240, 16, v191
    v_and_b32 v241, 0xffff0000, v191
    v_sub_f32 v240, v240, v4
    v_sub_f32 v241, v241, v4
    v_fmac_f32 v242, v240, v240
    v_fmac_f32 v243, v241, v241
    v_lshlrev_b32 v240, 16, v192
    v_and_b32 v241, 0xffff0000, v192
    v_sub_f32 v240, v240, v4
    v_sub_f32 v241, v241, v4
    v_fmac_f32 v242, v240, v240
    v_fmac_f32 v243, v241, v241
    v_lshlrev_b32 v240, 16, v193
    v_and_b32 v241, 0xffff0000, v193
    v_sub_f32 v240, v240, v4
    v_sub_f32 v241, v241, v4
    v_fmac_f32 v242, v240, v240
    v_fmac_f32 v243, v241, v241
    v_lshlrev_b32 v240, 16, v194
    v_and_b32 v241, 0xffff0000, v194
    v_sub_f32 v240, v240, v4
    v_sub_f32 v241, v241, v4
    v_fmac_f32 v242, v240, v240
    v_fmac_f32 v243, v241, v241
    v_lshlrev_b32 v240, 16, v195
    v_and_b32 v241, 0xffff0000, v195
    v_sub_f32 v240, v240, v4
    v_sub_f32 v241, v241, v4
    v_fmac_f32 v242, v240, v240
    v_fmac_f32 v243, v241, v241
    v_lshlrev_b32 v240, 16, v196
    v_and_b32 v241, 0xffff0000, v196
    v_sub_f32 v240, v240, v4
    v_sub_f32 v241, v241, v4
    v_fmac_f32 v242, v240, v240
    v_fmac_f32 v243, v241, v241
    v_lshlrev_b32 v240, 16, v197
    v_and_b32 v241, 0xffff0000, v197
    v_sub_f32 v240, v240, v4
    v_sub_f32 v241, v241, v4
    v_fmac_f32 v242, v240, v240
    v_fmac_f32 v243, v241, v241
    v_lshlrev_b32 v240, 16, v198
    v_and_b32 v241, 0xffff0000, v198
    v_sub_f32 v240, v240, v4
    v_sub_f32 v241, v241, v4
    v_fmac_f32 v242, v240, v240
    v_fmac_f32 v243, v241, v241
    v_lshlrev_b32 v240, 16, v199
    v_and_b32 v241, 0xffff0000, v199
    v_sub_f32 v240, v240, v4
    v_sub_f32 v241, v241, v4
    v_fmac_f32 v242, v240, v240
    v_fmac_f32 v243, v241, v241
    v_lshlrev_b32 v240, 16, v200
    v_and_b32 v241, 0xffff0000, v200
    v_sub_f32 v240, v240, v4
    v_sub_f32 v241, v241, v4
    v_fmac_f32 v242, v240, v240
    v_fmac_f32 v243, v241, v241
    v_lshlrev_b32 v240, 16, v201
    v_and_b32 v241, 0xffff0000, v201
    v_sub_f32 v240, v240, v4
    v_sub_f32 v241, v241, v4
    v_fmac_f32 v242, v240, v240
    v_fmac_f32 v243, v241, v241
    v_lshlrev_b32 v240, 16, v202
    v_and_b32 v241, 0xffff0000, v202
    v_sub_f32 v240, v240, v4
    v_sub_f32 v241, v241, v4
    v_fmac_f32 v242, v240, v240
    v_fmac_f32 v243, v241, v241
    v_lshlrev_b32 v240, 16, v203
    v_and_b32 v241, 0xffff0000, v203
    v_sub_f32 v240, v240, v4
    v_sub_f32 v241, v241, v4
    v_fmac_f32 v242, v240, v240
    v_fmac_f32 v243, v241, v241
    v_lshlrev_b32 v240, 16, v204
    v_and_b32 v241, 0xffff0000, v204
    v_sub_f32 v240, v240, v4
    v_sub_f32 v241, v241, v4
    v_fmac_f32 v242, v240, v240
    v_fmac_f32 v243, v241, v241
    v_lshlrev_b32 v240, 16, v205
    v_and_b32 v241, 0xffff0000, v205
    v_sub_f32 v240, v240, v4
    v_sub_f32 v241, v241, v4
    v_fmac_f32 v242, v240, v240
    v_fmac_f32 v243, v241, v241
    v_lshlrev_b32 v240, 16, v206
    v_and_b32 v241, 0xffff0000, v206
    v_sub_f32 v240, v240, v4
    v_sub_f32 v241, v241, v4
    v_fmac_f32 v242, v240, v240
    v_fmac_f32 v243, v241, v241
    v_lshlrev_b32 v240, 16, v207
    v_and_b32 v241, 0xffff0000, v207
    v_sub_f32 v240, v240, v4
    v_sub_f32 v241, v241, v4
    v_fmac_f32 v242, v240, v240
    v_fmac_f32 v243, v241, v241
    v_add_f32 v242, v242, v243
    s_nop 1
    v_add_f32_dpp v242, v242, v242 row_ror:8 row_mask:0xf bank_mask:0xf
    ds_bpermute_b32 v240, v244, v242
    s_waitcnt lgkmcnt(0)
    v_add_f32 v242, v242, v240
    ds_bpermute_b32 v240, v245, v242
    s_waitcnt lgkmcnt(0)
    v_add_f32 v242, v242, v240
    v_mul_f32 v247, 0x3ae38e39, v242
    v_cvt_pk_bf16_f32 v4, v4, v4
    v_and_b32 v4, 0xffff0000, v4
    v_cvt_pk_bf16_f32 v247, v247, v247
    v_and_b32 v247, 0xffff0000, v247
    v_add_f32 v247, 0x3727c5ac, v247
    v_cvt_pk_bf16_f32 v247, v247, v247
    v_and_b32 v247, 0xffff0000, v247
    v_sqrt_f32 v5, v247
    s_nop 0
    v_cvt_pk_bf16_f32 v5, v5, v5
    v_and_b32 v5, 0xffff0000, v5
    v_rcp_f32 v6, v5
    v_lshlrev_b32 v240, 16, v172
    v_and_b32 v241, 0xffff0000, v172
    v_sub_f32 v240, v240, v4
    v_sub_f32 v241, v241, v4
    v_cvt_pk_bf16_f32 v241, v240, v241
    v_lshlrev_b32 v240, 16, v241
    v_and_b32 v241, 0xffff0000, v241
    v_mul_f32 v242, v240, v6
    v_mul_f32 v243, v241, v6
    v_fma_f32 v240, -v242, v5, v240
    v_fma_f32 v241, -v243, v5, v241
    v_fma_f32 v240, v240, v6, v242
    v_fma_f32 v241, v241, v6, v243
    v_cvt_pk_bf16_f32 v172, v240, v241
    v_lshlrev_b32 v240, 16, v173
    v_and_b32 v241, 0xffff0000, v173
    v_sub_f32 v240, v240, v4
    v_sub_f32 v241, v241, v4
    v_cvt_pk_bf16_f32 v241, v240, v241
    v_lshlrev_b32 v240, 16, v241
    v_and_b32 v241, 0xffff0000, v241
    v_mul_f32 v242, v240, v6
    v_mul_f32 v243, v241, v6
    v_fma_f32 v240, -v242, v5, v240
    v_fma_f32 v241, -v243, v5, v241
    v_fma_f32 v240, v240, v6, v242
    v_fma_f32 v241, v241, v6, v243
    v_cvt_pk_bf16_f32 v173, v240, v241
    v_lshlrev_b32 v240, 16, v174
    v_and_b32 v241, 0xffff0000, v174
    v_sub_f32 v240, v240, v4
    v_sub_f32 v241, v241, v4
    v_cvt_pk_bf16_f32 v241, v240, v241
    v_lshlrev_b32 v240, 16, v241
    v_and_b32 v241, 0xffff0000, v241
    v_mul_f32 v242, v240, v6
    v_mul_f32 v243, v241, v6
    v_fma_f32 v240, -v242, v5, v240
    v_fma_f32 v241, -v243, v5, v241
    v_fma_f32 v240, v240, v6, v242
    v_fma_f32 v241, v241, v6, v243
    v_cvt_pk_bf16_f32 v174, v240, v241
    v_lshlrev_b32 v240, 16, v175
    v_and_b32 v241, 0xffff0000, v175
    v_sub_f32 v240, v240, v4
    v_sub_f32 v241, v241, v4
    v_cvt_pk_bf16_f32 v241, v240, v241
    v_lshlrev_b32 v240, 16, v241
    v_and_b32 v241, 0xffff0000, v241
    v_mul_f32 v242, v240, v6
    v_mul_f32 v243, v241, v6
    v_fma_f32 v240, -v242, v5, v240
    v_fma_f32 v241, -v243, v5, v241
    v_fma_f32 v240, v240, v6, v242
    v_fma_f32 v241, v241, v6, v243
    v_cvt_pk_bf16_f32 v175, v240, v241
    v_lshlrev_b32 v240, 16, v176
    v_and_b32 v241, 0xffff0000, v176
    v_sub_f32 v240, v240, v4
    v_sub_f32 v241, v241, v4
    v_cvt_pk_bf16_f32 v241, v240, v241
    v_lshlrev_b32 v240, 16, v241
    v_and_b32 v241, 0xffff0000, v241
    v_mul_f32 v242, v240, v6
    v_mul_f32 v243, v241, v6
    v_fma_f32 v240, -v242, v5, v240
    v_fma_f32 v241, -v243, v5, v241
    v_fma_f32 v240, v240, v6, v242
    v_fma_f32 v241, v241, v6, v243
    v_cvt_pk_bf16_f32 v176, v240, v241
    v_lshlrev_b32 v240, 16, v177
    v_and_b32 v241, 0xffff0000, v177
    v_sub_f32 v240, v240, v4
    v_sub_f32 v241, v241, v4
    v_cvt_pk_bf16_f32 v241, v240, v241
    v_lshlrev_b32 v240, 16, v241
    v_and_b32 v241, 0xffff0000, v241
    v_mul_f32 v242, v240, v6
    v_mul_f32 v243, v241, v6
    v_fma_f32 v240, -v242, v5, v240
    v_fma_f32 v241, -v243, v5, v241
    v_fma_f32 v240, v240, v6, v242
    v_fma_f32 v241, v241, v6, v243
    v_cvt_pk_bf16_f32 v177, v240, v241
    v_lshlrev_b32 v240, 16, v178
    v_and_b32 v241, 0xffff0000, v178
    v_sub_f32 v240, v240, v4
    v_sub_f32 v241, v241, v4
    v_cvt_pk_bf16_f32 v241, v240, v241
    v_lshlrev_b32 v240, 16, v241
    v_and_b32 v241, 0xffff0000, v241
    v_mul_f32 v242, v240, v6
    v_mul_f32 v243, v241, v6
    v_fma_f32 v240, -v242, v5, v240
    v_fma_f32 v241, -v243, v5, v241
    v_fma_f32 v240, v240, v6, v242
    v_fma_f32 v241, v241, v6, v243
    v_cvt_pk_bf16_f32 v178, v240, v241
    v_lshlrev_b32 v240, 16, v179
    v_and_b32 v241, 0xffff0000, v179
    v_sub_f32 v240, v240, v4
    v_sub_f32 v241, v241, v4
    v_cvt_pk_bf16_f32 v241, v240, v241
    v_lshlrev_b32 v240, 16, v241
    v_and_b32 v241, 0xffff0000, v241
    v_mul_f32 v242, v240, v6
    v_mul_f32 v243, v241, v6
    v_fma_f32 v240, -v242, v5, v240
    v_fma_f32 v241, -v243, v5, v241
    v_fma_f32 v240, v240, v6, v242
    v_fma_f32 v241, v241, v6, v243
    v_cvt_pk_bf16_f32 v179, v240, v241
    v_lshlrev_b32 v240, 16, v180
    v_and_b32 v241, 0xffff0000, v180
    v_sub_f32 v240, v240, v4
    v_sub_f32 v241, v241, v4
    v_cvt_pk_bf16_f32 v241, v240, v241
    v_lshlrev_b32 v240, 16, v241
    v_and_b32 v241, 0xffff0000, v241
    v_mul_f32 v242, v240, v6
    v_mul_f32 v243, v241, v6
    v_fma_f32 v240, -v242, v5, v240
    v_fma_f32 v241, -v243, v5, v241
    v_fma_f32 v240, v240, v6, v242
    v_fma_f32 v241, v241, v6, v243
    v_cvt_pk_bf16_f32 v180, v240, v241
    v_lshlrev_b32 v240, 16, v181
    v_and_b32 v241, 0xffff0000, v181
    v_sub_f32 v240, v240, v4
    v_sub_f32 v241, v241, v4
    v_cvt_pk_bf16_f32 v241, v240, v241
    v_lshlrev_b32 v240, 16, v241
    v_and_b32 v241, 0xffff0000, v241
    v_mul_f32 v242, v240, v6
    v_mul_f32 v243, v241, v6
    v_fma_f32 v240, -v242, v5, v240
    v_fma_f32 v241, -v243, v5, v241
    v_fma_f32 v240, v240, v6, v242
    v_fma_f32 v241, v241, v6, v243
    v_cvt_pk_bf16_f32 v181, v240, v241
    v_lshlrev_b32 v240, 16, v182
    v_and_b32 v241, 0xffff0000, v182
    v_sub_f32 v240, v240, v4
    v_sub_f32 v241, v241, v4
    v_cvt_pk_bf16_f32 v241, v240, v241
    v_lshlrev_b32 v240, 16, v241
    v_and_b32 v241, 0xffff0000, v241
    v_mul_f32 v242, v240, v6
    v_mul_f32 v243, v241, v6
    v_fma_f32 v240, -v242, v5, v240
    v_fma_f32 v241, -v243, v5, v241
    v_fma_f32 v240, v240, v6, v242
    v_fma_f32 v241, v241, v6, v243
    v_cvt_pk_bf16_f32 v182, v240, v241
    v_lshlrev_b32 v240, 16, v183
    v_and_b32 v241, 0xffff0000, v183
    v_sub_f32 v240, v240, v4
    v_sub_f32 v241, v241, v4
    v_cvt_pk_bf16_f32 v241, v240, v241
    v_lshlrev_b32 v240, 16, v241
    v_and_b32 v241, 0xffff0000, v241
    v_mul_f32 v242, v240, v6
    v_mul_f32 v243, v241, v6
    v_fma_f32 v240, -v242, v5, v240
    v_fma_f32 v241, -v243, v5, v241
    v_fma_f32 v240, v240, v6, v242
    v_fma_f32 v241, v241, v6, v243
    v_cvt_pk_bf16_f32 v183, v240, v241
    v_lshlrev_b32 v240, 16, v184
    v_and_b32 v241, 0xffff0000, v184
    v_sub_f32 v240, v240, v4
    v_sub_f32 v241, v241, v4
    v_cvt_pk_bf16_f32 v241, v240, v241
    v_lshlrev_b32 v240, 16, v241
    v_and_b32 v241, 0xffff0000, v241
    v_mul_f32 v242, v240, v6
    v_mul_f32 v243, v241, v6
    v_fma_f32 v240, -v242, v5, v240
    v_fma_f32 v241, -v243, v5, v241
    v_fma_f32 v240, v240, v6, v242
    v_fma_f32 v241, v241, v6, v243
    v_cvt_pk_bf16_f32 v184, v240, v241
    v_lshlrev_b32 v240, 16, v185
    v_and_b32 v241, 0xffff0000, v185
    v_sub_f32 v240, v240, v4
    v_sub_f32 v241, v241, v4
    v_cvt_pk_bf16_f32 v241, v240, v241
    v_lshlrev_b32 v240, 16, v241
    v_and_b32 v241, 0xffff0000, v241
    v_mul_f32 v242, v240, v6
    v_mul_f32 v243, v241, v6
    v_fma_f32 v240, -v242, v5, v240
    v_fma_f32 v241, -v243, v5, v241
    v_fma_f32 v240, v240, v6, v242
    v_fma_f32 v241, v241, v6, v243
    v_cvt_pk_bf16_f32 v185, v240, v241
    v_lshlrev_b32 v240, 16, v186
    v_and_b32 v241, 0xffff0000, v186
    v_sub_f32 v240, v240, v4
    v_sub_f32 v241, v241, v4
    v_cvt_pk_bf16_f32 v241, v240, v241
    v_lshlrev_b32 v240, 16, v241
    v_and_b32 v241, 0xffff0000, v241
    v_mul_f32 v242, v240, v6
    v_mul_f32 v243, v241, v6
    v_fma_f32 v240, -v242, v5, v240
    v_fma_f32 v241, -v243, v5, v241
    v_fma_f32 v240, v240, v6, v242
    v_fma_f32 v241, v241, v6, v243
    v_cvt_pk_bf16_f32 v186, v240, v241
    v_lshlrev_b32 v240, 16, v187
    v_and_b32 v241, 0xffff0000, v187
    v_sub_f32 v240, v240, v4
    v_sub_f32 v241, v241, v4
    v_cvt_pk_bf16_f32 v241, v240, v241
    v_lshlrev_b32 v240, 16, v241
    v_and_b32 v241, 0xffff0000, v241
    v_mul_f32 v242, v240, v6
    v_mul_f32 v243, v241, v6
    v_fma_f32 v240, -v242, v5, v240
    v_fma_f32 v241, -v243, v5, v241
    v_fma_f32 v240, v240, v6, v242
    v_fma_f32 v241, v241, v6, v243
    v_cvt_pk_bf16_f32 v187, v240, v241
    v_lshlrev_b32 v240, 16, v188
    v_and_b32 v241, 0xffff0000, v188
    v_sub_f32 v240, v240, v4
    v_sub_f32 v241, v241, v4
    v_cvt_pk_bf16_f32 v241, v240, v241
    v_lshlrev_b32 v240, 16, v241
    v_and_b32 v241, 0xffff0000, v241
    v_mul_f32 v242, v240, v6
    v_mul_f32 v243, v241, v6
    v_fma_f32 v240, -v242, v5, v240
    v_fma_f32 v241, -v243, v5, v241
    v_fma_f32 v240, v240, v6, v242
    v_fma_f32 v241, v241, v6, v243
    v_cvt_pk_bf16_f32 v188, v240, v241
    v_lshlrev_b32 v240, 16, v189
    v_and_b32 v241, 0xffff0000, v189
    v_sub_f32 v240, v240, v4
    v_sub_f32 v241, v241, v4
    v_cvt_pk_bf16_f32 v241, v240, v241
    v_lshlrev_b32 v240, 16, v241
    v_and_b32 v241, 0xffff0000, v241
    v_mul_f32 v242, v240, v6
    v_mul_f32 v243, v241, v6
    v_fma_f32 v240, -v242, v5, v240
    v_fma_f32 v241, -v243, v5, v241
    v_fma_f32 v240, v240, v6, v242
    v_fma_f32 v241, v241, v6, v243
    v_cvt_pk_bf16_f32 v189, v240, v241
    v_lshlrev_b32 v240, 16, v190
    v_and_b32 v241, 0xffff0000, v190
    v_sub_f32 v240, v240, v4
    v_sub_f32 v241, v241, v4
    v_cvt_pk_bf16_f32 v241, v240, v241
    v_lshlrev_b32 v240, 16, v241
    v_and_b32 v241, 0xffff0000, v241
    v_mul_f32 v242, v240, v6
    v_mul_f32 v243, v241, v6
    v_fma_f32 v240, -v242, v5, v240
    v_fma_f32 v241, -v243, v5, v241
    v_fma_f32 v240, v240, v6, v242
    v_fma_f32 v241, v241, v6, v243
    v_cvt_pk_bf16_f32 v190, v240, v241
    v_lshlrev_b32 v240, 16, v191
    v_and_b32 v241, 0xffff0000, v191
    v_sub_f32 v240, v240, v4
    v_sub_f32 v241, v241, v4
    v_cvt_pk_bf16_f32 v241, v240, v241
    v_lshlrev_b32 v240, 16, v241
    v_and_b32 v241, 0xffff0000, v241
    v_mul_f32 v242, v240, v6
    v_mul_f32 v243, v241, v6
    v_fma_f32 v240, -v242, v5, v240
    v_fma_f32 v241, -v243, v5, v241
    v_fma_f32 v240, v240, v6, v242
    v_fma_f32 v241, v241, v6, v243
    v_cvt_pk_bf16_f32 v191, v240, v241
    v_lshlrev_b32 v240, 16, v192
    v_and_b32 v241, 0xffff0000, v192
    v_sub_f32 v240, v240, v4
    v_sub_f32 v241, v241, v4
    v_cvt_pk_bf16_f32 v241, v240, v241
    v_lshlrev_b32 v240, 16, v241
    v_and_b32 v241, 0xffff0000, v241
    v_mul_f32 v242, v240, v6
    v_mul_f32 v243, v241, v6
    v_fma_f32 v240, -v242, v5, v240
    v_fma_f32 v241, -v243, v5, v241
    v_fma_f32 v240, v240, v6, v242
    v_fma_f32 v241, v241, v6, v243
    v_cvt_pk_bf16_f32 v192, v240, v241
    v_lshlrev_b32 v240, 16, v193
    v_and_b32 v241, 0xffff0000, v193
    v_sub_f32 v240, v240, v4
    v_sub_f32 v241, v241, v4
    v_cvt_pk_bf16_f32 v241, v240, v241
    v_lshlrev_b32 v240, 16, v241
    v_and_b32 v241, 0xffff0000, v241
    v_mul_f32 v242, v240, v6
    v_mul_f32 v243, v241, v6
    v_fma_f32 v240, -v242, v5, v240
    v_fma_f32 v241, -v243, v5, v241
    v_fma_f32 v240, v240, v6, v242
    v_fma_f32 v241, v241, v6, v243
    v_cvt_pk_bf16_f32 v193, v240, v241
    v_lshlrev_b32 v240, 16, v194
    v_and_b32 v241, 0xffff0000, v194
    v_sub_f32 v240, v240, v4
    v_sub_f32 v241, v241, v4
    v_cvt_pk_bf16_f32 v241, v240, v241
    v_lshlrev_b32 v240, 16, v241
    v_and_b32 v241, 0xffff0000, v241
    v_mul_f32 v242, v240, v6
    v_mul_f32 v243, v241, v6
    v_fma_f32 v240, -v242, v5, v240
    v_fma_f32 v241, -v243, v5, v241
    v_fma_f32 v240, v240, v6, v242
    v_fma_f32 v241, v241, v6, v243
    v_cvt_pk_bf16_f32 v194, v240, v241
    v_lshlrev_b32 v240, 16, v195
    v_and_b32 v241, 0xffff0000, v195
    v_sub_f32 v240, v240, v4
    v_sub_f32 v241, v241, v4
    v_cvt_pk_bf16_f32 v241, v240, v241
    v_lshlrev_b32 v240, 16, v241
    v_and_b32 v241, 0xffff0000, v241
    v_mul_f32 v242, v240, v6
    v_mul_f32 v243, v241, v6
    v_fma_f32 v240, -v242, v5, v240
    v_fma_f32 v241, -v243, v5, v241
    v_fma_f32 v240, v240, v6, v242
    v_fma_f32 v241, v241, v6, v243
    v_cvt_pk_bf16_f32 v195, v240, v241
    v_lshlrev_b32 v240, 16, v196
    v_and_b32 v241, 0xffff0000, v196
    v_sub_f32 v240, v240, v4
    v_sub_f32 v241, v241, v4
    v_cvt_pk_bf16_f32 v241, v240, v241
    v_lshlrev_b32 v240, 16, v241
    v_and_b32 v241, 0xffff0000, v241
    v_mul_f32 v242, v240, v6
    v_mul_f32 v243, v241, v6
    v_fma_f32 v240, -v242, v5, v240
    v_fma_f32 v241, -v243, v5, v241
    v_fma_f32 v240, v240, v6, v242
    v_fma_f32 v241, v241, v6, v243
    v_cvt_pk_bf16_f32 v196, v240, v241
    v_lshlrev_b32 v240, 16, v197
    v_and_b32 v241, 0xffff0000, v197
    v_sub_f32 v240, v240, v4
    v_sub_f32 v241, v241, v4
    v_cvt_pk_bf16_f32 v241, v240, v241
    v_lshlrev_b32 v240, 16, v241
    v_and_b32 v241, 0xffff0000, v241
    v_mul_f32 v242, v240, v6
    v_mul_f32 v243, v241, v6
    v_fma_f32 v240, -v242, v5, v240
    v_fma_f32 v241, -v243, v5, v241
    v_fma_f32 v240, v240, v6, v242
    v_fma_f32 v241, v241, v6, v243
    v_cvt_pk_bf16_f32 v197, v240, v241
    v_lshlrev_b32 v240, 16, v198
    v_and_b32 v241, 0xffff0000, v198
    v_sub_f32 v240, v240, v4
    v_sub_f32 v241, v241, v4
    v_cvt_pk_bf16_f32 v241, v240, v241
    v_lshlrev_b32 v240, 16, v241
    v_and_b32 v241, 0xffff0000, v241
    v_mul_f32 v242, v240, v6
    v_mul_f32 v243, v241, v6
    v_fma_f32 v240, -v242, v5, v240
    v_fma_f32 v241, -v243, v5, v241
    v_fma_f32 v240, v240, v6, v242
    v_fma_f32 v241, v241, v6, v243
    v_cvt_pk_bf16_f32 v198, v240, v241
    v_lshlrev_b32 v240, 16, v199
    v_and_b32 v241, 0xffff0000, v199
    v_sub_f32 v240, v240, v4
    v_sub_f32 v241, v241, v4
    v_cvt_pk_bf16_f32 v241, v240, v241
    v_lshlrev_b32 v240, 16, v241
    v_and_b32 v241, 0xffff0000, v241
    v_mul_f32 v242, v240, v6
    v_mul_f32 v243, v241, v6
    v_fma_f32 v240, -v242, v5, v240
    v_fma_f32 v241, -v243, v5, v241
    v_fma_f32 v240, v240, v6, v242
    v_fma_f32 v241, v241, v6, v243
    v_cvt_pk_bf16_f32 v199, v240, v241
    v_lshlrev_b32 v240, 16, v200
    v_and_b32 v241, 0xffff0000, v200
    v_sub_f32 v240, v240, v4
    v_sub_f32 v241, v241, v4
    v_cvt_pk_bf16_f32 v241, v240, v241
    v_lshlrev_b32 v240, 16, v241
    v_and_b32 v241, 0xffff0000, v241
    v_mul_f32 v242, v240, v6
    v_mul_f32 v243, v241, v6
    v_fma_f32 v240, -v242, v5, v240
    v_fma_f32 v241, -v243, v5, v241
    v_fma_f32 v240, v240, v6, v242
    v_fma_f32 v241, v241, v6, v243
    v_cvt_pk_bf16_f32 v200, v240, v241
    v_lshlrev_b32 v240, 16, v201
    v_and_b32 v241, 0xffff0000, v201
    v_sub_f32 v240, v240, v4
    v_sub_f32 v241, v241, v4
    v_cvt_pk_bf16_f32 v241, v240, v241
    v_lshlrev_b32 v240, 16, v241
    v_and_b32 v241, 0xffff0000, v241
    v_mul_f32 v242, v240, v6
    v_mul_f32 v243, v241, v6
    v_fma_f32 v240, -v242, v5, v240
    v_fma_f32 v241, -v243, v5, v241
    v_fma_f32 v240, v240, v6, v242
    v_fma_f32 v241, v241, v6, v243
    v_cvt_pk_bf16_f32 v201, v240, v241
    v_lshlrev_b32 v240, 16, v202
    v_and_b32 v241, 0xffff0000, v202
    v_sub_f32 v240, v240, v4
    v_sub_f32 v241, v241, v4
    v_cvt_pk_bf16_f32 v241, v240, v241
    v_lshlrev_b32 v240, 16, v241
    v_and_b32 v241, 0xffff0000, v241
    v_mul_f32 v242, v240, v6
    v_mul_f32 v243, v241, v6
    v_fma_f32 v240, -v242, v5, v240
    v_fma_f32 v241, -v243, v5, v241
    v_fma_f32 v240, v240, v6, v242
    v_fma_f32 v241, v241, v6, v243
    v_cvt_pk_bf16_f32 v202, v240, v241
    v_lshlrev_b32 v240, 16, v203
    v_and_b32 v241, 0xffff0000, v203
    v_sub_f32 v240, v240, v4
    v_sub_f32 v241, v241, v4
    v_cvt_pk_bf16_f32 v241, v240, v241
    v_lshlrev_b32 v240, 16, v241
    v_and_b32 v241, 0xffff0000, v241
    v_mul_f32 v242, v240, v6
    v_mul_f32 v243, v241, v6
    v_fma_f32 v240, -v242, v5, v240
    v_fma_f32 v241, -v243, v5, v241
    v_fma_f32 v240, v240, v6, v242
    v_fma_f32 v241, v241, v6, v243
    v_cvt_pk_bf16_f32 v203, v240, v241
    v_lshlrev_b32 v240, 16, v204
    v_and_b32 v241, 0xffff0000, v204
    v_sub_f32 v240, v240, v4
    v_sub_f32 v241, v241, v4
    v_cvt_pk_bf16_f32 v241, v240, v241
    v_lshlrev_b32 v240, 16, v241
    v_and_b32 v241, 0xffff0000, v241
    v_mul_f32 v242, v240, v6
    v_mul_f32 v243, v241, v6
    v_fma_f32 v240, -v242, v5, v240
    v_fma_f32 v241, -v243, v5, v241
    v_fma_f32 v240, v240, v6, v242
    v_fma_f32 v241, v241, v6, v243
    v_cvt_pk_bf16_f32 v204, v240, v241
    v_lshlrev_b32 v240, 16, v205
    v_and_b32 v241, 0xffff0000, v205
    v_sub_f32 v240, v240, v4
    v_sub_f32 v241, v241, v4
    v_cvt_pk_bf16_f32 v241, v240, v241
    v_lshlrev_b32 v240, 16, v241
    v_and_b32 v241, 0xffff0000, v241
    v_mul_f32 v242, v240, v6
    v_mul_f32 v243, v241, v6
    v_fma_f32 v240, -v242, v5, v240
    v_fma_f32 v241, -v243, v5, v241
    v_fma_f32 v240, v240, v6, v242
    v_fma_f32 v241, v241, v6, v243
    v_cvt_pk_bf16_f32 v205, v240, v241
    v_lshlrev_b32 v240, 16, v206
    v_and_b32 v241, 0xffff0000, v206
    v_sub_f32 v240, v240, v4
    v_sub_f32 v241, v241, v4
    v_cvt_pk_bf16_f32 v241, v240, v241
    v_lshlrev_b32 v240, 16, v241
    v_and_b32 v241, 0xffff0000, v241
    v_mul_f32 v242, v240, v6
    v_mul_f32 v243, v241, v6
    v_fma_f32 v240, -v242, v5, v240
    v_fma_f32 v241, -v243, v5, v241
    v_fma_f32 v240, v240, v6, v242
    v_fma_f32 v241, v241, v6, v243
    v_cvt_pk_bf16_f32 v206, v240, v241
    v_lshlrev_b32 v240, 16, v207
    v_and_b32 v241, 0xffff0000, v207
    v_sub_f32 v240, v240, v4
    v_sub_f32 v241, v241, v4
    v_cvt_pk_bf16_f32 v241, v240, v241
    v_lshlrev_b32 v240, 16, v241
    v_and_b32 v241, 0xffff0000, v241
    v_mul_f32 v242, v240, v6
    v_mul_f32 v243, v241, v6
    v_fma_f32 v240, -v242, v5, v240
    v_fma_f32 v241, -v243, v5, v241
    v_fma_f32 v240, v240, v6, v242
    v_fma_f32 v241, v241, v6, v243
    v_cvt_pk_bf16_f32 v207, v240, v241
    s_waitcnt vmcnt(0)
    v_add_u32 v126, 1, v126
    v_xor_b32 v127, 0x9e3779b9, v126
    v_lshlrev_b32 v9, 9, v3
    v_lshl_add_u32 v9, v2, 4, v9
    s_lshl_b32 s64, s30, 12
    s_add_u32 s64, s64, 524288
    s_lshl_b32 s65, s29, 6
    s_add_u32 s66, s64, s65
    s_lshl_b32 s65, s29, 9
    s_add_u32 s65, s64, s65
    v_lshlrev_b32 v11, 4, v1
    v_lshlrev_b32 v10, 3, v1
    v_add_u32 v10, 154176, v10
    s_waitcnt vmcnt(0)
    ds_read_b64_tr_b16 v[12:13], v129 offset:0
    ds_read_b64_tr_b16 v[14:15], v129 offset:128
    ds_read_b64_tr_b16 v[16:17], v129 offset:1024
    ds_read_b64_tr_b16 v[18:19], v129 offset:1152
    ds_read_b64_tr_b16 v[20:21], v129 offset:2048
    ds_read_b64_tr_b16 v[22:23], v129 offset:2176
    ds_read_b64_tr_b16 v[24:25], v129 offset:3072
    ds_read_b64_tr_b16 v[26:27], v129 offset:3200
    ds_read_b64_tr_b16 v[28:29], v129 offset:4096
    ds_read_b64_tr_b16 v[30:31], v129 offset:4224
    ds_read_b64_tr_b16 v[32:33], v129 offset:5120
    ds_read_b64_tr_b16 v[34:35], v129 offset:5248
    ds_read_b64_tr_b16 v[36:37], v129 offset:6144
    ds_read_b64_tr_b16 v[38:39], v129 offset:6272
    ds_read_b64_tr_b16 v[40:41], v129 offset:7168
    ds_read_b64_tr_b16 v[42:43], v129 offset:7296
    ds_read_b64_tr_b16 v[44:45], v129 offset:8192
    ds_read_b64_tr_b16 v[46:47], v129 offset:8320
    s_waitcnt lgkmcnt(0)
    v_mfma_f32_16x16x32_bf16 v[208:211], v[12:15], v[172:175], 0
    v_mfma_f32_16x16x32_bf16 v[212:215], v[16:19], v[172:175], 0
    v_mfma_f32_16x16x32_bf16 v[208:211], v[20:23], v[176:179], v[208:211]
    v_mfma_f32_16x16x32_bf16 v[212:215], v[24:27], v[176:179], v[212:215]
    v_mfma_f32_16x16x32_bf16 v[208:211], v[28:31], v[180:183], v[208:211]
    v_mfma_f32_16x16x32_bf16 v[212:215], v[32:35], v[180:183], v[212:215]
    v_mfma_f32_16x16x32_bf16 v[208:211], v[36:39], v[184:187], v[208:211]
    v_mfma_f32_16x16x32_bf16 v[212:215], v[40:43], v[184:187], v[212:215]
    v_mfma_f32_16x16x32_bf16 v[208:211], v[44:47], v[188:191], v[208:211]
    ds_read_b64_tr_b16 v[12:13], v129 offset:9216
    ds_read_b64_tr_b16 v[14:15], v129 offset:9344
    ds_read_b64_tr_b16 v[16:17], v129 offset:10240
    ds_read_b64_tr_b16 v[18:19], v129 offset:10368
    ds_read_b64_tr_b16 v[20:21], v129 offset:11264
    ds_read_b64_tr_b16 v[22:23], v129 offset:11392
    ds_read_b64_tr_b16 v[24:25], v129 offset:12288
    ds_read_b64_tr_b16 v[26:27], v129 offset:12416
    ds_read_b64_tr_b16 v[28:29], v129 offset:13312
    ds_read_b64_tr_b16 v[30:31], v129 offset:13440
    ds_read_b64_tr_b16 v[32:33], v129 offset:14336
    ds_read_b64_tr_b16 v[34:35], v129 offset:14464
    ds_read_b64_tr_b16 v[36:37], v129 offset:15360
    ds_read_b64_tr_b16 v[38:39], v129 offset:15488
    ds_read_b64_tr_b16 v[40:41], v129 offset:16384
    ds_read_b64_tr_b16 v[42:43], v129 offset:16512
    ds_read_b64_tr_b16 v[44:45], v129 offset:17408
    ds_read_b64_tr_b16 v[46:47], v129 offset:17536
    s_waitcnt lgkmcnt(0)
    v_mfma_f32_16x16x32_bf16 v[212:215], v[12:15], v[188:191], v[212:215]
    v_mfma_f32_16x16x32_bf16 v[208:211], v[16:19], v[192:195], v[208:211]
    v_mfma_f32_16x16x32_bf16 v[212:215], v[20:23], v[192:195], v[212:215]
    v_mfma_f32_16x16x32_bf16 v[208:211], v[24:27], v[196:199], v[208:211]
    v_mfma_f32_16x16x32_bf16 v[212:215], v[28:31], v[196:199], v[212:215]
    v_mfma_f32_16x16x32_bf16 v[208:211], v[32:35], v[200:203], v[208:211]
    v_mfma_f32_16x16x32_bf16 v[212:215], v[36:39], v[200:203], v[212:215]
    v_mfma_f32_16x16x32_bf16 v[208:211], v[40:43], v[204:207], v[208:211]
    v_mfma_f32_16x16x32_bf16 v[212:215], v[44:47], v[204:207], v[212:215]
    s_nop 7
    v_add_f32_dpp v208, v212, v208 row_ror:8 row_mask:0xf bank_mask:0xf
    v_add_f32_dpp v209, v213, v209 row_ror:8 row_mask:0xf bank_mask:0xf
    v_add_f32_dpp v210, v214, v210 row_ror:8 row_mask:0xf bank_mask:0xf
    v_add_f32_dpp v211, v215, v211 row_ror:8 row_mask:0xf bank_mask:0xf
    v_cvt_pk_bf16_f32 v124, v208, v209
    v_cvt_pk_bf16_f32 v125, v210, v211
    s_mov_b32 exec_lo, 0xff00ff
    s_mov_b32 exec_hi, 0xff00ff
    buffer_store_dwordx4 v[124:127], v9, s[52:55], s66 offen
    s_mov_b32 exec_lo, 0xffffffff
    s_mov_b32 exec_hi, 0x0
    s_mov_b32 s68, 300
L_h_qpoll:
    buffer_load_dwordx4 v[12:15], v11, s[52:55], s65 offen sc1
    s_sub_u32 s68, s68, 1
    s_waitcnt vmcnt(0)
    v_cmp_ne_u32 vcc, v14, v126
    v_cmp_ne_u32 s[82:83], v15, v127
    s_nop 0
    s_or_b64 vcc, vcc, s[82:83]
    s_nop 2
    s_cbranch_vccz L_h_qok
    s_cmp_gt_i32 s68, 0
    s_cbranch_scc1 L_h_qpoll
    s_mov_b64 exec, -1
    s_mov_b32 s67, 0
    v_lshlrev_b32 v10, 3, v2
    v_add_u32 v10, 154176, v10
    v_cmp_eq_u32 s[82:83], s29, v3
    s_nop 4
L_h_qfb:
    s_mov_b32 m0, 0
    s_add_u32 s66, s67, 0
    buffer_load_dwordx4 v128, s[44:47], s66 offen lds
    s_mov_b32 m0, 1024
    s_add_u32 s66, s67, 262144
    buffer_load_dwordx4 v128, s[44:47], s66 offen lds
    s_mov_b32 m0, 2048
    s_add_u32 s66, s67, 524288
    buffer_load_dwordx4 v128, s[44:47], s66 offen lds
    s_mov_b32 m0, 3072
    s_add_u32 s66, s67, 786432
    buffer_load_dwordx4 v128, s[44:47], s66 offen lds
    s_mov_b32 m0, 4096
    s_add_u32 s66, s67, 1048576
    buffer_load_dwordx4 v128, s[44:47], s66 offen lds
    s_mov_b32 m0, 5120
    s_add_u32 s66, s67, 1310720
    buffer_load_dwordx4 v128, s[44:47], s66 offen lds
    s_mov_b32 m0, 6144
    s_add_u32 s66, s67, 1572864
    buffer_load_dwordx4 v128, s[44:47], s66 offen lds
    s_mov_b32 m0, 7168
    s_add_u32 s66, s67, 1835008
    buffer_load_dwordx4 v128, s[44:47], s66 offen lds
    s_mov_b32 m0, 8192
    s_add_u32 s66, s67, 2097152
    buffer_load_dwordx4 v128, s[44:47], s66 offen lds
    s_mov_b32 m0, 9216
    s_add_u32 s66, s67, 2359296
    buffer_load_dwordx4 v128, s[44:47], s66 offen lds
    s_mov_b32 m0, 10240
    s_add_u32 s66, s67, 2621440
    buffer_load_dwordx4 v128, s[44:47], s66 offen lds
    s_mov_b32 m0, 11264
    s_add_u32 s66, s67, 2883584
    buffer_load_dwordx4 v128, s[44:47], s66 offen lds
    s_mov_b32 m0, 12288
    s_add_u32 s66, s67, 3145728
    buffer_load_dwordx4 v128, s[44:47], s66 offen lds
    s_mov_b32 m0, 13312
    s_add_u32 s66, s67, 3407872
    buffer_load_dwordx4 v128, s[44:47], s66 offen lds
    s_mov_b32 m0, 14336
    s_add_u32 s66, s67, 3670016
    buffer_load_dwordx4 v128, s[44:47], s66 offen lds
    s_mov_b32 m0, 15360
    s_add_u32 s66, s67, 3932160
    buffer_load_dwordx4 v128, s[44:47], s66 offen lds
    s_mov_b32 m0, 16384
    s_add_u32 s66, s67, 4194304
    buffer_load_dwordx4 v128, s[44:47], s66 offen lds
    s_mov_b32 m0, 17408
    s_add_u32 s66, s67, 4456448
    buffer_load_dwordx4 v128, s[44:47], s66 offen lds
    s_waitcnt vmcnt(0)
    ds_read_b64_tr_b16 v[12:13], v129 offset:0
    ds_read_b64_tr_b16 v[14:15], v129 offset:128
    ds_read_b64_tr_b16 v[16:17], v129 offset:1024
    ds_read_b64_tr_b16 v[18:19], v129 offset:1152
    ds_read_b64_tr_b16 v[20:21], v129 offset:2048
    ds_read_b64_tr_b16 v[22:23], v129 offset:2176
    ds_read_b64_tr_b16 v[24:25], v129 offset:3072
    ds_read_b64_tr_b16 v[26:27], v129 offset:3200
    ds_read_b64_tr_b16 v[28:29], v129 offset:4096
    ds_read_b64_tr_b16 v[30:31], v129 offset:4224
    ds_read_b64_tr_b16 v[32:33], v129 offset:5120
    ds_read_b64_tr_b16 v[34:35], v129 offset:5248
    ds_read_b64_tr_b16 v[36:37], v129 offset:6144
    ds_read_b64_tr_b16 v[38:39], v129 offset:6272
    ds_read_b64_tr_b16 v[40:41], v129 offset:7168
    ds_read_b64_tr_b16 v[42:43], v129 offset:7296
    ds_read_b64_tr_b16 v[44:45], v129 offset:8192
    ds_read_b64_tr_b16 v[46:47], v129 offset:8320
    s_waitcnt lgkmcnt(0)
    v_mfma_f32_16x16x32_bf16 v[208:211], v[12:15], v[172:175], 0
    v_mfma_f32_16x16x32_bf16 v[212:215], v[16:19], v[172:175], 0
    v_mfma_f32_16x16x32_bf16 v[208:211], v[20:23], v[176:179], v[208:211]
    v_mfma_f32_16x16x32_bf16 v[212:215], v[24:27], v[176:179], v[212:215]
    v_mfma_f32_16x16x32_bf16 v[208:211], v[28:31], v[180:183], v[208:211]
    v_mfma_f32_16x16x32_bf16 v[212:215], v[32:35], v[180:183], v[212:215]
    v_mfma_f32_16x16x32_bf16 v[208:211], v[36:39], v[184:187], v[208:211]
    v_mfma_f32_16x16x32_bf16 v[212:215], v[40:43], v[184:187], v[212:215]
    v_mfma_f32_16x16x32_bf16 v[208:211], v[44:47], v[188:191], v[208:211]
    ds_read_b64_tr_b16 v[12:13], v129 offset:9216
    ds_read_b64_tr_b16 v[14:15], v129 offset:9344
    ds_read_b64_tr_b16 v[16:17], v129 offset:10240
    ds_read_b64_tr_b16 v[18:19], v129 offset:10368
    ds_read_b64_tr_b16 v[20:21], v129 offset:11264
    ds_read_b64_tr_b16 v[22:23], v129 offset:11392
    ds_read_b64_tr_b16 v[24:25], v129 offset:12288
    ds_read_b64_tr_b16 v[26:27], v129 offset:12416
    ds_read_b64_tr_b16 v[28:29], v129 offset:13312
    ds_read_b64_tr_b16 v[30:31], v129 offset:13440
    ds_read_b64_tr_b16 v[32:33], v129 offset:14336
    ds_read_b64_tr_b16 v[34:35], v129 offset:14464
    ds_read_b64_tr_b16 v[36:37], v129 offset:15360
    ds_read_b64_tr_b16 v[38:39], v129 offset:15488
    ds_read_b64_tr_b16 v[40:41], v129 offset:16384
    ds_read_b64_tr_b16 v[42:43], v129 offset:16512
    ds_read_b64_tr_b16 v[44:45], v129 offset:17408
    ds_read_b64_tr_b16 v[46:47], v129 offset:17536
    s_waitcnt lgkmcnt(0)
    v_mfma_f32_16x16x32_bf16 v[212:215], v[12:15], v[188:191], v[212:215]
    v_mfma_f32_16x16x32_bf16 v[208:211], v[16:19], v[192:195], v[208:211]
    v_mfma_f32_16x16x32_bf16 v[212:215], v[20:23], v[192:195], v[212:215]
    v_mfma_f32_16x16x32_bf16 v[208:211], v[24:27], v[196:199], v[208:211]
    v_mfma_f32_16x16x32_bf16 v[212:215], v[28:31], v[196:199], v[212:215]
    v_mfma_f32_16x16x32_bf16 v[208:211], v[32:35], v[200:203], v[208:211]
    v_mfma_f32_16x16x32_bf16 v[212:215], v[36:39], v[200:203], v[212:215]
    v_mfma_f32_16x16x32_bf16 v[208:211], v[40:43], v[204:207], v[208:211]
    v_mfma_f32_16x16x32_bf16 v[212:215], v[44:47], v[204:207], v[212:215]
    s_nop 7
    v_add_f32_dpp v208, v212, v208 row_ror:8 row_mask:0xf bank_mask:0xf
    v_add_f32_dpp v209, v213, v209 row_ror:8 row_mask:0xf bank_mask:0xf
    v_add_f32_dpp v210, v214, v210 row_ror:8 row_mask:0xf bank_mask:0xf
    v_add_f32_dpp v211, v215, v211 row_ror:8 row_mask:0xf bank_mask:0xf
    v_cvt_pk_bf16_f32 v124, v208, v209
    v_cvt_pk_bf16_f32 v125, v210, v211
    s_mov_b64 exec, s[82:83]
    ds_write_b64 v10, v[124:125]
    s_mov_b64 exec, -1
    v_add_u32 v10, 32, v10
    s_add_u32 s67, s67, 32
    s_cmp_lt_u32 s67, 256
    s_nop 0
    s_cbranch_scc1 L_h_qfb
    s_branch L_h_qhave
L_h_qok:
    ds_write_b64 v10, v[12:13]
    s_mov_b64 exec, -1
L_h_qhave:
    s_waitcnt lgkmcnt(0)
    v_mov_b32 v11, 154464
    v_mov_b32 v10, 1
    ds_write_b32 v11, v10
    s_setprio 0
    s_cmp_lg_u32 s2, 255
    s_cbranch_scc1 L_h_nozero
    v_mov_b32 v11, 1
    s_mov_b64 exec, 1
    buffer_atomic_add v11, v7, s[60:63], 0 offen sc0 sc1
    s_waitcnt vmcnt(0)
    v_readfirstlane_b32 s64, v11
    s_mov_b64 exec, -1
    s_cmp_lg_u32 s64, 0
    s_nop 2
    s_cbranch_scc1 L_h_nozero
    v_mov_b32 v252, 0
    v_mov_b32 v253, 0
    v_mov_b32 v254, 0
    v_mov_b32 v255, 0
    v_lshlrev_b32 v11, 4, v1
    s_mov_b32 s66, 0
    buffer_store_dwordx4 v[252:255], v11, s[52:55], s66 offen offset:0 sc1
    buffer_store_dwordx4 v[252:255], v11, s[52:55], s66 offen offset:1024 sc1
    buffer_store_dwordx4 v[252:255], v11, s[52:55], s66 offen offset:2048 sc1
    buffer_store_dwordx4 v[252:255], v11, s[52:55], s66 offen offset:3072 sc1
    s_mov_b32 s66, 4096
    buffer_store_dwordx4 v[252:255], v11, s[52:55], s66 offen offset:0 sc1
    buffer_store_dwordx4 v[252:255], v11, s[52:55], s66 offen offset:1024 sc1
    buffer_store_dwordx4 v[252:255], v11, s[52:55], s66 offen offset:2048 sc1
    buffer_store_dwordx4 v[252:255], v11, s[52:55], s66 offen offset:3072 sc1
    s_mov_b32 s66, 8192
    buffer_store_dwordx4 v[252:255], v11, s[52:55], s66 offen offset:0 sc1
    buffer_store_dwordx4 v[252:255], v11, s[52:55], s66 offen offset:1024 sc1
    buffer_store_dwordx4 v[252:255], v11, s[52:55], s66 offen offset:2048 sc1
    buffer_store_dwordx4 v[252:255], v11, s[52:55], s66 offen offset:3072 sc1
    s_mov_b32 s66, 12288
    buffer_store_dwordx4 v[252:255], v11, s[52:55], s66 offen offset:0 sc1
    buffer_store_dwordx4 v[252:255], v11, s[52:55], s66 offen offset:1024 sc1
    buffer_store_dwordx4 v[252:255], v11, s[52:55], s66 offen offset:2048 sc1
    buffer_store_dwordx4 v[252:255], v11, s[52:55], s66 offen offset:3072 sc1
    s_mov_b32 s66, 16384
    buffer_store_dwordx4 v[252:255], v11, s[52:55], s66 offen offset:0 sc1
    buffer_store_dwordx4 v[252:255], v11, s[52:55], s66 offen offset:1024 sc1
    buffer_store_dwordx4 v[252:255], v11, s[52:55], s66 offen offset:2048 sc1
    buffer_store_dwordx4 v[252:255], v11, s[52:55], s66 offen offset:3072 sc1
    s_mov_b32 s66, 20480
    buffer_store_dwordx4 v[252:255], v11, s[52:55], s66 offen offset:0 sc1
    buffer_store_dwordx4 v[252:255], v11, s[52:55], s66 offen offset:1024 sc1
    buffer_store_dwordx4 v[252:255], v11, s[52:55], s66 offen offset:2048 sc1
    buffer_store_dwordx4 v[252:255], v11, s[52:55], s66 offen offset:3072 sc1
    s_mov_b32 s66, 24576
    buffer_store_dwordx4 v[252:255], v11, s[52:55], s66 offen offset:0 sc1
    buffer_store_dwordx4 v[252:255], v11, s[52:55], s66 offen offset:1024 sc1
    s_waitcnt vmcnt(0)
    v_mov_b32 v11, 1
    s_mov_b64 exec, 1
    buffer_store_dword v11, v7, s[60:63], 0 offen offset:128 sc1
    s_mov_b64 exec, -1
L_h_nozero:
    s_lshr_b32 s64, s2, 3
    s_sub_i32 s65, s64, 14
    s_ashr_i32 s65, s65, 2
    s_max_i32 s65, s65, 0
    s_sub_u32 s65, s64, s65
    s_and_b32 s69, s2, 7
    s_mul_i32 s69, s69, 27
    s_add_u32 s69, s69, s65
    s_and_b32 s65, s64, 0x13
    s_cmp_eq_u32 s65, 0x11
    s_cselect_b32 s69, 1000, s69
    s_cmp_eq_u32 s64, 31
    s_cselect_b32 s69, 1000, s69
    s_cmp_ge_u32 s69, 1000
    s_cbranch_scc1 L_h_role
    s_and_b32 s64, s2, 7
    s_mul_i32 s65, s64, 27
    s_sub_u32 s65, s69, s65
    s_mul_i32 s69, s64, 18
    s_add_u32 s69, s69, s65
    s_cmp_lt_u32 s65, 18
    s_cbranch_scc1 L_h_role
    s_mul_i32 s69, s64, 9
    s_add_u32 s69, s69, s65
    s_add_u32 s69, s69, 126
L_h_role:
    s_cmp_ge_u32 s69, 144
    s_cbranch_scc1 L_h_wo
    v_lshrrev_b32 v9, 3, v3
    v_lshlrev_b32 v9, 2, v9
    v_add_u32 v9, v9, v2
    v_mul_u32_u24 v9, 73728, v9
    v_and_b32 v11, 7, v3
    v_lshl_add_u32 v9, v11, 4, v9
    s_lshr_b32 s84, s69, 1
    s_lshl_b32 s64, s84, 7
    v_add_u32 v9, s64, v9
    s_bitcmp1_b32 s69, 0
    s_cselect_b32 s44, s18, s16
    s_cselect_b32 s45, s19, s17
    s_mov_b32 s46, 5308416
    s_mov_b32 s47, 0x20000
    s_mov_b32 s66, 0
    buffer_load_dwordx4 v[12:15], v9, s[44:47], s66 offen nt
    s_mov_b32 s66, 9216
    buffer_load_dwordx4 v[16:19], v9, s[44:47], s66 offen nt
    s_mov_b32 s66, 18432
    buffer_load_dwordx4 v[20:23], v9, s[44:47], s66 offen nt
    s_mov_b32 s66, 27648
    buffer_load_dwordx4 v[24:27], v9, s[44:47], s66 offen nt
    s_mov_b32 s66, 36864
    buffer_load_dwordx4 v[28:31], v9, s[44:47], s66 offen nt
    s_mov_b32 s66, 46080
    buffer_load_dwordx4 v[32:35], v9, s[44:47], s66 offen nt
    s_mov_b32 s66, 55296
    buffer_load_dwordx4 v[36:39], v9, s[44:47], s66 offen nt
    s_mov_b32 s66, 64512
    buffer_load_dwordx4 v[40:43], v9, s[44:47], s66 offen nt
    s_mov_b32 s66, 589824
    buffer_load_dwordx4 v[44:47], v9, s[44:47], s66 offen nt
    s_mov_b32 s66, 599040
    buffer_load_dwordx4 v[48:51], v9, s[44:47], s66 offen nt
    s_mov_b32 s66, 608256
    buffer_load_dwordx4 v[52:55], v9, s[44:47], s66 offen nt
    s_mov_b32 s66, 617472
    buffer_load_dwordx4 v[56:59], v9, s[44:47], s66 offen nt
    s_mov_b32 s66, 626688
    buffer_load_dwordx4 v[60:63], v9, s[44:47], s66 offen nt
    s_mov_b32 s66, 635904
    buffer_load_dwordx4 v[64:67], v9, s[44:47], s66 offen nt
    s_mov_b32 s66, 645120
    buffer_load_dwordx4 v[68:71], v9, s[44:47], s66 offen nt
    s_mov_b32 s66, 654336
    buffer_load_dwordx4 v[72:75], v9, s[44:47], s66 offen nt
    s_mov_b32 s66, 1179648
    buffer_load_dwordx4 v[76:79], v9, s[44:47], s66 offen nt
    s_mov_b32 s66, 1188864
    buffer_load_dwordx4 v[80:83], v9, s[44:47], s66 offen nt
    s_mov_b32 s66, 1198080
    buffer_load_dwordx4 v[84:87], v9, s[44:47], s66 offen nt
    s_mov_b32 s66, 1207296
    buffer_load_dwordx4 v[88:91], v9, s[44:47], s66 offen nt
    s_mov_b32 s66, 1216512
    buffer_load_dwordx4 v[92:95], v9, s[44:47], s66 offen nt
    s_mov_b32 s66, 1225728
    buffer_load_dwordx4 v[96:99], v9, s[44:47], s66 offen nt
    s_mov_b32 s66, 1234944
    buffer_load_dwordx4 v[100:103], v9, s[44:47], s66 offen nt
    s_mov_b32 s66, 1244160
    buffer_load_dwordx4 v[104:107], v9, s[44:47], s66 offen nt
    s_waitcnt vmcnt(16)
    v_perm_b32 v240, v16, v12, s74
    v_perm_b32 v244, v16, v12, s75
    v_perm_b32 v241, v24, v20, s74
    v_perm_b32 v245, v24, v20, s75
    v_perm_b32 v242, v32, v28, s74
    v_perm_b32 v246, v32, v28, s75
    v_perm_b32 v243, v40, v36, s74
    v_perm_b32 v247, v40, v36, s75
    s_nop 0
    v_mfma_f32_16x16x32_bf16 v[208:211], v[240:243], v[172:175], 0
    v_mfma_f32_16x16x32_bf16 v[212:215], v[244:247], v[172:175], 0
    v_perm_b32 v248, v17, v13, s74
    v_perm_b32 v252, v17, v13, s75
    v_perm_b32 v249, v25, v21, s74
    v_perm_b32 v253, v25, v21, s75
    v_perm_b32 v250, v33, v29, s74
    v_perm_b32 v254, v33, v29, s75
    v_perm_b32 v251, v41, v37, s74
    v_perm_b32 v255, v41, v37, s75
    s_nop 0
    v_mfma_f32_16x16x32_bf16 v[216:219], v[248:251], v[172:175], 0
    v_mfma_f32_16x16x32_bf16 v[220:223], v[252:255], v[172:175], 0
    v_perm_b32 v240, v18, v14, s74
    v_perm_b32 v244, v18, v14, s75
    v_perm_b32 v241, v26, v22, s74
    v_perm_b32 v245, v26, v22, s75
    v_perm_b32 v242, v34, v30, s74
    v_perm_b32 v246, v34, v30, s75
    v_perm_b32 v243, v42, v38, s74
    v_perm_b32 v247, v42, v38, s75
    s_nop 0
    v_mfma_f32_16x16x32_bf16 v[224:227], v[240:243], v[172:175], 0
    v_mfma_f32_16x16x32_bf16 v[228:231], v[244:247], v[172:175], 0
    v_perm_b32 v248, v19, v15, s74
    v_perm_b32 v252, v19, v15, s75
    v_perm_b32 v249, v27, v23, s74
    v_perm_b32 v253, v27, v23, s75
    v_perm_b32 v250, v35, v31, s74
    v_perm_b32 v254, v35, v31, s75
    v_perm_b32 v251, v43, v39, s74
    v_perm_b32 v255, v43, v39, s75
    s_nop 0
    v_mfma_f32_16x16x32_bf16 v[232:235], v[248:251], v[172:175], 0
    v_mfma_f32_16x16x32_bf16 v[236:239], v[252:255], v[172:175], 0
    s_mov_b32 s66, 1769472
    buffer_load_dwordx4 v[108:111], v9, s[44:47], s66 offen nt
    s_mov_b32 s66, 1778688
    buffer_load_dwordx4 v[112:115], v9, s[44:47], s66 offen nt
    s_mov_b32 s66, 1787904
    buffer_load_dwordx4 v[116:119], v9, s[44:47], s66 offen nt
    s_mov_b32 s66, 1797120
    buffer_load_dwordx4 v[120:123], v9, s[44:47], s66 offen nt
    s_mov_b32 s66, 1806336
    buffer_load_dwordx4 v[124:127], v9, s[44:47], s66 offen nt
    s_mov_b32 s66, 1815552
    buffer_load_dwordx4 v[128:131], v9, s[44:47], s66 offen nt
    s_mov_b32 s66, 1824768
    buffer_load_dwordx4 v[132:135], v9, s[44:47], s66 offen nt
    s_mov_b32 s66, 1833984
    buffer_load_dwordx4 v[136:139], v9, s[44:47], s66 offen nt
    s_waitcnt vmcnt(16)
    v_perm_b32 v240, v48, v44, s74
    v_perm_b32 v244, v48, v44, s75
    v_perm_b32 v241, v56, v52, s74
    v_perm_b32 v245, v56, v52, s75
    v_perm_b32 v242, v64, v60, s74
    v_perm_b32 v246, v64, v60, s75
    v_perm_b32 v243, v72, v68, s74
    v_perm_b32 v247, v72, v68, s75
    s_nop 0
    v_mfma_f32_16x16x32_bf16 v[208:211], v[240:243], v[176:179], v[208:211]
    v_mfma_f32_16x16x32_bf16 v[212:215], v[244:247], v[176:179], v[212:215]
    v_perm_b32 v248, v49, v45, s74
    v_perm_b32 v252, v49, v45, s75
    v_perm_b32 v249, v57, v53, s74
    v_perm_b32 v253, v57, v53, s75
    v_perm_b32 v250, v65, v61, s74
    v_perm_b32 v254, v65, v61, s75
    v_perm_b32 v251, v73, v69, s74
    v_perm_b32 v255, v73, v69, s75
    s_nop 0
    v_mfma_f32_16x16x32_bf16 v[216:219], v[248:251], v[176:179], v[216:219]
    v_mfma_f32_16x16x32_bf16 v[220:223], v[252:255], v[176:179], v[220:223]
    v_perm_b32 v240, v50, v46, s74
    v_perm_b32 v244, v50, v46, s75
    v_perm_b32 v241, v58, v54, s74
    v_perm_b32 v245, v58, v54, s75
    v_perm_b32 v242, v66, v62, s74
    v_perm_b32 v246, v66, v62, s75
    v_perm_b32 v243, v74, v70, s74
    v_perm_b32 v247, v74, v70, s75
    s_nop 0
    v_mfma_f32_16x16x32_bf16 v[224:227], v[240:243], v[176:179], v[224:227]
    v_mfma_f32_16x16x32_bf16 v[228:231], v[244:247], v[176:179], v[228:231]
    v_perm_b32 v248, v51, v47, s74
    v_perm_b32 v252, v51, v47, s75
    v_perm_b32 v249, v59, v55, s74
    v_perm_b32 v253, v59, v55, s75
    v_perm_b32 v250, v67, v63, s74
    v_perm_b32 v254, v67, v63, s75
    v_perm_b32 v251, v75, v71, s74
    v_perm_b32 v255, v75, v71, s75
    s_nop 0
    v_mfma_f32_16x16x32_bf16 v[232:235], v[248:251], v[176:179], v[232:235]
    v_mfma_f32_16x16x32_bf16 v[236:239], v[252:255], v[176:179], v[236:239]
    s_mov_b32 s66, 2359296
    buffer_load_dwordx4 v[140:143], v9, s[44:47], s66 offen nt
    s_mov_b32 s66, 2368512
    buffer_load_dwordx4 v[144:147], v9, s[44:47], s66 offen nt
    s_mov_b32 s66, 2377728
    buffer_load_dwordx4 v[148:151], v9, s[44:47], s66 offen nt
    s_mov_b32 s66, 2386944
    buffer_load_dwordx4 v[152:155], v9, s[44:47], s66 offen nt
    s_mov_b32 s66, 2396160
    buffer_load_dwordx4 v[156:159], v9, s[44:47], s66 offen nt
    s_mov_b32 s66, 2405376
    buffer_load_dwordx4 v[160:163], v9, s[44:47], s66 offen nt
    s_mov_b32 s66, 2414592
    buffer_load_dwordx4 v[164:167], v9, s[44:47], s66 offen nt
    s_mov_b32 s66, 2423808
    buffer_load_dwordx4 v[168:171], v9, s[44:47], s66 offen nt
    s_waitcnt vmcnt(16)
    v_perm_b32 v240, v80, v76, s74
    v_perm_b32 v244, v80, v76, s75
    v_perm_b32 v241, v88, v84, s74
    v_perm_b32 v245, v88, v84, s75
    v_perm_b32 v242, v96, v92, s74
    v_perm_b32 v246, v96, v92, s75
    v_perm_b32 v243, v104, v100, s74
    v_perm_b32 v247, v104, v100, s75
    s_nop 0
    v_mfma_f32_16x16x32_bf16 v[208:211], v[240:243], v[180:183], v[208:211]
    v_mfma_f32_16x16x32_bf16 v[212:215], v[244:247], v[180:183], v[212:215]
    v_perm_b32 v248, v81, v77, s74
    v_perm_b32 v252, v81, v77, s75
    v_perm_b32 v249, v89, v85, s74
    v_perm_b32 v253, v89, v85, s75
    v_perm_b32 v250, v97, v93, s74
    v_perm_b32 v254, v97, v93, s75
    v_perm_b32 v251, v105, v101, s74
    v_perm_b32 v255, v105, v101, s75
    s_nop 0
    v_mfma_f32_16x16x32_bf16 v[216:219], v[248:251], v[180:183], v[216:219]
    v_mfma_f32_16x16x32_bf16 v[220:223], v[252:255], v[180:183], v[220:223]
    v_perm_b32 v240, v82, v78, s74
    v_perm_b32 v244, v82, v78, s75
    v_perm_b32 v241, v90, v86, s74
    v_perm_b32 v245, v90, v86, s75
    v_perm_b32 v242, v98, v94, s74
    v_perm_b32 v246, v98, v94, s75
    v_perm_b32 v243, v106, v102, s74
    v_perm_b32 v247, v106, v102, s75
    s_nop 0
    v_mfma_f32_16x16x32_bf16 v[224:227], v[240:243], v[180:183], v[224:227]
    v_mfma_f32_16x16x32_bf16 v[228:231], v[244:247], v[180:183], v[228:231]
    v_perm_b32 v248, v83, v79, s74
    v_perm_b32 v252, v83, v79, s75
    v_perm_b32 v249, v91, v87, s74
    v_perm_b32 v253, v91, v87, s75
    v_perm_b32 v250, v99, v95, s74
    v_perm_b32 v254, v99, v95, s75
    v_perm_b32 v251, v107, v103, s74
    v_perm_b32 v255, v107, v103, s75
    s_nop 0
    v_mfma_f32_16x16x32_bf16 v[232:235], v[248:251], v[180:183], v[232:235]
    v_mfma_f32_16x16x32_bf16 v[236:239], v[252:255], v[180:183], v[236:239]
    s_mov_b32 s66, 2949120
    buffer_load_dwordx4 v[12:15], v9, s[44:47], s66 offen nt
    s_mov_b32 s66, 2958336
    buffer_load_dwordx4 v[16:19], v9, s[44:47], s66 offen nt
    s_mov_b32 s66, 2967552
    buffer_load_dwordx4 v[20:23], v9, s[44:47], s66 offen nt
    s_mov_b32 s66, 2976768
    buffer_load_dwordx4 v[24:27], v9, s[44:47], s66 offen nt
    s_mov_b32 s66, 2985984
    buffer_load_dwordx4 v[28:31], v9, s[44:47], s66 offen nt
    s_mov_b32 s66, 2995200
    buffer_load_dwordx4 v[32:35], v9, s[44:47], s66 offen nt
    s_mov_b32 s66, 3004416
    buffer_load_dwordx4 v[36:39], v9, s[44:47], s66 offen nt
    s_mov_b32 s66, 3013632
    buffer_load_dwordx4 v[40:43], v9, s[44:47], s66 offen nt
    s_waitcnt vmcnt(16)
    v_perm_b32 v240, v112, v108, s74
    v_perm_b32 v244, v112, v108, s75
    v_perm_b32 v241, v120, v116, s74
    v_perm_b32 v245, v120, v116, s75
    v_perm_b32 v242, v128, v124, s74
    v_perm_b32 v246, v128, v124, s75
    v_perm_b32 v243, v136, v132, s74
    v_perm_b32 v247, v136, v132, s75
    s_nop 0
    v_mfma_f32_16x16x32_bf16 v[208:211], v[240:243], v[184:187], v[208:211]
    v_mfma_f32_16x16x32_bf16 v[212:215], v[244:247], v[184:187], v[212:215]
    v_perm_b32 v248, v113, v109, s74
    v_perm_b32 v252, v113, v109, s75
    v_perm_b32 v249, v121, v117, s74
    v_perm_b32 v253, v121, v117, s75
    v_perm_b32 v250, v129, v125, s74
    v_perm_b32 v254, v129, v125, s75
    v_perm_b32 v251, v137, v133, s74
    v_perm_b32 v255, v137, v133, s75
    s_nop 0
    v_mfma_f32_16x16x32_bf16 v[216:219], v[248:251], v[184:187], v[216:219]
    v_mfma_f32_16x16x32_bf16 v[220:223], v[252:255], v[184:187], v[220:223]
    v_perm_b32 v240, v114, v110, s74
    v_perm_b32 v244, v114, v110, s75
    v_perm_b32 v241, v122, v118, s74
    v_perm_b32 v245, v122, v118, s75
    v_perm_b32 v242, v130, v126, s74
    v_perm_b32 v246, v130, v126, s75
    v_perm_b32 v243, v138, v134, s74
    v_perm_b32 v247, v138, v134, s75
    s_nop 0
    v_mfma_f32_16x16x32_bf16 v[224:227], v[240:243], v[184:187], v[224:227]
    v_mfma_f32_16x16x32_bf16 v[228:231], v[244:247], v[184:187], v[228:231]
    v_perm_b32 v248, v115, v111, s74
    v_perm_b32 v252, v115, v111, s75
    v_perm_b32 v249, v123, v119, s74
    v_perm_b32 v253, v123, v119, s75
    v_perm_b32 v250, v131, v127, s74
    v_perm_b32 v254, v131, v127, s75
    v_perm_b32 v251, v139, v135, s74
    v_perm_b32 v255, v139, v135, s75
    s_nop 0
    v_mfma_f32_16x16x32_bf16 v[232:235], v[248:251], v[184:187], v[232:235]
    v_mfma_f32_16x16x32_bf16 v[236:239], v[252:255], v[184:187], v[236:239]
    s_mov_b32 s66, 3538944
    buffer_load_dwordx4 v[44:47], v9, s[44:47], s66 offen nt
    s_mov_b32 s66, 3548160
    buffer_load_dwordx4 v[48:51], v9, s[44:47], s66 offen nt
    s_mov_b32 s66, 3557376
    buffer_load_dwordx4 v[52:55], v9, s[44:47], s66 offen nt
    s_mov_b32 s66, 3566592
    buffer_load_dwordx4 v[56:59], v9, s[44:47], s66 offen nt
    s_mov_b32 s66, 3575808
    buffer_load_dwordx4 v[60:63], v9, s[44:47], s66 offen nt
    s_mov_b32 s66, 3585024
    buffer_load_dwordx4 v[64:67], v9, s[44:47], s66 offen nt
    s_mov_b32 s66, 3594240
    buffer_load_dwordx4 v[68:71], v9, s[44:47], s66 offen nt
    s_mov_b32 s66, 3603456
    buffer_load_dwordx4 v[72:75], v9, s[44:47], s66 offen nt
    s_waitcnt vmcnt(16)
    v_perm_b32 v240, v144, v140, s74
    v_perm_b32 v244, v144, v140, s75
    v_perm_b32 v241, v152, v148, s74
    v_perm_b32 v245, v152, v148, s75
    v_perm_b32 v242, v160, v156, s74
    v_perm_b32 v246, v160, v156, s75
    v_perm_b32 v243, v168, v164, s74
    v_perm_b32 v247, v168, v164, s75
    s_nop 0
    v_mfma_f32_16x16x32_bf16 v[208:211], v[240:243], v[188:191], v[208:211]
    v_mfma_f32_16x16x32_bf16 v[212:215], v[244:247], v[188:191], v[212:215]
    v_perm_b32 v248, v145, v141, s74
    v_perm_b32 v252, v145, v141, s75
    v_perm_b32 v249, v153, v149, s74
    v_perm_b32 v253, v153, v149, s75
    v_perm_b32 v250, v161, v157, s74
    v_perm_b32 v254, v161, v157, s75
    v_perm_b32 v251, v169, v165, s74
    v_perm_b32 v255, v169, v165, s75
    s_nop 0
    v_mfma_f32_16x16x32_bf16 v[216:219], v[248:251], v[188:191], v[216:219]
    v_mfma_f32_16x16x32_bf16 v[220:223], v[252:255], v[188:191], v[220:223]
    v_perm_b32 v240, v146, v142, s74
    v_perm_b32 v244, v146, v142, s75
    v_perm_b32 v241, v154, v150, s74
    v_perm_b32 v245, v154, v150, s75
    v_perm_b32 v242, v162, v158, s74
    v_perm_b32 v246, v162, v158, s75
    v_perm_b32 v243, v170, v166, s74
    v_perm_b32 v247, v170, v166, s75
    s_nop 0
    v_mfma_f32_16x16x32_bf16 v[224:227], v[240:243], v[188:191], v[224:227]
    v_mfma_f32_16x16x32_bf16 v[228:231], v[244:247], v[188:191], v[228:231]
    v_perm_b32 v248, v147, v143, s74
    v_perm_b32 v252, v147, v143, s75
    v_perm_b32 v249, v155, v151, s74
    v_perm_b32 v253, v155, v151, s75
    v_perm_b32 v250, v163, v159, s74
    v_perm_b32 v254, v163, v159, s75
    v_perm_b32 v251, v171, v167, s74
    v_perm_b32 v255, v171, v167, s75
    s_nop 0
    v_mfma_f32_16x16x32_bf16 v[232:235], v[248:251], v[188:191], v[232:235]
    v_mfma_f32_16x16x32_bf16 v[236:239], v[252:255], v[188:191], v[236:239]
    s_mov_b32 s66, 4128768
    buffer_load_dwordx4 v[76:79], v9, s[44:47], s66 offen nt
    s_mov_b32 s66, 4137984
    buffer_load_dwordx4 v[80:83], v9, s[44:47], s66 offen nt
    s_mov_b32 s66, 4147200
    buffer_load_dwordx4 v[84:87], v9, s[44:47], s66 offen nt
    s_mov_b32 s66, 4156416
    buffer_load_dwordx4 v[88:91], v9, s[44:47], s66 offen nt
    s_mov_b32 s66, 4165632
    buffer_load_dwordx4 v[92:95], v9, s[44:47], s66 offen nt
    s_mov_b32 s66, 4174848
    buffer_load_dwordx4 v[96:99], v9, s[44:47], s66 offen nt
    s_mov_b32 s66, 4184064
    buffer_load_dwordx4 v[100:103], v9, s[44:47], s66 offen nt
    s_mov_b32 s66, 4193280
    buffer_load_dwordx4 v[104:107], v9, s[44:47], s66 offen nt
    s_waitcnt vmcnt(16)
    v_perm_b32 v240, v16, v12, s74
    v_perm_b32 v244, v16, v12, s75
    v_perm_b32 v241, v24, v20, s74
    v_perm_b32 v245, v24, v20, s75
    v_perm_b32 v242, v32, v28, s74
    v_perm_b32 v246, v32, v28, s75
    v_perm_b32 v243, v40, v36, s74
    v_perm_b32 v247, v40, v36, s75
    s_nop 0
    v_mfma_f32_16x16x32_bf16 v[208:211], v[240:243], v[192:195], v[208:211]
    v_mfma_f32_16x16x32_bf16 v[212:215], v[244:247], v[192:195], v[212:215]
    v_perm_b32 v248, v17, v13, s74
    v_perm_b32 v252, v17, v13, s75
    v_perm_b32 v249, v25, v21, s74
    v_perm_b32 v253, v25, v21, s75
    v_perm_b32 v250, v33, v29, s74
    v_perm_b32 v254, v33, v29, s75
    v_perm_b32 v251, v41, v37, s74
    v_perm_b32 v255, v41, v37, s75
    s_nop 0
    v_mfma_f32_16x16x32_bf16 v[216:219], v[248:251], v[192:195], v[216:219]
    v_mfma_f32_16x16x32_bf16 v[220:223], v[252:255], v[192:195], v[220:223]
    v_perm_b32 v240, v18, v14, s74
    v_perm_b32 v244, v18, v14, s75
    v_perm_b32 v241, v26, v22, s74
    v_perm_b32 v245, v26, v22, s75
    v_perm_b32 v242, v34, v30, s74
    v_perm_b32 v246, v34, v30, s75
    v_perm_b32 v243, v42, v38, s74
    v_perm_b32 v247, v42, v38, s75
    s_nop 0
    v_mfma_f32_16x16x32_bf16 v[224:227], v[240:243], v[192:195], v[224:227]
    v_mfma_f32_16x16x32_bf16 v[228:231], v[244:247], v[192:195], v[228:231]
    v_perm_b32 v248, v19, v15, s74
    v_perm_b32 v252, v19, v15, s75
    v_perm_b32 v249, v27, v23, s74
    v_perm_b32 v253, v27, v23, s75
    v_perm_b32 v250, v35, v31, s74
    v_perm_b32 v254, v35, v31, s75
    v_perm_b32 v251, v43, v39, s74
    v_perm_b32 v255, v43, v39, s75
    s_nop 0
    v_mfma_f32_16x16x32_bf16 v[232:235], v[248:251], v[192:195], v[232:235]
    v_mfma_f32_16x16x32_bf16 v[236:239], v[252:255], v[192:195], v[236:239]
    s_mov_b32 s66, 4718592
    buffer_load_dwordx4 v[108:111], v9, s[44:47], s66 offen nt
    s_mov_b32 s66, 4727808
    buffer_load_dwordx4 v[112:115], v9, s[44:47], s66 offen nt
    s_mov_b32 s66, 4737024
    buffer_load_dwordx4 v[116:119], v9, s[44:47], s66 offen nt
    s_mov_b32 s66, 4746240
    buffer_load_dwordx4 v[120:123], v9, s[44:47], s66 offen nt
    s_mov_b32 s66, 4755456
    buffer_load_dwordx4 v[124:127], v9, s[44:47], s66 offen nt
    s_mov_b32 s66, 4764672
    buffer_load_dwordx4 v[128:131], v9, s[44:47], s66 offen nt
    s_mov_b32 s66, 4773888
    buffer_load_dwordx4 v[132:135], v9, s[44:47], s66 offen nt
    s_mov_b32 s66, 4783104
    buffer_load_dwordx4 v[136:139], v9, s[44:47], s66 offen nt
    s_waitcnt vmcnt(16)
    v_perm_b32 v240, v48, v44, s74
    v_perm_b32 v244, v48, v44, s75
    v_perm_b32 v241, v56, v52, s74
    v_perm_b32 v245, v56, v52, s75
    v_perm_b32 v242, v64, v60, s74
    v_perm_b32 v246, v64, v60, s75
    v_perm_b32 v243, v72, v68, s74
    v_perm_b32 v247, v72, v68, s75
    s_nop 0
    v_mfma_f32_16x16x32_bf16 v[208:211], v[240:243], v[196:199], v[208:211]
    v_mfma_f32_16x16x32_bf16 v[212:215], v[244:247], v[196:199], v[212:215]
    v_perm_b32 v248, v49, v45, s74
    v_perm_b32 v252, v49, v45, s75
    v_perm_b32 v249, v57, v53, s74
    v_perm_b32 v253, v57, v53, s75
    v_perm_b32 v250, v65, v61, s74
    v_perm_b32 v254, v65, v61, s75
    v_perm_b32 v251, v73, v69, s74
    v_perm_b32 v255, v73, v69, s75
    s_nop 0
    v_mfma_f32_16x16x32_bf16 v[216:219], v[248:251], v[196:199], v[216:219]
    v_mfma_f32_16x16x32_bf16 v[220:223], v[252:255], v[196:199], v[220:223]
    v_perm_b32 v240, v50, v46, s74
    v_perm_b32 v244, v50, v46, s75
    v_perm_b32 v241, v58, v54, s74
    v_perm_b32 v245, v58, v54, s75
    v_perm_b32 v242, v66, v62, s74
    v_perm_b32 v246, v66, v62, s75
    v_perm_b32 v243, v74, v70, s74
    v_perm_b32 v247, v74, v70, s75
    s_nop 0
    v_mfma_f32_16x16x32_bf16 v[224:227], v[240:243], v[196:199], v[224:227]
    v_mfma_f32_16x16x32_bf16 v[228:231], v[244:247], v[196:199], v[228:231]
    v_perm_b32 v248, v51, v47, s74
    v_perm_b32 v252, v51, v47, s75
    v_perm_b32 v249, v59, v55, s74
    v_perm_b32 v253, v59, v55, s75
    v_perm_b32 v250, v67, v63, s74
    v_perm_b32 v254, v67, v63, s75
    v_perm_b32 v251, v75, v71, s74
    v_perm_b32 v255, v75, v71, s75
    s_nop 0
    v_mfma_f32_16x16x32_bf16 v[232:235], v[248:251], v[196:199], v[232:235]
    v_mfma_f32_16x16x32_bf16 v[236:239], v[252:255], v[196:199], v[236:239]
    s_waitcnt vmcnt(8)
    v_perm_b32 v240, v80, v76, s74
    v_perm_b32 v244, v80, v76, s75
    v_perm_b32 v241, v88, v84, s74
    v_perm_b32 v245, v88, v84, s75
    v_perm_b32 v242, v96, v92, s74
    v_perm_b32 v246, v96, v92, s75
    v_perm_b32 v243, v104, v100, s74
    v_perm_b32 v247, v104, v100, s75
    s_nop 0
    v_mfma_f32_16x16x32_bf16 v[208:211], v[240:243], v[200:203], v[208:211]
    v_mfma_f32_16x16x32_bf16 v[212:215], v[244:247], v[200:203], v[212:215]
    v_perm_b32 v248, v81, v77, s74
    v_perm_b32 v252, v81, v77, s75
    v_perm_b32 v249, v89, v85, s74
    v_perm_b32 v253, v89, v85, s75
    v_perm_b32 v250, v97, v93, s74
    v_perm_b32 v254, v97, v93, s75
    v_perm_b32 v251, v105, v101, s74
    v_perm_b32 v255, v105, v101, s75
    s_nop 0
    v_mfma_f32_16x16x32_bf16 v[216:219], v[248:251], v[200:203], v[216:219]
    v_mfma_f32_16x16x32_bf16 v[220:223], v[252:255], v[200:203], v[220:223]
    v_perm_b32 v240, v82, v78, s74
    v_perm_b32 v244, v82, v78, s75
    v_perm_b32 v241, v90, v86, s74
    v_perm_b32 v245, v90, v86, s75
    v_perm_b32 v242, v98, v94, s74
    v_perm_b32 v246, v98, v94, s75
    v_perm_b32 v243, v106, v102, s74
    v_perm_b32 v247, v106, v102, s75
    s_nop 0
    v_mfma_f32_16x16x32_bf16 v[224:227], v[240:243], v[200:203], v[224:227]
    v_mfma_f32_16x16x32_bf16 v[228:231], v[244:247], v[200:203], v[228:231]
    v_perm_b32 v248, v83, v79, s74
    v_perm_b32 v252, v83, v79, s75
    v_perm_b32 v249, v91, v87, s74
    v_perm_b32 v253, v91, v87, s75
    v_perm_b32 v250, v99, v95, s74
    v_perm_b32 v254, v99, v95, s75
    v_perm_b32 v251, v107, v103, s74
    v_perm_b32 v255, v107, v103, s75
    s_nop 0
    v_mfma_f32_16x16x32_bf16 v[232:235], v[248:251], v[200:203], v[232:235]
    v_mfma_f32_16x16x32_bf16 v[236:239], v[252:255], v[200:203], v[236:239]
    s_waitcnt vmcnt(0)
    v_perm_b32 v240, v112, v108, s74
    v_perm_b32 v244, v112, v108, s75
    v_perm_b32 v241, v120, v116, s74
    v_perm_b32 v245, v120, v116, s75
    v_perm_b32 v242, v128, v124, s74
    v_perm_b32 v246, v128, v124, s75
    v_perm_b32 v243, v136, v132, s74
    v_perm_b32 v247, v136, v132, s75
    s_nop 0
    v_mfma_f32_16x16x32_bf16 v[208:211], v[240:243], v[204:207], v[208:211]
    v_mfma_f32_16x16x32_bf16 v[212:215], v[244:247], v[204:207], v[212:215]
    v_perm_b32 v248, v113, v109, s74
    v_perm_b32 v252, v113, v109, s75
    v_perm_b32 v249, v121, v117, s74
    v_perm_b32 v253, v121, v117, s75
    v_perm_b32 v250, v129, v125, s74
    v_perm_b32 v254, v129, v125, s75
    v_perm_b32 v251, v137, v133, s74
    v_perm_b32 v255, v137, v133, s75
    s_nop 0
    v_mfma_f32_16x16x32_bf16 v[216:219], v[248:251], v[204:207], v[216:219]
    v_mfma_f32_16x16x32_bf16 v[220:223], v[252:255], v[204:207], v[220:223]
    v_perm_b32 v240, v114, v110, s74
    v_perm_b32 v244, v114, v110, s75
    v_perm_b32 v241, v122, v118, s74
    v_perm_b32 v245, v122, v118, s75
    v_perm_b32 v242, v130, v126, s74
    v_perm_b32 v246, v130, v126, s75
    v_perm_b32 v243, v138, v134, s74
    v_perm_b32 v247, v138, v134, s75
    s_nop 0
    v_mfma_f32_16x16x32_bf16 v[224:227], v[240:243], v[204:207], v[224:227]
    v_mfma_f32_16x16x32_bf16 v[228:231], v[244:247], v[204:207], v[228:231]
    v_perm_b32 v248, v115, v111, s74
    v_perm_b32 v252, v115, v111, s75
    v_perm_b32 v249, v123, v119, s74
    v_perm_b32 v253, v123, v119, s75
    v_perm_b32 v250, v131, v127, s74
    v_perm_b32 v254, v131, v127, s75
    v_perm_b32 v251, v139, v135, s74
    v_perm_b32 v255, v139, v135, s75
    s_nop 0
    v_mfma_f32_16x16x32_bf16 v[232:235], v[248:251], v[204:207], v[232:235]
    v_mfma_f32_16x16x32_bf16 v[236:239], v[252:255], v[204:207], v[236:239]
    v_and_b32 v8, 7, v3
    v_lshl_add_u32 v9, v2, 3, v8
    v_mul_u32_u24 v9, 144, v9
    v_add_u32 v9, 149568, v9
    v_mul_u32_u24 v8, 144, v8
    v_lshl_add_u32 v8, v2, 2, v8
    v_add_u32 v8, 149568, v8
    s_mov_b32 exec_lo, 0xff00ff
    s_mov_b32 exec_hi, 0xff00ff00
    ds_write_b128 v9, v[208:211] offset:0
    ds_write_b128 v9, v[212:215] offset:16
    ds_write_b128 v9, v[216:219] offset:32
    ds_write_b128 v9, v[220:223] offset:48
    ds_write_b128 v9, v[224:227] offset:64
    ds_write_b128 v9, v[228:231] offset:80
    ds_write_b128 v9, v[232:235] offset:96
    ds_write_b128 v9, v[236:239] offset:112
    s_mov_b64 exec, -1
    s_waitcnt lgkmcnt(0)
    ds_read_b32 v172, v8 offset:0
    ds_read_b32 v173, v8 offset:16
    ds_read_b32 v174, v8 offset:32
    ds_read_b32 v175, v8 offset:48
    ds_read_b32 v176, v8 offset:64
    ds_read_b32 v177, v8 offset:80
    ds_read_b32 v178, v8 offset:96
    ds_read_b32 v179, v8 offset:112
    ds_read_b32 v180, v8 offset:1152
    ds_read_b32 v181, v8 offset:1168
    ds_read_b32 v182, v8 offset:1184
    ds_read_b32 v183, v8 offset:1200
    ds_read_b32 v184, v8 offset:1216
    ds_read_b32 v185, v8 offset:1232
    ds_read_b32 v186, v8 offset:1248
    ds_read_b32 v187, v8 offset:1264
    ds_read_b32 v188, v8 offset:2304
    ds_read_b32 v189, v8 offset:2320
    ds_read_b32 v190, v8 offset:2336
    ds_read_b32 v191, v8 offset:2352
    ds_read_b32 v192, v8 offset:2368
    ds_read_b32 v193, v8 offset:2384
    ds_read_b32 v194, v8 offset:2400
    ds_read_b32 v195, v8 offset:2416
    ds_read_b32 v196, v8 offset:3456
    ds_read_b32 v197, v8 offset:3472
    ds_read_b32 v198, v8 offset:3488
    ds_read_b32 v199, v8 offset:3504
    ds_read_b32 v200, v8 offset:3520
    ds_read_b32 v201, v8 offset:3536
    ds_read_b32 v202, v8 offset:3552
    ds_read_b32 v203, v8 offset:3568
    s_waitcnt lgkmcnt(0)
    v_add_f32 v172, v172, v188
    v_add_f32 v173, v173, v189
    v_add_f32 v174, v174, v190
    v_add_f32 v175, v175, v191
    v_add_f32 v176, v176, v192
    v_add_f32 v177, v177, v193
    v_add_f32 v178, v178, v194
    v_add_f32 v179, v179, v195
    v_add_f32 v180, v180, v196
    v_add_f32 v181, v181, v197
    v_add_f32 v182, v182, v198
    v_add_f32 v183, v183, v199
    v_add_f32 v184, v184, v200
    v_add_f32 v185, v185, v201
    v_add_f32 v186, v186, v202
    v_add_f32 v187, v187, v203
    v_cvt_pk_bf16_f32 v208, v172, v173
    v_cvt_pk_bf16_f32 v209, v174, v175
    v_cvt_pk_bf16_f32 v210, v176, v177
    v_cvt_pk_bf16_f32 v211, v178, v179
    v_cvt_pk_bf16_f32 v212, v180, v181
    v_cvt_pk_bf16_f32 v213, v182, v183
    v_cvt_pk_bf16_f32 v214, v184, v185
    v_cvt_pk_bf16_f32 v215, v186, v187
    v_lshlrev_b32 v8, 4, v1
    s_lshl_b32 s66, s69, 11
    s_add_u32 s66, s66, 196608
    buffer_store_dwordx4 v[208:211], v8, s[52:55], s66 offen sc1
    buffer_store_dwordx4 v[212:215], v8, s[52:55], s66 offen offset:1024 sc1
    s_mov_b32 s76, 2000
    s_nop 0
L_h_z1:
    buffer_load_dword v11, v7, s[60:63], 0 offen offset:128 sc1
    s_waitcnt vmcnt(0)
    v_readfirstlane_b32 s64, v11
    s_nop 0
    s_cmp_lg_u32 s64, 0
    s_nop 2
    s_cbranch_scc1 L_h_z1_ok
    s_sleep 16
    s_sub_u32 s76, s76, 1
    s_cmp_lg_u32 s76, 0
    s_cbranch_scc1 L_h_z1
    v_mov_b32 v11, 1
    s_mov_b64 exec, 1
    buffer_atomic_add v11, v7, s[60:63], 0 offen sc0 sc1
    s_waitcnt vmcnt(0)
    v_readfirstlane_b32 s64, v11
    s_mov_b64 exec, -1
    s_cmp_lg_u32 s64, 0
    s_nop 2
    s_cbranch_scc1 L_h_z1
    v_mov_b32 v252, 0
    v_mov_b32 v253, 0
    v_mov_b32 v254, 0
    v_mov_b32 v255, 0
    v_lshlrev_b32 v11, 4, v1
    s_mov_b32 s66, 0
    buffer_store_dwordx4 v[252:255], v11, s[52:55], s66 offen offset:0 sc1
    buffer_store_dwordx4 v[252:255], v11, s[52:55], s66 offen offset:1024 sc1
    buffer_store_dwordx4 v[252:255], v11, s[52:55], s66 offen offset:2048 sc1
    buffer_store_dwordx4 v[252:255], v11, s[52:55], s66 offen offset:3072 sc1
    s_mov_b32 s66, 4096
    buffer_store_dwordx4 v[252:255], v11, s[52:55], s66 offen offset:0 sc1
    buffer_store_dwordx4 v[252:255], v11, s[52:55], s66 offen offset:1024 sc1
    buffer_store_dwordx4 v[252:255], v11, s[52:55], s66 offen offset:2048 sc1
    buffer_store_dwordx4 v[252:255], v11, s[52:55], s66 offen offset:3072 sc1
    s_mov_b32 s66, 8192
    buffer_store_dwordx4 v[252:255], v11, s[52:55], s66 offen offset:0 sc1
    buffer_store_dwordx4 v[252:255], v11, s[52:55], s66 offen offset:1024 sc1
    buffer_store_dwordx4 v[252:255], v11, s[52:55], s66 offen offset:2048 sc1
    buffer_store_dwordx4 v[252:255], v11, s[52:55], s66 offen offset:3072 sc1
    s_mov_b32 s66, 12288
    buffer_store_dwordx4 v[252:255], v11, s[52:55], s66 offen offset:0 sc1
    buffer_store_dwordx4 v[252:255], v11, s[52:55], s66 offen offset:1024 sc1
    buffer_store_dwordx4 v[252:255], v11, s[52:55], s66 offen offset:2048 sc1
    buffer_store_dwordx4 v[252:255], v11, s[52:55], s66 offen offset:3072 sc1
    s_mov_b32 s66, 16384
    buffer_store_dwordx4 v[252:255], v11, s[52:55], s66 offen offset:0 sc1
    buffer_store_dwordx4 v[252:255], v11, s[52:55], s66 offen offset:1024 sc1
    buffer_store_dwordx4 v[252:255], v11, s[52:55], s66 offen offset:2048 sc1
    buffer_store_dwordx4 v[252:255], v11, s[52:55], s66 offen offset:3072 sc1
    s_mov_b32 s66, 20480
    buffer_store_dwordx4 v[252:255], v11, s[52:55], s66 offen offset:0 sc1
    buffer_store_dwordx4 v[252:255], v11, s[52:55], s66 offen offset:1024 sc1
    buffer_store_dwordx4 v[252:255], v11, s[52:55], s66 offen offset:2048 sc1
    buffer_store_dwordx4 v[252:255], v11, s[52:55], s66 offen offset:3072 sc1
    s_mov_b32 s66, 24576
    buffer_store_dwordx4 v[252:255], v11, s[52:55], s66 offen offset:0 sc1
    buffer_store_dwordx4 v[252:255], v11, s[52:55], s66 offen offset:1024 sc1
    s_waitcnt vmcnt(0)
    v_mov_b32 v11, 1
    s_mov_b64 exec, 1
    buffer_store_dword v11, v7, s[60:63], 0 offen offset:128 sc1
    s_mov_b64 exec, -1
    s_branch L_h_z1
L_h_z1_ok:
    s_mul_i32 s66, s84, 7282
    s_lshr_b32 s66, s66, 16
    s_lshl_b32 s66, s66, 6
    s_add_u32 s66, s66, 24576
    v_mov_b32 v10, 1
    s_mov_b64 exec, 1
    buffer_atomic_add v10, v7, s[52:55], s66 offen sc1
    s_mov_b64 exec, -1
L_h_wo:
    s_mul_i32 s64, s30, 147456
    s_add_u32 s48, s12, s64
    s_addc_u32 s49, s13, 0
    s_mov_b32 s50, 147456
    s_mov_b32 s51, 0x20000
    v_lshrrev_b32 v8, 3, v3
    v_lshlrev_b32 v8, 2, v8
    v_add_u32 v8, v8, v2
    v_mul_u32_u24 v8, 4608, v8
    v_and_b32 v9, 7, v3
    v_lshl_add_u32 v8, v9, 4, v8
    s_mov_b32 s68, 0
    s_mov_b32 s67, 0
    s_mov_b32 s79, 0
L_h_woloop:
    s_lshr_b32 s64, s68, 2
    s_lshl_b32 s64, s64, 5
    s_and_b32 s65, s68, 3
    s_add_u32 s64, s64, s65
    s_mul_i32 s64, s64, 1152
    s_add_u32 m0, s67, 0
    s_add_u32 s66, s64, 0
    buffer_load_dwordx4 v8, s[48:51], s66 offen lds
    s_waitcnt vmcnt(10)
    s_add_u32 m0, s67, 1024
    s_add_u32 s66, s64, 128
    buffer_load_dwordx4 v8, s[48:51], s66 offen lds
    s_waitcnt vmcnt(10)
    s_add_u32 m0, s67, 2048
    s_add_u32 s66, s64, 256
    buffer_load_dwordx4 v8, s[48:51], s66 offen lds
    s_waitcnt vmcnt(10)
    s_add_u32 m0, s67, 3072
    s_add_u32 s66, s64, 384
    buffer_load_dwordx4 v8, s[48:51], s66 offen lds
    s_waitcnt vmcnt(10)
    s_add_u32 m0, s67, 4096
    s_add_u32 s66, s64, 512
    buffer_load_dwordx4 v8, s[48:51], s66 offen lds
    s_waitcnt vmcnt(10)
    s_add_u32 m0, s67, 5120
    s_add_u32 s66, s64, 640
    buffer_load_dwordx4 v8, s[48:51], s66 offen lds
    s_waitcnt vmcnt(10)
    s_add_u32 m0, s67, 6144
    s_add_u32 s66, s64, 768
    buffer_load_dwordx4 v8, s[48:51], s66 offen lds
    s_waitcnt vmcnt(10)
    s_add_u32 m0, s67, 7168
    s_add_u32 s66, s64, 896
    buffer_load_dwordx4 v8, s[48:51], s66 offen lds
    s_waitcnt vmcnt(10)
    s_add_u32 m0, s67, 8192
    s_add_u32 s66, s64, 1024
    buffer_load_dwordx4 v8, s[48:51], s66 offen lds
    s_waitcnt vmcnt(10)
    s_add_u32 s67, s67, 9216
    s_add_u32 s68, s68, 1
    s_cmp_lt_u32 s68, 16
    s_cbranch_scc1 L_h_woloop
    s_mov_b32 s76, 2000
L_h_z2:
    buffer_load_dword v11, v7, s[60:63], 0 offen offset:128 sc1
    s_waitcnt vmcnt(0)
    v_readfirstlane_b32 s64, v11
    s_nop 0
    s_cmp_lg_u32 s64, 0
    s_nop 2
    s_cbranch_scc1 L_h_z2_ok
    s_sleep 16
    s_sub_u32 s76, s76, 1
    s_cmp_lg_u32 s76, 0
    s_cbranch_scc1 L_h_z2
    v_mov_b32 v11, 1
    s_mov_b64 exec, 1
    buffer_atomic_add v11, v7, s[60:63], 0 offen sc0 sc1
    s_waitcnt vmcnt(0)
    v_readfirstlane_b32 s64, v11
    s_mov_b64 exec, -1
    s_cmp_lg_u32 s64, 0
    s_nop 2
    s_cbranch_scc1 L_h_z2
    v_mov_b32 v252, 0
    v_mov_b32 v253, 0
    v_mov_b32 v254, 0
    v_mov_b32 v255, 0
    v_lshlrev_b32 v11, 4, v1
    s_mov_b32 s66, 0
    buffer_store_dwordx4 v[252:255], v11, s[52:55], s66 offen offset:0 sc1
    buffer_store_dwordx4 v[252:255], v11, s[52:55], s66 offen offset:1024 sc1
    buffer_store_dwordx4 v[252:255], v11, s[52:55], s66 offen offset:2048 sc1
    buffer_store_dwordx4 v[252:255], v11, s[52:55], s66 offen offset:3072 sc1
    s_mov_b32 s66, 4096
    buffer_store_dwordx4 v[252:255], v11, s[52:55], s66 offen offset:0 sc1
    buffer_store_dwordx4 v[252:255], v11, s[52:55], s66 offen offset:1024 sc1
    buffer_store_dwordx4 v[252:255], v11, s[52:55], s66 offen offset:2048 sc1
    buffer_store_dwordx4 v[252:255], v11, s[52:55], s66 offen offset:3072 sc1
    s_mov_b32 s66, 8192
    buffer_store_dwordx4 v[252:255], v11, s[52:55], s66 offen offset:0 sc1
    buffer_store_dwordx4 v[252:255], v11, s[52:55], s66 offen offset:1024 sc1
    buffer_store_dwordx4 v[252:255], v11, s[52:55], s66 offen offset:2048 sc1
    buffer_store_dwordx4 v[252:255], v11, s[52:55], s66 offen offset:3072 sc1
    s_mov_b32 s66, 12288
    buffer_store_dwordx4 v[252:255], v11, s[52:55], s66 offen offset:0 sc1
    buffer_store_dwordx4 v[252:255], v11, s[52:55], s66 offen offset:1024 sc1
    buffer_store_dwordx4 v[252:255], v11, s[52:55], s66 offen offset:2048 sc1
    buffer_store_dwordx4 v[252:255], v11, s[52:55], s66 offen offset:3072 sc1
    s_mov_b32 s66, 16384
    buffer_store_dwordx4 v[252:255], v11, s[52:55], s66 offen offset:0 sc1
    buffer_store_dwordx4 v[252:255], v11, s[52:55], s66 offen offset:1024 sc1
    buffer_store_dwordx4 v[252:255], v11, s[52:55], s66 offen offset:2048 sc1
    buffer_store_dwordx4 v[252:255], v11, s[52:55], s66 offen offset:3072 sc1
    s_mov_b32 s66, 20480
    buffer_store_dwordx4 v[252:255], v11, s[52:55], s66 offen offset:0 sc1
    buffer_store_dwordx4 v[252:255], v11, s[52:55], s66 offen offset:1024 sc1
    buffer_store_dwordx4 v[252:255], v11, s[52:55], s66 offen offset:2048 sc1
    buffer_store_dwordx4 v[252:255], v11, s[52:55], s66 offen offset:3072 sc1
    s_mov_b32 s66, 24576
    buffer_store_dwordx4 v[252:255], v11, s[52:55], s66 offen offset:0 sc1
    buffer_store_dwordx4 v[252:255], v11, s[52:55], s66 offen offset:1024 sc1
    s_waitcnt vmcnt(0)
    v_mov_b32 v11, 1
    s_mov_b64 exec, 1
    buffer_store_dword v11, v7, s[60:63], 0 offen offset:128 sc1
    s_mov_b64 exec, -1
    s_branch L_h_z2
L_h_z2_ok:
    v_mov_b32 v10, 1
    s_mov_b32 s66, 25728
    s_mov_b64 exec, 1
    s_waitcnt vmcnt(0)
    buffer_atomic_add v10, v7, s[52:55], s66 offen sc0 sc1
    s_waitcnt vmcnt(0)
    v_readfirstlane_b32 s68, v10
    s_mov_b64 exec, -1
    s_cmp_lg_u32 s68, 255
    s_nop 2
    s_cbranch_scc1 L_h_noep
    v_lshlrev_b32 v8, 6, v1
    s_mov_b32 s66, 36864
    s_mov_b32 exec_lo, 0xffffffff
    s_mov_b32 exec_hi, 0x0
    buffer_load_dword v9, v8, s[52:55], s66 offen sc1
    s_waitcnt vmcnt(0)
    v_add_u32 v9, 1, v9
    buffer_store_dword v9, v8, s[52:55], s66 offen sc1
    s_mov_b64 exec, -1
    s_nop 0
L_h_noep:
    s_sub_u32 s84, s69, 144
    s_cmp_lt_u32 s84, 72
    s_cbranch_scc1 L_h_s2
    s_branch L_end
L_h_s2:
    s_mul_i32 s79, s84, 7282
    s_lshr_b32 s79, s79, 16
    s_mul_i32 s64, s79, 9
    s_sub_u32 s85, s84, s64
    s_mov_b32 s44, s20
    s_mov_b32 s45, s21
    s_mov_b32 s46, 5308416
    s_mov_b32 s47, 0x20000
    v_lshrrev_b32 v9, 3, v3
    v_lshlrev_b32 v9, 2, v9
    v_add_u32 v9, v9, v2
    v_mul_u32_u24 v9, 9216, v9
    v_and_b32 v11, 7, v3
    v_lshl_add_u32 v9, v11, 4, v9
    s_mul_i32 s64, s79, 663552
    s_lshl_b32 s65, s85, 7
    s_add_u32 s64, s64, s65
    v_add_u32 v9, s64, v9
    s_mov_b32 s66, 0
    buffer_load_dwordx4 v[12:15], v9, s[44:47], s66 offen nt
    s_mov_b32 s66, 1152
    buffer_load_dwordx4 v[16:19], v9, s[44:47], s66 offen nt
    s_mov_b32 s66, 2304
    buffer_load_dwordx4 v[20:23], v9, s[44:47], s66 offen nt
    s_mov_b32 s66, 3456
    buffer_load_dwordx4 v[24:27], v9, s[44:47], s66 offen nt
    s_mov_b32 s66, 4608
    buffer_load_dwordx4 v[28:31], v9, s[44:47], s66 offen nt
    s_mov_b32 s66, 5760
    buffer_load_dwordx4 v[32:35], v9, s[44:47], s66 offen nt
    s_mov_b32 s66, 6912
    buffer_load_dwordx4 v[36:39], v9, s[44:47], s66 offen nt
    s_mov_b32 s66, 8064
    buffer_load_dwordx4 v[40:43], v9, s[44:47], s66 offen nt
    s_mov_b32 s66, 73728
    buffer_load_dwordx4 v[44:47], v9, s[44:47], s66 offen nt
    s_mov_b32 s66, 74880
    buffer_load_dwordx4 v[48:51], v9, s[44:47], s66 offen nt
    s_mov_b32 s66, 76032
    buffer_load_dwordx4 v[52:55], v9, s[44:47], s66 offen nt
    s_mov_b32 s66, 77184
    buffer_load_dwordx4 v[56:59], v9, s[44:47], s66 offen nt
    s_mov_b32 s66, 78336
    buffer_load_dwordx4 v[60:63], v9, s[44:47], s66 offen nt
    s_mov_b32 s66, 79488
    buffer_load_dwordx4 v[64:67], v9, s[44:47], s66 offen nt
    s_mov_b32 s66, 80640
    buffer_load_dwordx4 v[68:71], v9, s[44:47], s66 offen nt
    s_mov_b32 s66, 81792
    buffer_load_dwordx4 v[72:75], v9, s[44:47], s66 offen nt
    s_mov_b32 s66, 147456
    buffer_load_dwordx4 v[76:79], v9, s[44:47], s66 offen nt
    s_mov_b32 s66, 148608
    buffer_load_dwordx4 v[80:83], v9, s[44:47], s66 offen nt
    s_mov_b32 s66, 149760
    buffer_load_dwordx4 v[84:87], v9, s[44:47], s66 offen nt
    s_mov_b32 s66, 150912
    buffer_load_dwordx4 v[88:91], v9, s[44:47], s66 offen nt
    s_mov_b32 s66, 152064
    buffer_load_dwordx4 v[92:95], v9, s[44:47], s66 offen nt
    s_mov_b32 s66, 153216
    buffer_load_dwordx4 v[96:99], v9, s[44:47], s66 offen nt
    s_mov_b32 s66, 154368
    buffer_load_dwordx4 v[100:103], v9, s[44:47], s66 offen nt
    s_mov_b32 s66, 155520
    buffer_load_dwordx4 v[104:107], v9, s[44:47], s66 offen nt
    s_lshl_b32 s67, s79, 6
    s_add_u32 s67, s67, 24576
L_h_hf:
    buffer_load_dword v11, v7, s[52:55], s67 offen offset:0 sc1
    s_waitcnt vmcnt(0)
    v_readfirstlane_b32 s64, v11
    s_nop 0
    s_cmp_ge_u32 s64, 18
    s_nop 2
    s_cbranch_scc1 L_h_hf_ok
    s_sleep 16
    s_branch L_h_hf
L_h_hf_ok:
    v_lshrrev_b32 v8, 3, v3
    v_lshlrev_b32 v8, 10, v8
    v_lshl_add_u32 v8, v1, 4, v8
    s_mul_i32 s66, s79, 36864
    s_add_u32 s66, s66, 196608
    buffer_load_dwordx4 v[172:175], v8, s[52:55], s66 offen sc1
    buffer_load_dwordx4 v[208:211], v8, s[52:55], s66 offen offset:2048 sc1
    s_add_u32 s66, s66, 4096
    buffer_load_dwordx4 v[176:179], v8, s[52:55], s66 offen sc1
    buffer_load_dwordx4 v[212:215], v8, s[52:55], s66 offen offset:2048 sc1
    s_add_u32 s66, s66, 4096
    buffer_load_dwordx4 v[180:183], v8, s[52:55], s66 offen sc1
    buffer_load_dwordx4 v[216:219], v8, s[52:55], s66 offen offset:2048 sc1
    s_add_u32 s66, s66, 4096
    buffer_load_dwordx4 v[184:187], v8, s[52:55], s66 offen sc1
    buffer_load_dwordx4 v[220:223], v8, s[52:55], s66 offen offset:2048 sc1
    s_add_u32 s66, s66, 4096
    buffer_load_dwordx4 v[188:191], v8, s[52:55], s66 offen sc1
    buffer_load_dwordx4 v[224:227], v8, s[52:55], s66 offen offset:2048 sc1
    s_add_u32 s66, s66, 4096
    buffer_load_dwordx4 v[192:195], v8, s[52:55], s66 offen sc1
    buffer_load_dwordx4 v[228:231], v8, s[52:55], s66 offen offset:2048 sc1
    s_add_u32 s66, s66, 4096
    buffer_load_dwordx4 v[196:199], v8, s[52:55], s66 offen sc1
    buffer_load_dwordx4 v[232:235], v8, s[52:55], s66 offen offset:2048 sc1
    s_add_u32 s66, s66, 4096
    buffer_load_dwordx4 v[200:203], v8, s[52:55], s66 offen sc1
    buffer_load_dwordx4 v[236:239], v8, s[52:55], s66 offen offset:2048 sc1
    s_add_u32 s66, s66, 4096
    buffer_load_dwordx4 v[204:207], v8, s[52:55], s66 offen sc1
    buffer_load_dwordx4 v[240:243], v8, s[52:55], s66 offen offset:2048 sc1
    s_waitcnt vmcnt(16)
    v_lshlrev_b32 v248, 16, v172
    v_and_b32 v249, 0xffff0000, v172
    v_lshlrev_b32 v250, 16, v208
    v_and_b32 v251, 0xffff0000, v208
    v_mul_f32 v252, 0xbfb8aa3b, v248
    v_exp_f32 v252, v252
    s_nop 0
    v_add_f32 v252, 1.0, v252
    v_rcp_f32 v252, v252
    s_nop 0
    v_mul_f32 v248, v248, v252
    v_mul_f32 v253, 0xbfb8aa3b, v249
    v_exp_f32 v253, v253
    s_nop 0
    v_add_f32 v253, 1.0, v253
    v_rcp_f32 v253, v253
    s_nop 0
    v_mul_f32 v249, v249, v253
    v_cvt_pk_bf16_f32 v249, v248, v249
    v_lshlrev_b32 v248, 16, v249
    v_and_b32 v249, 0xffff0000, v249
    v_mul_f32 v248, v248, v250
    v_mul_f32 v249, v249, v251
    v_cvt_pk_bf16_f32 v172, v248, v249
    v_lshlrev_b32 v248, 16, v173
    v_and_b32 v249, 0xffff0000, v173
    v_lshlrev_b32 v250, 16, v209
    v_and_b32 v251, 0xffff0000, v209
    v_mul_f32 v252, 0xbfb8aa3b, v248
    v_exp_f32 v252, v252
    s_nop 0
    v_add_f32 v252, 1.0, v252
    v_rcp_f32 v252, v252
    s_nop 0
    v_mul_f32 v248, v248, v252
    v_mul_f32 v253, 0xbfb8aa3b, v249
    v_exp_f32 v253, v253
    s_nop 0
    v_add_f32 v253, 1.0, v253
    v_rcp_f32 v253, v253
    s_nop 0
    v_mul_f32 v249, v249, v253
    v_cvt_pk_bf16_f32 v249, v248, v249
    v_lshlrev_b32 v248, 16, v249
    v_and_b32 v249, 0xffff0000, v249
    v_mul_f32 v248, v248, v250
    v_mul_f32 v249, v249, v251
    v_cvt_pk_bf16_f32 v173, v248, v249
    v_lshlrev_b32 v248, 16, v174
    v_and_b32 v249, 0xffff0000, v174
    v_lshlrev_b32 v250, 16, v210
    v_and_b32 v251, 0xffff0000, v210
    v_mul_f32 v252, 0xbfb8aa3b, v248
    v_exp_f32 v252, v252
    s_nop 0
    v_add_f32 v252, 1.0, v252
    v_rcp_f32 v252, v252
    s_nop 0
    v_mul_f32 v248, v248, v252
    v_mul_f32 v253, 0xbfb8aa3b, v249
    v_exp_f32 v253, v253
    s_nop 0
    v_add_f32 v253, 1.0, v253
    v_rcp_f32 v253, v253
    s_nop 0
    v_mul_f32 v249, v249, v253
    v_cvt_pk_bf16_f32 v249, v248, v249
    v_lshlrev_b32 v248, 16, v249
    v_and_b32 v249, 0xffff0000, v249
    v_mul_f32 v248, v248, v250
    v_mul_f32 v249, v249, v251
    v_cvt_pk_bf16_f32 v174, v248, v249
    v_lshlrev_b32 v248, 16, v175
    v_and_b32 v249, 0xffff0000, v175
    v_lshlrev_b32 v250, 16, v211
    v_and_b32 v251, 0xffff0000, v211
    v_mul_f32 v252, 0xbfb8aa3b, v248
    v_exp_f32 v252, v252
    s_nop 0
    v_add_f32 v252, 1.0, v252
    v_rcp_f32 v252, v252
    s_nop 0
    v_mul_f32 v248, v248, v252
    v_mul_f32 v253, 0xbfb8aa3b, v249
    v_exp_f32 v253, v253
    s_nop 0
    v_add_f32 v253, 1.0, v253
    v_rcp_f32 v253, v253
    s_nop 0
    v_mul_f32 v249, v249, v253
    v_cvt_pk_bf16_f32 v249, v248, v249
    v_lshlrev_b32 v248, 16, v249
    v_and_b32 v249, 0xffff0000, v249
    v_mul_f32 v248, v248, v250
    v_mul_f32 v249, v249, v251
    v_cvt_pk_bf16_f32 v175, v248, v249
    s_waitcnt vmcnt(14)
    v_lshlrev_b32 v248, 16, v176
    v_and_b32 v249, 0xffff0000, v176
    v_lshlrev_b32 v250, 16, v212
    v_and_b32 v251, 0xffff0000, v212
    v_mul_f32 v252, 0xbfb8aa3b, v248
    v_exp_f32 v252, v252
    s_nop 0
    v_add_f32 v252, 1.0, v252
    v_rcp_f32 v252, v252
    s_nop 0
    v_mul_f32 v248, v248, v252
    v_mul_f32 v253, 0xbfb8aa3b, v249
    v_exp_f32 v253, v253
    s_nop 0
    v_add_f32 v253, 1.0, v253
    v_rcp_f32 v253, v253
    s_nop 0
    v_mul_f32 v249, v249, v253
    v_cvt_pk_bf16_f32 v249, v248, v249
    v_lshlrev_b32 v248, 16, v249
    v_and_b32 v249, 0xffff0000, v249
    v_mul_f32 v248, v248, v250
    v_mul_f32 v249, v249, v251
    v_cvt_pk_bf16_f32 v176, v248, v249
    v_lshlrev_b32 v248, 16, v177
    v_and_b32 v249, 0xffff0000, v177
    v_lshlrev_b32 v250, 16, v213
    v_and_b32 v251, 0xffff0000, v213
    v_mul_f32 v252, 0xbfb8aa3b, v248
    v_exp_f32 v252, v252
    s_nop 0
    v_add_f32 v252, 1.0, v252
    v_rcp_f32 v252, v252
    s_nop 0
    v_mul_f32 v248, v248, v252
    v_mul_f32 v253, 0xbfb8aa3b, v249
    v_exp_f32 v253, v253
    s_nop 0
    v_add_f32 v253, 1.0, v253
    v_rcp_f32 v253, v253
    s_nop 0
    v_mul_f32 v249, v249, v253
    v_cvt_pk_bf16_f32 v249, v248, v249
    v_lshlrev_b32 v248, 16, v249
    v_and_b32 v249, 0xffff0000, v249
    v_mul_f32 v248, v248, v250
    v_mul_f32 v249, v249, v251
    v_cvt_pk_bf16_f32 v177, v248, v249
    v_lshlrev_b32 v248, 16, v178
    v_and_b32 v249, 0xffff0000, v178
    v_lshlrev_b32 v250, 16, v214
    v_and_b32 v251, 0xffff0000, v214
    v_mul_f32 v252, 0xbfb8aa3b, v248
    v_exp_f32 v252, v252
    s_nop 0
    v_add_f32 v252, 1.0, v252
    v_rcp_f32 v252, v252
    s_nop 0
    v_mul_f32 v248, v248, v252
    v_mul_f32 v253, 0xbfb8aa3b, v249
    v_exp_f32 v253, v253
    s_nop 0
    v_add_f32 v253, 1.0, v253
    v_rcp_f32 v253, v253
    s_nop 0
    v_mul_f32 v249, v249, v253
    v_cvt_pk_bf16_f32 v249, v248, v249
    v_lshlrev_b32 v248, 16, v249
    v_and_b32 v249, 0xffff0000, v249
    v_mul_f32 v248, v248, v250
    v_mul_f32 v249, v249, v251
    v_cvt_pk_bf16_f32 v178, v248, v249
    v_lshlrev_b32 v248, 16, v179
    v_and_b32 v249, 0xffff0000, v179
    v_lshlrev_b32 v250, 16, v215
    v_and_b32 v251, 0xffff0000, v215
    v_mul_f32 v252, 0xbfb8aa3b, v248
    v_exp_f32 v252, v252
    s_nop 0
    v_add_f32 v252, 1.0, v252
    v_rcp_f32 v252, v252
    s_nop 0
    v_mul_f32 v248, v248, v252
    v_mul_f32 v253, 0xbfb8aa3b, v249
    v_exp_f32 v253, v253
    s_nop 0
    v_add_f32 v253, 1.0, v253
    v_rcp_f32 v253, v253
    s_nop 0
    v_mul_f32 v249, v249, v253
    v_cvt_pk_bf16_f32 v249, v248, v249
    v_lshlrev_b32 v248, 16, v249
    v_and_b32 v249, 0xffff0000, v249
    v_mul_f32 v248, v248, v250
    v_mul_f32 v249, v249, v251
    v_cvt_pk_bf16_f32 v179, v248, v249
    s_waitcnt vmcnt(12)
    v_lshlrev_b32 v248, 16, v180
    v_and_b32 v249, 0xffff0000, v180
    v_lshlrev_b32 v250, 16, v216
    v_and_b32 v251, 0xffff0000, v216
    v_mul_f32 v252, 0xbfb8aa3b, v248
    v_exp_f32 v252, v252
    s_nop 0
    v_add_f32 v252, 1.0, v252
    v_rcp_f32 v252, v252
    s_nop 0
    v_mul_f32 v248, v248, v252
    v_mul_f32 v253, 0xbfb8aa3b, v249
    v_exp_f32 v253, v253
    s_nop 0
    v_add_f32 v253, 1.0, v253
    v_rcp_f32 v253, v253
    s_nop 0
    v_mul_f32 v249, v249, v253
    v_cvt_pk_bf16_f32 v249, v248, v249
    v_lshlrev_b32 v248, 16, v249
    v_and_b32 v249, 0xffff0000, v249
    v_mul_f32 v248, v248, v250
    v_mul_f32 v249, v249, v251
    v_cvt_pk_bf16_f32 v180, v248, v249
    v_lshlrev_b32 v248, 16, v181
    v_and_b32 v249, 0xffff0000, v181
    v_lshlrev_b32 v250, 16, v217
    v_and_b32 v251, 0xffff0000, v217
    v_mul_f32 v252, 0xbfb8aa3b, v248
    v_exp_f32 v252, v252
    s_nop 0
    v_add_f32 v252, 1.0, v252
    v_rcp_f32 v252, v252
    s_nop 0
    v_mul_f32 v248, v248, v252
    v_mul_f32 v253, 0xbfb8aa3b, v249
    v_exp_f32 v253, v253
    s_nop 0
    v_add_f32 v253, 1.0, v253
    v_rcp_f32 v253, v253
    s_nop 0
    v_mul_f32 v249, v249, v253
    v_cvt_pk_bf16_f32 v249, v248, v249
    v_lshlrev_b32 v248, 16, v249
    v_and_b32 v249, 0xffff0000, v249
    v_mul_f32 v248, v248, v250
    v_mul_f32 v249, v249, v251
    v_cvt_pk_bf16_f32 v181, v248, v249
    v_lshlrev_b32 v248, 16, v182
    v_and_b32 v249, 0xffff0000, v182
    v_lshlrev_b32 v250, 16, v218
    v_and_b32 v251, 0xffff0000, v218
    v_mul_f32 v252, 0xbfb8aa3b, v248
    v_exp_f32 v252, v252
    s_nop 0
    v_add_f32 v252, 1.0, v252
    v_rcp_f32 v252, v252
    s_nop 0
    v_mul_f32 v248, v248, v252
    v_mul_f32 v253, 0xbfb8aa3b, v249
    v_exp_f32 v253, v253
    s_nop 0
    v_add_f32 v253, 1.0, v253
    v_rcp_f32 v253, v253
    s_nop 0
    v_mul_f32 v249, v249, v253
    v_cvt_pk_bf16_f32 v249, v248, v249
    v_lshlrev_b32 v248, 16, v249
    v_and_b32 v249, 0xffff0000, v249
    v_mul_f32 v248, v248, v250
    v_mul_f32 v249, v249, v251
    v_cvt_pk_bf16_f32 v182, v248, v249
    v_lshlrev_b32 v248, 16, v183
    v_and_b32 v249, 0xffff0000, v183
    v_lshlrev_b32 v250, 16, v219
    v_and_b32 v251, 0xffff0000, v219
    v_mul_f32 v252, 0xbfb8aa3b, v248
    v_exp_f32 v252, v252
    s_nop 0
    v_add_f32 v252, 1.0, v252
    v_rcp_f32 v252, v252
    s_nop 0
    v_mul_f32 v248, v248, v252
    v_mul_f32 v253, 0xbfb8aa3b, v249
    v_exp_f32 v253, v253
    s_nop 0
    v_add_f32 v253, 1.0, v253
    v_rcp_f32 v253, v253
    s_nop 0
    v_mul_f32 v249, v249, v253
    v_cvt_pk_bf16_f32 v249, v248, v249
    v_lshlrev_b32 v248, 16, v249
    v_and_b32 v249, 0xffff0000, v249
    v_mul_f32 v248, v248, v250
    v_mul_f32 v249, v249, v251
    v_cvt_pk_bf16_f32 v183, v248, v249
    s_waitcnt vmcnt(10)
    v_lshlrev_b32 v248, 16, v184
    v_and_b32 v249, 0xffff0000, v184
    v_lshlrev_b32 v250, 16, v220
    v_and_b32 v251, 0xffff0000, v220
    v_mul_f32 v252, 0xbfb8aa3b, v248
    v_exp_f32 v252, v252
    s_nop 0
    v_add_f32 v252, 1.0, v252
    v_rcp_f32 v252, v252
    s_nop 0
    v_mul_f32 v248, v248, v252
    v_mul_f32 v253, 0xbfb8aa3b, v249
    v_exp_f32 v253, v253
    s_nop 0
    v_add_f32 v253, 1.0, v253
    v_rcp_f32 v253, v253
    s_nop 0
    v_mul_f32 v249, v249, v253
    v_cvt_pk_bf16_f32 v249, v248, v249
    v_lshlrev_b32 v248, 16, v249
    v_and_b32 v249, 0xffff0000, v249
    v_mul_f32 v248, v248, v250
    v_mul_f32 v249, v249, v251
    v_cvt_pk_bf16_f32 v184, v248, v249
    v_lshlrev_b32 v248, 16, v185
    v_and_b32 v249, 0xffff0000, v185
    v_lshlrev_b32 v250, 16, v221
    v_and_b32 v251, 0xffff0000, v221
    v_mul_f32 v252, 0xbfb8aa3b, v248
    v_exp_f32 v252, v252
    s_nop 0
    v_add_f32 v252, 1.0, v252
    v_rcp_f32 v252, v252
    s_nop 0
    v_mul_f32 v248, v248, v252
    v_mul_f32 v253, 0xbfb8aa3b, v249
    v_exp_f32 v253, v253
    s_nop 0
    v_add_f32 v253, 1.0, v253
    v_rcp_f32 v253, v253
    s_nop 0
    v_mul_f32 v249, v249, v253
    v_cvt_pk_bf16_f32 v249, v248, v249
    v_lshlrev_b32 v248, 16, v249
    v_and_b32 v249, 0xffff0000, v249
    v_mul_f32 v248, v248, v250
    v_mul_f32 v249, v249, v251
    v_cvt_pk_bf16_f32 v185, v248, v249
    v_lshlrev_b32 v248, 16, v186
    v_and_b32 v249, 0xffff0000, v186
    v_lshlrev_b32 v250, 16, v222
    v_and_b32 v251, 0xffff0000, v222
    v_mul_f32 v252, 0xbfb8aa3b, v248
    v_exp_f32 v252, v252
    s_nop 0
    v_add_f32 v252, 1.0, v252
    v_rcp_f32 v252, v252
    s_nop 0
    v_mul_f32 v248, v248, v252
    v_mul_f32 v253, 0xbfb8aa3b, v249
    v_exp_f32 v253, v253
    s_nop 0
    v_add_f32 v253, 1.0, v253
    v_rcp_f32 v253, v253
    s_nop 0
    v_mul_f32 v249, v249, v253
    v_cvt_pk_bf16_f32 v249, v248, v249
    v_lshlrev_b32 v248, 16, v249
    v_and_b32 v249, 0xffff0000, v249
    v_mul_f32 v248, v248, v250
    v_mul_f32 v249, v249, v251
    v_cvt_pk_bf16_f32 v186, v248, v249
    v_lshlrev_b32 v248, 16, v187
    v_and_b32 v249, 0xffff0000, v187
    v_lshlrev_b32 v250, 16, v223
    v_and_b32 v251, 0xffff0000, v223
    v_mul_f32 v252, 0xbfb8aa3b, v248
    v_exp_f32 v252, v252
    s_nop 0
    v_add_f32 v252, 1.0, v252
    v_rcp_f32 v252, v252
    s_nop 0
    v_mul_f32 v248, v248, v252
    v_mul_f32 v253, 0xbfb8aa3b, v249
    v_exp_f32 v253, v253
    s_nop 0
    v_add_f32 v253, 1.0, v253
    v_rcp_f32 v253, v253
    s_nop 0
    v_mul_f32 v249, v249, v253
    v_cvt_pk_bf16_f32 v249, v248, v249
    v_lshlrev_b32 v248, 16, v249
    v_and_b32 v249, 0xffff0000, v249
    v_mul_f32 v248, v248, v250
    v_mul_f32 v249, v249, v251
    v_cvt_pk_bf16_f32 v187, v248, v249
    s_waitcnt vmcnt(8)
    v_lshlrev_b32 v248, 16, v188
    v_and_b32 v249, 0xffff0000, v188
    v_lshlrev_b32 v250, 16, v224
    v_and_b32 v251, 0xffff0000, v224
    v_mul_f32 v252, 0xbfb8aa3b, v248
    v_exp_f32 v252, v252
    s_nop 0
    v_add_f32 v252, 1.0, v252
    v_rcp_f32 v252, v252
    s_nop 0
    v_mul_f32 v248, v248, v252
    v_mul_f32 v253, 0xbfb8aa3b, v249
    v_exp_f32 v253, v253
    s_nop 0
    v_add_f32 v253, 1.0, v253
    v_rcp_f32 v253, v253
    s_nop 0
    v_mul_f32 v249, v249, v253
    v_cvt_pk_bf16_f32 v249, v248, v249
    v_lshlrev_b32 v248, 16, v249
    v_and_b32 v249, 0xffff0000, v249
    v_mul_f32 v248, v248, v250
    v_mul_f32 v249, v249, v251
    v_cvt_pk_bf16_f32 v188, v248, v249
    v_lshlrev_b32 v248, 16, v189
    v_and_b32 v249, 0xffff0000, v189
    v_lshlrev_b32 v250, 16, v225
    v_and_b32 v251, 0xffff0000, v225
    v_mul_f32 v252, 0xbfb8aa3b, v248
    v_exp_f32 v252, v252
    s_nop 0
    v_add_f32 v252, 1.0, v252
    v_rcp_f32 v252, v252
    s_nop 0
    v_mul_f32 v248, v248, v252
    v_mul_f32 v253, 0xbfb8aa3b, v249
    v_exp_f32 v253, v253
    s_nop 0
    v_add_f32 v253, 1.0, v253
    v_rcp_f32 v253, v253
    s_nop 0
    v_mul_f32 v249, v249, v253
    v_cvt_pk_bf16_f32 v249, v248, v249
    v_lshlrev_b32 v248, 16, v249
    v_and_b32 v249, 0xffff0000, v249
    v_mul_f32 v248, v248, v250
    v_mul_f32 v249, v249, v251
    v_cvt_pk_bf16_f32 v189, v248, v249
    v_lshlrev_b32 v248, 16, v190
    v_and_b32 v249, 0xffff0000, v190
    v_lshlrev_b32 v250, 16, v226
    v_and_b32 v251, 0xffff0000, v226
    v_mul_f32 v252, 0xbfb8aa3b, v248
    v_exp_f32 v252, v252
    s_nop 0
    v_add_f32 v252, 1.0, v252
    v_rcp_f32 v252, v252
    s_nop 0
    v_mul_f32 v248, v248, v252
    v_mul_f32 v253, 0xbfb8aa3b, v249
    v_exp_f32 v253, v253
    s_nop 0
    v_add_f32 v253, 1.0, v253
    v_rcp_f32 v253, v253
    s_nop 0
    v_mul_f32 v249, v249, v253
    v_cvt_pk_bf16_f32 v249, v248, v249
    v_lshlrev_b32 v248, 16, v249
    v_and_b32 v249, 0xffff0000, v249
    v_mul_f32 v248, v248, v250
    v_mul_f32 v249, v249, v251
    v_cvt_pk_bf16_f32 v190, v248, v249
    v_lshlrev_b32 v248, 16, v191
    v_and_b32 v249, 0xffff0000, v191
    v_lshlrev_b32 v250, 16, v227
    v_and_b32 v251, 0xffff0000, v227
    v_mul_f32 v252, 0xbfb8aa3b, v248
    v_exp_f32 v252, v252
    s_nop 0
    v_add_f32 v252, 1.0, v252
    v_rcp_f32 v252, v252
    s_nop 0
    v_mul_f32 v248, v248, v252
    v_mul_f32 v253, 0xbfb8aa3b, v249
    v_exp_f32 v253, v253
    s_nop 0
    v_add_f32 v253, 1.0, v253
    v_rcp_f32 v253, v253
    s_nop 0
    v_mul_f32 v249, v249, v253
    v_cvt_pk_bf16_f32 v249, v248, v249
    v_lshlrev_b32 v248, 16, v249
    v_and_b32 v249, 0xffff0000, v249
    v_mul_f32 v248, v248, v250
    v_mul_f32 v249, v249, v251
    v_cvt_pk_bf16_f32 v191, v248, v249
    s_waitcnt vmcnt(6)
    v_lshlrev_b32 v248, 16, v192
    v_and_b32 v249, 0xffff0000, v192
    v_lshlrev_b32 v250, 16, v228
    v_and_b32 v251, 0xffff0000, v228
    v_mul_f32 v252, 0xbfb8aa3b, v248
    v_exp_f32 v252, v252
    s_nop 0
    v_add_f32 v252, 1.0, v252
    v_rcp_f32 v252, v252
    s_nop 0
    v_mul_f32 v248, v248, v252
    v_mul_f32 v253, 0xbfb8aa3b, v249
    v_exp_f32 v253, v253
    s_nop 0
    v_add_f32 v253, 1.0, v253
    v_rcp_f32 v253, v253
    s_nop 0
    v_mul_f32 v249, v249, v253
    v_cvt_pk_bf16_f32 v249, v248, v249
    v_lshlrev_b32 v248, 16, v249
    v_and_b32 v249, 0xffff0000, v249
    v_mul_f32 v248, v248, v250
    v_mul_f32 v249, v249, v251
    v_cvt_pk_bf16_f32 v192, v248, v249
    v_lshlrev_b32 v248, 16, v193
    v_and_b32 v249, 0xffff0000, v193
    v_lshlrev_b32 v250, 16, v229
    v_and_b32 v251, 0xffff0000, v229
    v_mul_f32 v252, 0xbfb8aa3b, v248
    v_exp_f32 v252, v252
    s_nop 0
    v_add_f32 v252, 1.0, v252
    v_rcp_f32 v252, v252
    s_nop 0
    v_mul_f32 v248, v248, v252
    v_mul_f32 v253, 0xbfb8aa3b, v249
    v_exp_f32 v253, v253
    s_nop 0
    v_add_f32 v253, 1.0, v253
    v_rcp_f32 v253, v253
    s_nop 0
    v_mul_f32 v249, v249, v253
    v_cvt_pk_bf16_f32 v249, v248, v249
    v_lshlrev_b32 v248, 16, v249
    v_and_b32 v249, 0xffff0000, v249
    v_mul_f32 v248, v248, v250
    v_mul_f32 v249, v249, v251
    v_cvt_pk_bf16_f32 v193, v248, v249
    v_lshlrev_b32 v248, 16, v194
    v_and_b32 v249, 0xffff0000, v194
    v_lshlrev_b32 v250, 16, v230
    v_and_b32 v251, 0xffff0000, v230
    v_mul_f32 v252, 0xbfb8aa3b, v248
    v_exp_f32 v252, v252
    s_nop 0
    v_add_f32 v252, 1.0, v252
    v_rcp_f32 v252, v252
    s_nop 0
    v_mul_f32 v248, v248, v252
    v_mul_f32 v253, 0xbfb8aa3b, v249
    v_exp_f32 v253, v253
    s_nop 0
    v_add_f32 v253, 1.0, v253
    v_rcp_f32 v253, v253
    s_nop 0
    v_mul_f32 v249, v249, v253
    v_cvt_pk_bf16_f32 v249, v248, v249
    v_lshlrev_b32 v248, 16, v249
    v_and_b32 v249, 0xffff0000, v249
    v_mul_f32 v248, v248, v250
    v_mul_f32 v249, v249, v251
    v_cvt_pk_bf16_f32 v194, v248, v249
    v_lshlrev_b32 v248, 16, v195
    v_and_b32 v249, 0xffff0000, v195
    v_lshlrev_b32 v250, 16, v231
    v_and_b32 v251, 0xffff0000, v231
    v_mul_f32 v252, 0xbfb8aa3b, v248
    v_exp_f32 v252, v252
    s_nop 0
    v_add_f32 v252, 1.0, v252
    v_rcp_f32 v252, v252
    s_nop 0
    v_mul_f32 v248, v248, v252
    v_mul_f32 v253, 0xbfb8aa3b, v249
    v_exp_f32 v253, v253
    s_nop 0
    v_add_f32 v253, 1.0, v253
    v_rcp_f32 v253, v253
    s_nop 0
    v_mul_f32 v249, v249, v253
    v_cvt_pk_bf16_f32 v249, v248, v249
    v_lshlrev_b32 v248, 16, v249
    v_and_b32 v249, 0xffff0000, v249
    v_mul_f32 v248, v248, v250
    v_mul_f32 v249, v249, v251
    v_cvt_pk_bf16_f32 v195, v248, v249
    s_waitcnt vmcnt(4)
    v_lshlrev_b32 v248, 16, v196
    v_and_b32 v249, 0xffff0000, v196
    v_lshlrev_b32 v250, 16, v232
    v_and_b32 v251, 0xffff0000, v232
    v_mul_f32 v252, 0xbfb8aa3b, v248
    v_exp_f32 v252, v252
    s_nop 0
    v_add_f32 v252, 1.0, v252
    v_rcp_f32 v252, v252
    s_nop 0
    v_mul_f32 v248, v248, v252
    v_mul_f32 v253, 0xbfb8aa3b, v249
    v_exp_f32 v253, v253
    s_nop 0
    v_add_f32 v253, 1.0, v253
    v_rcp_f32 v253, v253
    s_nop 0
    v_mul_f32 v249, v249, v253
    v_cvt_pk_bf16_f32 v249, v248, v249
    v_lshlrev_b32 v248, 16, v249
    v_and_b32 v249, 0xffff0000, v249
    v_mul_f32 v248, v248, v250
    v_mul_f32 v249, v249, v251
    v_cvt_pk_bf16_f32 v196, v248, v249
    v_lshlrev_b32 v248, 16, v197
    v_and_b32 v249, 0xffff0000, v197
    v_lshlrev_b32 v250, 16, v233
    v_and_b32 v251, 0xffff0000, v233
    v_mul_f32 v252, 0xbfb8aa3b, v248
    v_exp_f32 v252, v252
    s_nop 0
    v_add_f32 v252, 1.0, v252
    v_rcp_f32 v252, v252
    s_nop 0
    v_mul_f32 v248, v248, v252
    v_mul_f32 v253, 0xbfb8aa3b, v249
    v_exp_f32 v253, v253
    s_nop 0
    v_add_f32 v253, 1.0, v253
    v_rcp_f32 v253, v253
    s_nop 0
    v_mul_f32 v249, v249, v253
    v_cvt_pk_bf16_f32 v249, v248, v249
    v_lshlrev_b32 v248, 16, v249
    v_and_b32 v249, 0xffff0000, v249
    v_mul_f32 v248, v248, v250
    v_mul_f32 v249, v249, v251
    v_cvt_pk_bf16_f32 v197, v248, v249
    v_lshlrev_b32 v248, 16, v198
    v_and_b32 v249, 0xffff0000, v198
    v_lshlrev_b32 v250, 16, v234
    v_and_b32 v251, 0xffff0000, v234
    v_mul_f32 v252, 0xbfb8aa3b, v248
    v_exp_f32 v252, v252
    s_nop 0
    v_add_f32 v252, 1.0, v252
    v_rcp_f32 v252, v252
    s_nop 0
    v_mul_f32 v248, v248, v252
    v_mul_f32 v253, 0xbfb8aa3b, v249
    v_exp_f32 v253, v253
    s_nop 0
    v_add_f32 v253, 1.0, v253
    v_rcp_f32 v253, v253
    s_nop 0
    v_mul_f32 v249, v249, v253
    v_cvt_pk_bf16_f32 v249, v248, v249
    v_lshlrev_b32 v248, 16, v249
    v_and_b32 v249, 0xffff0000, v249
    v_mul_f32 v248, v248, v250
    v_mul_f32 v249, v249, v251
    v_cvt_pk_bf16_f32 v198, v248, v249
    v_lshlrev_b32 v248, 16, v199
    v_and_b32 v249, 0xffff0000, v199
    v_lshlrev_b32 v250, 16, v235
    v_and_b32 v251, 0xffff0000, v235
    v_mul_f32 v252, 0xbfb8aa3b, v248
    v_exp_f32 v252, v252
    s_nop 0
    v_add_f32 v252, 1.0, v252
    v_rcp_f32 v252, v252
    s_nop 0
    v_mul_f32 v248, v248, v252
    v_mul_f32 v253, 0xbfb8aa3b, v249
    v_exp_f32 v253, v253
    s_nop 0
    v_add_f32 v253, 1.0, v253
    v_rcp_f32 v253, v253
    s_nop 0
    v_mul_f32 v249, v249, v253
    v_cvt_pk_bf16_f32 v249, v248, v249
    v_lshlrev_b32 v248, 16, v249
    v_and_b32 v249, 0xffff0000, v249
    v_mul_f32 v248, v248, v250
    v_mul_f32 v249, v249, v251
    v_cvt_pk_bf16_f32 v199, v248, v249
    s_waitcnt vmcnt(2)
    v_lshlrev_b32 v248, 16, v200
    v_and_b32 v249, 0xffff0000, v200
    v_lshlrev_b32 v250, 16, v236
    v_and_b32 v251, 0xffff0000, v236
    v_mul_f32 v252, 0xbfb8aa3b, v248
    v_exp_f32 v252, v252
    s_nop 0
    v_add_f32 v252, 1.0, v252
    v_rcp_f32 v252, v252
    s_nop 0
    v_mul_f32 v248, v248, v252
    v_mul_f32 v253, 0xbfb8aa3b, v249
    v_exp_f32 v253, v253
    s_nop 0
    v_add_f32 v253, 1.0, v253
    v_rcp_f32 v253, v253
    s_nop 0
    v_mul_f32 v249, v249, v253
    v_cvt_pk_bf16_f32 v249, v248, v249
    v_lshlrev_b32 v248, 16, v249
    v_and_b32 v249, 0xffff0000, v249
    v_mul_f32 v248, v248, v250
    v_mul_f32 v249, v249, v251
    v_cvt_pk_bf16_f32 v200, v248, v249
    v_lshlrev_b32 v248, 16, v201
    v_and_b32 v249, 0xffff0000, v201
    v_lshlrev_b32 v250, 16, v237
    v_and_b32 v251, 0xffff0000, v237
    v_mul_f32 v252, 0xbfb8aa3b, v248
    v_exp_f32 v252, v252
    s_nop 0
    v_add_f32 v252, 1.0, v252
    v_rcp_f32 v252, v252
    s_nop 0
    v_mul_f32 v248, v248, v252
    v_mul_f32 v253, 0xbfb8aa3b, v249
    v_exp_f32 v253, v253
    s_nop 0
    v_add_f32 v253, 1.0, v253
    v_rcp_f32 v253, v253
    s_nop 0
    v_mul_f32 v249, v249, v253
    v_cvt_pk_bf16_f32 v249, v248, v249
    v_lshlrev_b32 v248, 16, v249
    v_and_b32 v249, 0xffff0000, v249
    v_mul_f32 v248, v248, v250
    v_mul_f32 v249, v249, v251
    v_cvt_pk_bf16_f32 v201, v248, v249
    v_lshlrev_b32 v248, 16, v202
    v_and_b32 v249, 0xffff0000, v202
    v_lshlrev_b32 v250, 16, v238
    v_and_b32 v251, 0xffff0000, v238
    v_mul_f32 v252, 0xbfb8aa3b, v248
    v_exp_f32 v252, v252
    s_nop 0
    v_add_f32 v252, 1.0, v252
    v_rcp_f32 v252, v252
    s_nop 0
    v_mul_f32 v248, v248, v252
    v_mul_f32 v253, 0xbfb8aa3b, v249
    v_exp_f32 v253, v253
    s_nop 0
    v_add_f32 v253, 1.0, v253
    v_rcp_f32 v253, v253
    s_nop 0
    v_mul_f32 v249, v249, v253
    v_cvt_pk_bf16_f32 v249, v248, v249
    v_lshlrev_b32 v248, 16, v249
    v_and_b32 v249, 0xffff0000, v249
    v_mul_f32 v248, v248, v250
    v_mul_f32 v249, v249, v251
    v_cvt_pk_bf16_f32 v202, v248, v249
    v_lshlrev_b32 v248, 16, v203
    v_and_b32 v249, 0xffff0000, v203
    v_lshlrev_b32 v250, 16, v239
    v_and_b32 v251, 0xffff0000, v239
    v_mul_f32 v252, 0xbfb8aa3b, v248
    v_exp_f32 v252, v252
    s_nop 0
    v_add_f32 v252, 1.0, v252
    v_rcp_f32 v252, v252
    s_nop 0
    v_mul_f32 v248, v248, v252
    v_mul_f32 v253, 0xbfb8aa3b, v249
    v_exp_f32 v253, v253
    s_nop 0
    v_add_f32 v253, 1.0, v253
    v_rcp_f32 v253, v253
    s_nop 0
    v_mul_f32 v249, v249, v253
    v_cvt_pk_bf16_f32 v249, v248, v249
    v_lshlrev_b32 v248, 16, v249
    v_and_b32 v249, 0xffff0000, v249
    v_mul_f32 v248, v248, v250
    v_mul_f32 v249, v249, v251
    v_cvt_pk_bf16_f32 v203, v248, v249
    s_waitcnt vmcnt(0)
    v_lshlrev_b32 v248, 16, v204
    v_and_b32 v249, 0xffff0000, v204
    v_lshlrev_b32 v250, 16, v240
    v_and_b32 v251, 0xffff0000, v240
    v_mul_f32 v252, 0xbfb8aa3b, v248
    v_exp_f32 v252, v252
    s_nop 0
    v_add_f32 v252, 1.0, v252
    v_rcp_f32 v252, v252
    s_nop 0
    v_mul_f32 v248, v248, v252
    v_mul_f32 v253, 0xbfb8aa3b, v249
    v_exp_f32 v253, v253
    s_nop 0
    v_add_f32 v253, 1.0, v253
    v_rcp_f32 v253, v253
    s_nop 0
    v_mul_f32 v249, v249, v253
    v_cvt_pk_bf16_f32 v249, v248, v249
    v_lshlrev_b32 v248, 16, v249
    v_and_b32 v249, 0xffff0000, v249
    v_mul_f32 v248, v248, v250
    v_mul_f32 v249, v249, v251
    v_cvt_pk_bf16_f32 v204, v248, v249
    v_lshlrev_b32 v248, 16, v205
    v_and_b32 v249, 0xffff0000, v205
    v_lshlrev_b32 v250, 16, v241
    v_and_b32 v251, 0xffff0000, v241
    v_mul_f32 v252, 0xbfb8aa3b, v248
    v_exp_f32 v252, v252
    s_nop 0
    v_add_f32 v252, 1.0, v252
    v_rcp_f32 v252, v252
    s_nop 0
    v_mul_f32 v248, v248, v252
    v_mul_f32 v253, 0xbfb8aa3b, v249
    v_exp_f32 v253, v253
    s_nop 0
    v_add_f32 v253, 1.0, v253
    v_rcp_f32 v253, v253
    s_nop 0
    v_mul_f32 v249, v249, v253
    v_cvt_pk_bf16_f32 v249, v248, v249
    v_lshlrev_b32 v248, 16, v249
    v_and_b32 v249, 0xffff0000, v249
    v_mul_f32 v248, v248, v250
    v_mul_f32 v249, v249, v251
    v_cvt_pk_bf16_f32 v205, v248, v249
    v_lshlrev_b32 v248, 16, v206
    v_and_b32 v249, 0xffff0000, v206
    v_lshlrev_b32 v250, 16, v242
    v_and_b32 v251, 0xffff0000, v242
    v_mul_f32 v252, 0xbfb8aa3b, v248
    v_exp_f32 v252, v252
    s_nop 0
    v_add_f32 v252, 1.0, v252
    v_rcp_f32 v252, v252
    s_nop 0
    v_mul_f32 v248, v248, v252
    v_mul_f32 v253, 0xbfb8aa3b, v249
    v_exp_f32 v253, v253
    s_nop 0
    v_add_f32 v253, 1.0, v253
    v_rcp_f32 v253, v253
    s_nop 0
    v_mul_f32 v249, v249, v253
    v_cvt_pk_bf16_f32 v249, v248, v249
    v_lshlrev_b32 v248, 16, v249
    v_and_b32 v249, 0xffff0000, v249
    v_mul_f32 v248, v248, v250
    v_mul_f32 v249, v249, v251
    v_cvt_pk_bf16_f32 v206, v248, v249
    v_lshlrev_b32 v248, 16, v207
    v_and_b32 v249, 0xffff0000, v207
    v_lshlrev_b32 v250, 16, v243
    v_and_b32 v251, 0xffff0000, v243
    v_mul_f32 v252, 0xbfb8aa3b, v248
    v_exp_f32 v252, v252
    s_nop 0
    v_add_f32 v252, 1.0, v252
    v_rcp_f32 v252, v252
    s_nop 0
    v_mul_f32 v248, v248, v252
    v_mul_f32 v253, 0xbfb8aa3b, v249
    v_exp_f32 v253, v253
    s_nop 0
    v_add_f32 v253, 1.0, v253
    v_rcp_f32 v253, v253
    s_nop 0
    v_mul_f32 v249, v249, v253
    v_cvt_pk_bf16_f32 v249, v248, v249
    v_lshlrev_b32 v248, 16, v249
    v_and_b32 v249, 0xffff0000, v249
    v_mul_f32 v248, v248, v250
    v_mul_f32 v249, v249, v251
    v_cvt_pk_bf16_f32 v207, v248, v249
    v_perm_b32 v240, v16, v12, s74
    v_perm_b32 v244, v16, v12, s75
    v_perm_b32 v241, v24, v20, s74
    v_perm_b32 v245, v24, v20, s75
    v_perm_b32 v242, v32, v28, s74
    v_perm_b32 v246, v32, v28, s75
    v_perm_b32 v243, v40, v36, s74
    v_perm_b32 v247, v40, v36, s75
    s_nop 0
    v_mfma_f32_16x16x32_bf16 v[208:211], v[240:243], v[172:175], 0
    v_mfma_f32_16x16x32_bf16 v[212:215], v[244:247], v[172:175], 0
    v_perm_b32 v248, v17, v13, s74
    v_perm_b32 v252, v17, v13, s75
    v_perm_b32 v249, v25, v21, s74
    v_perm_b32 v253, v25, v21, s75
    v_perm_b32 v250, v33, v29, s74
    v_perm_b32 v254, v33, v29, s75
    v_perm_b32 v251, v41, v37, s74
    v_perm_b32 v255, v41, v37, s75
    s_nop 0
    v_mfma_f32_16x16x32_bf16 v[216:219], v[248:251], v[172:175], 0
    v_mfma_f32_16x16x32_bf16 v[220:223], v[252:255], v[172:175], 0
    v_perm_b32 v240, v18, v14, s74
    v_perm_b32 v244, v18, v14, s75
    v_perm_b32 v241, v26, v22, s74
    v_perm_b32 v245, v26, v22, s75
    v_perm_b32 v242, v34, v30, s74
    v_perm_b32 v246, v34, v30, s75
    v_perm_b32 v243, v42, v38, s74
    v_perm_b32 v247, v42, v38, s75
    s_nop 0
    v_mfma_f32_16x16x32_bf16 v[224:227], v[240:243], v[172:175], 0
    v_mfma_f32_16x16x32_bf16 v[228:231], v[244:247], v[172:175], 0
    v_perm_b32 v248, v19, v15, s74
    v_perm_b32 v252, v19, v15, s75
    v_perm_b32 v249, v27, v23, s74
    v_perm_b32 v253, v27, v23, s75
    v_perm_b32 v250, v35, v31, s74
    v_perm_b32 v254, v35, v31, s75
    v_perm_b32 v251, v43, v39, s74
    v_perm_b32 v255, v43, v39, s75
    s_nop 0
    v_mfma_f32_16x16x32_bf16 v[232:235], v[248:251], v[172:175], 0
    v_mfma_f32_16x16x32_bf16 v[236:239], v[252:255], v[172:175], 0
    s_mov_b32 s66, 221184
    buffer_load_dwordx4 v[108:111], v9, s[44:47], s66 offen nt
    s_mov_b32 s66, 222336
    buffer_load_dwordx4 v[112:115], v9, s[44:47], s66 offen nt
    s_mov_b32 s66, 223488
    buffer_load_dwordx4 v[116:119], v9, s[44:47], s66 offen nt
    s_mov_b32 s66, 224640
    buffer_load_dwordx4 v[120:123], v9, s[44:47], s66 offen nt
    s_mov_b32 s66, 225792
    buffer_load_dwordx4 v[124:127], v9, s[44:47], s66 offen nt
    s_mov_b32 s66, 226944
    buffer_load_dwordx4 v[128:131], v9, s[44:47], s66 offen nt
    s_mov_b32 s66, 228096
    buffer_load_dwordx4 v[132:135], v9, s[44:47], s66 offen nt
    s_mov_b32 s66, 229248
    buffer_load_dwordx4 v[136:139], v9, s[44:47], s66 offen nt
    v_perm_b32 v240, v48, v44, s74
    v_perm_b32 v244, v48, v44, s75
    v_perm_b32 v241, v56, v52, s74
    v_perm_b32 v245, v56, v52, s75
    v_perm_b32 v242, v64, v60, s74
    v_perm_b32 v246, v64, v60, s75
    v_perm_b32 v243, v72, v68, s74
    v_perm_b32 v247, v72, v68, s75
    s_nop 0
    v_mfma_f32_16x16x32_bf16 v[208:211], v[240:243], v[176:179], v[208:211]
    v_mfma_f32_16x16x32_bf16 v[212:215], v[244:247], v[176:179], v[212:215]
    v_perm_b32 v248, v49, v45, s74
    v_perm_b32 v252, v49, v45, s75
    v_perm_b32 v249, v57, v53, s74
    v_perm_b32 v253, v57, v53, s75
    v_perm_b32 v250, v65, v61, s74
    v_perm_b32 v254, v65, v61, s75
    v_perm_b32 v251, v73, v69, s74
    v_perm_b32 v255, v73, v69, s75
    s_nop 0
    v_mfma_f32_16x16x32_bf16 v[216:219], v[248:251], v[176:179], v[216:219]
    v_mfma_f32_16x16x32_bf16 v[220:223], v[252:255], v[176:179], v[220:223]
    v_perm_b32 v240, v50, v46, s74
    v_perm_b32 v244, v50, v46, s75
    v_perm_b32 v241, v58, v54, s74
    v_perm_b32 v245, v58, v54, s75
    v_perm_b32 v242, v66, v62, s74
    v_perm_b32 v246, v66, v62, s75
    v_perm_b32 v243, v74, v70, s74
    v_perm_b32 v247, v74, v70, s75
    s_nop 0
    v_mfma_f32_16x16x32_bf16 v[224:227], v[240:243], v[176:179], v[224:227]
    v_mfma_f32_16x16x32_bf16 v[228:231], v[244:247], v[176:179], v[228:231]
    v_perm_b32 v248, v51, v47, s74
    v_perm_b32 v252, v51, v47, s75
    v_perm_b32 v249, v59, v55, s74
    v_perm_b32 v253, v59, v55, s75
    v_perm_b32 v250, v67, v63, s74
    v_perm_b32 v254, v67, v63, s75
    v_perm_b32 v251, v75, v71, s74
    v_perm_b32 v255, v75, v71, s75
    s_nop 0
    v_mfma_f32_16x16x32_bf16 v[232:235], v[248:251], v[176:179], v[232:235]
    v_mfma_f32_16x16x32_bf16 v[236:239], v[252:255], v[176:179], v[236:239]
    s_mov_b32 s66, 294912
    buffer_load_dwordx4 v[140:143], v9, s[44:47], s66 offen nt
    s_mov_b32 s66, 296064
    buffer_load_dwordx4 v[144:147], v9, s[44:47], s66 offen nt
    s_mov_b32 s66, 297216
    buffer_load_dwordx4 v[148:151], v9, s[44:47], s66 offen nt
    s_mov_b32 s66, 298368
    buffer_load_dwordx4 v[152:155], v9, s[44:47], s66 offen nt
    s_mov_b32 s66, 299520
    buffer_load_dwordx4 v[156:159], v9, s[44:47], s66 offen nt
    s_mov_b32 s66, 300672
    buffer_load_dwordx4 v[160:163], v9, s[44:47], s66 offen nt
    s_mov_b32 s66, 301824
    buffer_load_dwordx4 v[164:167], v9, s[44:47], s66 offen nt
    s_mov_b32 s66, 302976
    buffer_load_dwordx4 v[168:171], v9, s[44:47], s66 offen nt
    v_perm_b32 v240, v80, v76, s74
    v_perm_b32 v244, v80, v76, s75
    v_perm_b32 v241, v88, v84, s74
    v_perm_b32 v245, v88, v84, s75
    v_perm_b32 v242, v96, v92, s74
    v_perm_b32 v246, v96, v92, s75
    v_perm_b32 v243, v104, v100, s74
    v_perm_b32 v247, v104, v100, s75
    s_nop 0
    v_mfma_f32_16x16x32_bf16 v[208:211], v[240:243], v[180:183], v[208:211]
    v_mfma_f32_16x16x32_bf16 v[212:215], v[244:247], v[180:183], v[212:215]
    v_perm_b32 v248, v81, v77, s74
    v_perm_b32 v252, v81, v77, s75
    v_perm_b32 v249, v89, v85, s74
    v_perm_b32 v253, v89, v85, s75
    v_perm_b32 v250, v97, v93, s74
    v_perm_b32 v254, v97, v93, s75
    v_perm_b32 v251, v105, v101, s74
    v_perm_b32 v255, v105, v101, s75
    s_nop 0
    v_mfma_f32_16x16x32_bf16 v[216:219], v[248:251], v[180:183], v[216:219]
    v_mfma_f32_16x16x32_bf16 v[220:223], v[252:255], v[180:183], v[220:223]
    v_perm_b32 v240, v82, v78, s74
    v_perm_b32 v244, v82, v78, s75
    v_perm_b32 v241, v90, v86, s74
    v_perm_b32 v245, v90, v86, s75
    v_perm_b32 v242, v98, v94, s74
    v_perm_b32 v246, v98, v94, s75
    v_perm_b32 v243, v106, v102, s74
    v_perm_b32 v247, v106, v102, s75
    s_nop 0
    v_mfma_f32_16x16x32_bf16 v[224:227], v[240:243], v[180:183], v[224:227]
    v_mfma_f32_16x16x32_bf16 v[228:231], v[244:247], v[180:183], v[228:231]
    v_perm_b32 v248, v83, v79, s74
    v_perm_b32 v252, v83, v79, s75
    v_perm_b32 v249, v91, v87, s74
    v_perm_b32 v253, v91, v87, s75
    v_perm_b32 v250, v99, v95, s74
    v_perm_b32 v254, v99, v95, s75
    v_perm_b32 v251, v107, v103, s74
    v_perm_b32 v255, v107, v103, s75
    s_nop 0
    v_mfma_f32_16x16x32_bf16 v[232:235], v[248:251], v[180:183], v[232:235]
    v_mfma_f32_16x16x32_bf16 v[236:239], v[252:255], v[180:183], v[236:239]
    s_mov_b32 s66, 368640
    buffer_load_dwordx4 v[12:15], v9, s[44:47], s66 offen nt
    s_mov_b32 s66, 369792
    buffer_load_dwordx4 v[16:19], v9, s[44:47], s66 offen nt
    s_mov_b32 s66, 370944
    buffer_load_dwordx4 v[20:23], v9, s[44:47], s66 offen nt
    s_mov_b32 s66, 372096
    buffer_load_dwordx4 v[24:27], v9, s[44:47], s66 offen nt
    s_mov_b32 s66, 373248
    buffer_load_dwordx4 v[28:31], v9, s[44:47], s66 offen nt
    s_mov_b32 s66, 374400
    buffer_load_dwordx4 v[32:35], v9, s[44:47], s66 offen nt
    s_mov_b32 s66, 375552
    buffer_load_dwordx4 v[36:39], v9, s[44:47], s66 offen nt
    s_mov_b32 s66, 376704
    buffer_load_dwordx4 v[40:43], v9, s[44:47], s66 offen nt
    s_waitcnt vmcnt(16)
    v_perm_b32 v240, v112, v108, s74
    v_perm_b32 v244, v112, v108, s75
    v_perm_b32 v241, v120, v116, s74
    v_perm_b32 v245, v120, v116, s75
    v_perm_b32 v242, v128, v124, s74
    v_perm_b32 v246, v128, v124, s75
    v_perm_b32 v243, v136, v132, s74
    v_perm_b32 v247, v136, v132, s75
    s_nop 0
    v_mfma_f32_16x16x32_bf16 v[208:211], v[240:243], v[184:187], v[208:211]
    v_mfma_f32_16x16x32_bf16 v[212:215], v[244:247], v[184:187], v[212:215]
    v_perm_b32 v248, v113, v109, s74
    v_perm_b32 v252, v113, v109, s75
    v_perm_b32 v249, v121, v117, s74
    v_perm_b32 v253, v121, v117, s75
    v_perm_b32 v250, v129, v125, s74
    v_perm_b32 v254, v129, v125, s75
    v_perm_b32 v251, v137, v133, s74
    v_perm_b32 v255, v137, v133, s75
    s_nop 0
    v_mfma_f32_16x16x32_bf16 v[216:219], v[248:251], v[184:187], v[216:219]
    v_mfma_f32_16x16x32_bf16 v[220:223], v[252:255], v[184:187], v[220:223]
    v_perm_b32 v240, v114, v110, s74
    v_perm_b32 v244, v114, v110, s75
    v_perm_b32 v241, v122, v118, s74
    v_perm_b32 v245, v122, v118, s75
    v_perm_b32 v242, v130, v126, s74
    v_perm_b32 v246, v130, v126, s75
    v_perm_b32 v243, v138, v134, s74
    v_perm_b32 v247, v138, v134, s75
    s_nop 0
    v_mfma_f32_16x16x32_bf16 v[224:227], v[240:243], v[184:187], v[224:227]
    v_mfma_f32_16x16x32_bf16 v[228:231], v[244:247], v[184:187], v[228:231]
    v_perm_b32 v248, v115, v111, s74
    v_perm_b32 v252, v115, v111, s75
    v_perm_b32 v249, v123, v119, s74
    v_perm_b32 v253, v123, v119, s75
    v_perm_b32 v250, v131, v127, s74
    v_perm_b32 v254, v131, v127, s75
    v_perm_b32 v251, v139, v135, s74
    v_perm_b32 v255, v139, v135, s75
    s_nop 0
    v_mfma_f32_16x16x32_bf16 v[232:235], v[248:251], v[184:187], v[232:235]
    v_mfma_f32_16x16x32_bf16 v[236:239], v[252:255], v[184:187], v[236:239]
    s_mov_b32 s66, 442368
    buffer_load_dwordx4 v[44:47], v9, s[44:47], s66 offen nt
    s_mov_b32 s66, 443520
    buffer_load_dwordx4 v[48:51], v9, s[44:47], s66 offen nt
    s_mov_b32 s66, 444672
    buffer_load_dwordx4 v[52:55], v9, s[44:47], s66 offen nt
    s_mov_b32 s66, 445824
    buffer_load_dwordx4 v[56:59], v9, s[44:47], s66 offen nt
    s_mov_b32 s66, 446976
    buffer_load_dwordx4 v[60:63], v9, s[44:47], s66 offen nt
    s_mov_b32 s66, 448128
    buffer_load_dwordx4 v[64:67], v9, s[44:47], s66 offen nt
    s_mov_b32 s66, 449280
    buffer_load_dwordx4 v[68:71], v9, s[44:47], s66 offen nt
    s_mov_b32 s66, 450432
    buffer_load_dwordx4 v[72:75], v9, s[44:47], s66 offen nt
    s_waitcnt vmcnt(16)
    v_perm_b32 v240, v144, v140, s74
    v_perm_b32 v244, v144, v140, s75
    v_perm_b32 v241, v152, v148, s74
    v_perm_b32 v245, v152, v148, s75
    v_perm_b32 v242, v160, v156, s74
    v_perm_b32 v246, v160, v156, s75
    v_perm_b32 v243, v168, v164, s74
    v_perm_b32 v247, v168, v164, s75
    s_nop 0
    v_mfma_f32_16x16x32_bf16 v[208:211], v[240:243], v[188:191], v[208:211]
    v_mfma_f32_16x16x32_bf16 v[212:215], v[244:247], v[188:191], v[212:215]
    v_perm_b32 v248, v145, v141, s74
    v_perm_b32 v252, v145, v141, s75
    v_perm_b32 v249, v153, v149, s74
    v_perm_b32 v253, v153, v149, s75
    v_perm_b32 v250, v161, v157, s74
    v_perm_b32 v254, v161, v157, s75
    v_perm_b32 v251, v169, v165, s74
    v_perm_b32 v255, v169, v165, s75
    s_nop 0
    v_mfma_f32_16x16x32_bf16 v[216:219], v[248:251], v[188:191], v[216:219]
    v_mfma_f32_16x16x32_bf16 v[220:223], v[252:255], v[188:191], v[220:223]
    v_perm_b32 v240, v146, v142, s74
    v_perm_b32 v244, v146, v142, s75
    v_perm_b32 v241, v154, v150, s74
    v_perm_b32 v245, v154, v150, s75
    v_perm_b32 v242, v162, v158, s74
    v_perm_b32 v246, v162, v158, s75
    v_perm_b32 v243, v170, v166, s74
    v_perm_b32 v247, v170, v166, s75
    s_nop 0
    v_mfma_f32_16x16x32_bf16 v[224:227], v[240:243], v[188:191], v[224:227]
    v_mfma_f32_16x16x32_bf16 v[228:231], v[244:247], v[188:191], v[228:231]
    v_perm_b32 v248, v147, v143, s74
    v_perm_b32 v252, v147, v143, s75
    v_perm_b32 v249, v155, v151, s74
    v_perm_b32 v253, v155, v151, s75
    v_perm_b32 v250, v163, v159, s74
    v_perm_b32 v254, v163, v159, s75
    v_perm_b32 v251, v171, v167, s74
    v_perm_b32 v255, v171, v167, s75
    s_nop 0
    v_mfma_f32_16x16x32_bf16 v[232:235], v[248:251], v[188:191], v[232:235]
    v_mfma_f32_16x16x32_bf16 v[236:239], v[252:255], v[188:191], v[236:239]
    s_mov_b32 s66, 516096
    buffer_load_dwordx4 v[76:79], v9, s[44:47], s66 offen nt
    s_mov_b32 s66, 517248
    buffer_load_dwordx4 v[80:83], v9, s[44:47], s66 offen nt
    s_mov_b32 s66, 518400
    buffer_load_dwordx4 v[84:87], v9, s[44:47], s66 offen nt
    s_mov_b32 s66, 519552
    buffer_load_dwordx4 v[88:91], v9, s[44:47], s66 offen nt
    s_mov_b32 s66, 520704
    buffer_load_dwordx4 v[92:95], v9, s[44:47], s66 offen nt
    s_mov_b32 s66, 521856
    buffer_load_dwordx4 v[96:99], v9, s[44:47], s66 offen nt
    s_mov_b32 s66, 523008
    buffer_load_dwordx4 v[100:103], v9, s[44:47], s66 offen nt
    s_mov_b32 s66, 524160
    buffer_load_dwordx4 v[104:107], v9, s[44:47], s66 offen nt
    s_waitcnt vmcnt(16)
    v_perm_b32 v240, v16, v12, s74
    v_perm_b32 v244, v16, v12, s75
    v_perm_b32 v241, v24, v20, s74
    v_perm_b32 v245, v24, v20, s75
    v_perm_b32 v242, v32, v28, s74
    v_perm_b32 v246, v32, v28, s75
    v_perm_b32 v243, v40, v36, s74
    v_perm_b32 v247, v40, v36, s75
    s_nop 0
    v_mfma_f32_16x16x32_bf16 v[208:211], v[240:243], v[192:195], v[208:211]
    v_mfma_f32_16x16x32_bf16 v[212:215], v[244:247], v[192:195], v[212:215]
    v_perm_b32 v248, v17, v13, s74
    v_perm_b32 v252, v17, v13, s75
    v_perm_b32 v249, v25, v21, s74
    v_perm_b32 v253, v25, v21, s75
    v_perm_b32 v250, v33, v29, s74
    v_perm_b32 v254, v33, v29, s75
    v_perm_b32 v251, v41, v37, s74
    v_perm_b32 v255, v41, v37, s75
    s_nop 0
    v_mfma_f32_16x16x32_bf16 v[216:219], v[248:251], v[192:195], v[216:219]
    v_mfma_f32_16x16x32_bf16 v[220:223], v[252:255], v[192:195], v[220:223]
    v_perm_b32 v240, v18, v14, s74
    v_perm_b32 v244, v18, v14, s75
    v_perm_b32 v241, v26, v22, s74
    v_perm_b32 v245, v26, v22, s75
    v_perm_b32 v242, v34, v30, s74
    v_perm_b32 v246, v34, v30, s75
    v_perm_b32 v243, v42, v38, s74
    v_perm_b32 v247, v42, v38, s75
    s_nop 0
    v_mfma_f32_16x16x32_bf16 v[224:227], v[240:243], v[192:195], v[224:227]
    v_mfma_f32_16x16x32_bf16 v[228:231], v[244:247], v[192:195], v[228:231]
    v_perm_b32 v248, v19, v15, s74
    v_perm_b32 v252, v19, v15, s75
    v_perm_b32 v249, v27, v23, s74
    v_perm_b32 v253, v27, v23, s75
    v_perm_b32 v250, v35, v31, s74
    v_perm_b32 v254, v35, v31, s75
    v_perm_b32 v251, v43, v39, s74
    v_perm_b32 v255, v43, v39, s75
    s_nop 0
    v_mfma_f32_16x16x32_bf16 v[232:235], v[248:251], v[192:195], v[232:235]
    v_mfma_f32_16x16x32_bf16 v[236:239], v[252:255], v[192:195], v[236:239]
    s_mov_b32 s66, 589824
    buffer_load_dwordx4 v[108:111], v9, s[44:47], s66 offen nt
    s_mov_b32 s66, 590976
    buffer_load_dwordx4 v[112:115], v9, s[44:47], s66 offen nt
    s_mov_b32 s66, 592128
    buffer_load_dwordx4 v[116:119], v9, s[44:47], s66 offen nt
    s_mov_b32 s66, 593280
    buffer_load_dwordx4 v[120:123], v9, s[44:47], s66 offen nt
    s_mov_b32 s66, 594432
    buffer_load_dwordx4 v[124:127], v9, s[44:47], s66 offen nt
    s_mov_b32 s66, 595584
    buffer_load_dwordx4 v[128:131], v9, s[44:47], s66 offen nt
    s_mov_b32 s66, 596736
    buffer_load_dwordx4 v[132:135], v9, s[44:47], s66 offen nt
    s_mov_b32 s66, 597888
    buffer_load_dwordx4 v[136:139], v9, s[44:47], s66 offen nt
    s_waitcnt vmcnt(16)
    v_perm_b32 v240, v48, v44, s74
    v_perm_b32 v244, v48, v44, s75
    v_perm_b32 v241, v56, v52, s74
    v_perm_b32 v245, v56, v52, s75
    v_perm_b32 v242, v64, v60, s74
    v_perm_b32 v246, v64, v60, s75
    v_perm_b32 v243, v72, v68, s74
    v_perm_b32 v247, v72, v68, s75
    s_nop 0
    v_mfma_f32_16x16x32_bf16 v[208:211], v[240:243], v[196:199], v[208:211]
    v_mfma_f32_16x16x32_bf16 v[212:215], v[244:247], v[196:199], v[212:215]
    v_perm_b32 v248, v49, v45, s74
    v_perm_b32 v252, v49, v45, s75
    v_perm_b32 v249, v57, v53, s74
    v_perm_b32 v253, v57, v53, s75
    v_perm_b32 v250, v65, v61, s74
    v_perm_b32 v254, v65, v61, s75
    v_perm_b32 v251, v73, v69, s74
    v_perm_b32 v255, v73, v69, s75
    s_nop 0
    v_mfma_f32_16x16x32_bf16 v[216:219], v[248:251], v[196:199], v[216:219]
    v_mfma_f32_16x16x32_bf16 v[220:223], v[252:255], v[196:199], v[220:223]
    v_perm_b32 v240, v50, v46, s74
    v_perm_b32 v244, v50, v46, s75
    v_perm_b32 v241, v58, v54, s74
    v_perm_b32 v245, v58, v54, s75
    v_perm_b32 v242, v66, v62, s74
    v_perm_b32 v246, v66, v62, s75
    v_perm_b32 v243, v74, v70, s74
    v_perm_b32 v247, v74, v70, s75
    s_nop 0
    v_mfma_f32_16x16x32_bf16 v[224:227], v[240:243], v[196:199], v[224:227]
    v_mfma_f32_16x16x32_bf16 v[228:231], v[244:247], v[196:199], v[228:231]
    v_perm_b32 v248, v51, v47, s74
    v_perm_b32 v252, v51, v47, s75
    v_perm_b32 v249, v59, v55, s74
    v_perm_b32 v253, v59, v55, s75
    v_perm_b32 v250, v67, v63, s74
    v_perm_b32 v254, v67, v63, s75
    v_perm_b32 v251, v75, v71, s74
    v_perm_b32 v255, v75, v71, s75
    s_nop 0
    v_mfma_f32_16x16x32_bf16 v[232:235], v[248:251], v[196:199], v[232:235]
    v_mfma_f32_16x16x32_bf16 v[236:239], v[252:255], v[196:199], v[236:239]
    s_waitcnt vmcnt(8)
    v_perm_b32 v240, v80, v76, s74
    v_perm_b32 v244, v80, v76, s75
    v_perm_b32 v241, v88, v84, s74
    v_perm_b32 v245, v88, v84, s75
    v_perm_b32 v242, v96, v92, s74
    v_perm_b32 v246, v96, v92, s75
    v_perm_b32 v243, v104, v100, s74
    v_perm_b32 v247, v104, v100, s75
    s_nop 0
    v_mfma_f32_16x16x32_bf16 v[208:211], v[240:243], v[200:203], v[208:211]
    v_mfma_f32_16x16x32_bf16 v[212:215], v[244:247], v[200:203], v[212:215]
    v_perm_b32 v248, v81, v77, s74
    v_perm_b32 v252, v81, v77, s75
    v_perm_b32 v249, v89, v85, s74
    v_perm_b32 v253, v89, v85, s75
    v_perm_b32 v250, v97, v93, s74
    v_perm_b32 v254, v97, v93, s75
    v_perm_b32 v251, v105, v101, s74
    v_perm_b32 v255, v105, v101, s75
    s_nop 0
    v_mfma_f32_16x16x32_bf16 v[216:219], v[248:251], v[200:203], v[216:219]
    v_mfma_f32_16x16x32_bf16 v[220:223], v[252:255], v[200:203], v[220:223]
    v_perm_b32 v240, v82, v78, s74
    v_perm_b32 v244, v82, v78, s75
    v_perm_b32 v241, v90, v86, s74
    v_perm_b32 v245, v90, v86, s75
    v_perm_b32 v242, v98, v94, s74
    v_perm_b32 v246, v98, v94, s75
    v_perm_b32 v243, v106, v102, s74
    v_perm_b32 v247, v106, v102, s75
    s_nop 0
    v_mfma_f32_16x16x32_bf16 v[224:227], v[240:243], v[200:203], v[224:227]
    v_mfma_f32_16x16x32_bf16 v[228:231], v[244:247], v[200:203], v[228:231]
    v_perm_b32 v248, v83, v79, s74
    v_perm_b32 v252, v83, v79, s75
    v_perm_b32 v249, v91, v87, s74
    v_perm_b32 v253, v91, v87, s75
    v_perm_b32 v250, v99, v95, s74
    v_perm_b32 v254, v99, v95, s75
    v_perm_b32 v251, v107, v103, s74
    v_perm_b32 v255, v107, v103, s75
    s_nop 0
    v_mfma_f32_16x16x32_bf16 v[232:235], v[248:251], v[200:203], v[232:235]
    v_mfma_f32_16x16x32_bf16 v[236:239], v[252:255], v[200:203], v[236:239]
    s_waitcnt vmcnt(0)
    v_perm_b32 v240, v112, v108, s74
    v_perm_b32 v244, v112, v108, s75
    v_perm_b32 v241, v120, v116, s74
    v_perm_b32 v245, v120, v116, s75
    v_perm_b32 v242, v128, v124, s74
    v_perm_b32 v246, v128, v124, s75
    v_perm_b32 v243, v136, v132, s74
    v_perm_b32 v247, v136, v132, s75
    s_nop 0
    v_mfma_f32_16x16x32_bf16 v[208:211], v[240:243], v[204:207], v[208:211]
    v_mfma_f32_16x16x32_bf16 v[212:215], v[244:247], v[204:207], v[212:215]
    v_perm_b32 v248, v113, v109, s74
    v_perm_b32 v252, v113, v109, s75
    v_perm_b32 v249, v121, v117, s74
    v_perm_b32 v253, v121, v117, s75
    v_perm_b32 v250, v129, v125, s74
    v_perm_b32 v254, v129, v125, s75
    v_perm_b32 v251, v137, v133, s74
    v_perm_b32 v255, v137, v133, s75
    s_nop 0
    v_mfma_f32_16x16x32_bf16 v[216:219], v[248:251], v[204:207], v[216:219]
    v_mfma_f32_16x16x32_bf16 v[220:223], v[252:255], v[204:207], v[220:223]
    v_perm_b32 v240, v114, v110, s74
    v_perm_b32 v244, v114, v110, s75
    v_perm_b32 v241, v122, v118, s74
    v_perm_b32 v245, v122, v118, s75
    v_perm_b32 v242, v130, v126, s74
    v_perm_b32 v246, v130, v126, s75
    v_perm_b32 v243, v138, v134, s74
    v_perm_b32 v247, v138, v134, s75
    s_nop 0
    v_mfma_f32_16x16x32_bf16 v[224:227], v[240:243], v[204:207], v[224:227]
    v_mfma_f32_16x16x32_bf16 v[228:231], v[244:247], v[204:207], v[228:231]
    v_perm_b32 v248, v115, v111, s74
    v_perm_b32 v252, v115, v111, s75
    v_perm_b32 v249, v123, v119, s74
    v_perm_b32 v253, v123, v119, s75
    v_perm_b32 v250, v131, v127, s74
    v_perm_b32 v254, v131, v127, s75
    v_perm_b32 v251, v139, v135, s74
    v_perm_b32 v255, v139, v135, s75
    s_nop 0
    v_mfma_f32_16x16x32_bf16 v[232:235], v[248:251], v[204:207], v[232:235]
    v_mfma_f32_16x16x32_bf16 v[236:239], v[252:255], v[204:207], v[236:239]
    v_and_b32 v8, 7, v3
    v_lshl_add_u32 v9, v2, 3, v8
    v_mul_u32_u24 v9, 144, v9
    v_add_u32 v9, 149568, v9
    v_mul_u32_u24 v8, 144, v8
    v_lshl_add_u32 v8, v2, 2, v8
    v_add_u32 v8, 149568, v8
    s_mov_b32 exec_lo, 0xff00ff
    s_mov_b32 exec_hi, 0xff00ff00
    ds_write_b128 v9, v[208:211] offset:0
    ds_write_b128 v9, v[212:215] offset:16
    ds_write_b128 v9, v[216:219] offset:32
    ds_write_b128 v9, v[220:223] offset:48
    ds_write_b128 v9, v[224:227] offset:64
    ds_write_b128 v9, v[228:231] offset:80
    ds_write_b128 v9, v[232:235] offset:96
    ds_write_b128 v9, v[236:239] offset:112
    s_mov_b64 exec, -1
    s_waitcnt lgkmcnt(0)
    ds_read_b32 v172, v8 offset:0
    ds_read_b32 v173, v8 offset:16
    ds_read_b32 v174, v8 offset:32
    ds_read_b32 v175, v8 offset:48
    ds_read_b32 v176, v8 offset:64
    ds_read_b32 v177, v8 offset:80
    ds_read_b32 v178, v8 offset:96
    ds_read_b32 v179, v8 offset:112
    ds_read_b32 v180, v8 offset:1152
    ds_read_b32 v181, v8 offset:1168
    ds_read_b32 v182, v8 offset:1184
    ds_read_b32 v183, v8 offset:1200
    ds_read_b32 v184, v8 offset:1216
    ds_read_b32 v185, v8 offset:1232
    ds_read_b32 v186, v8 offset:1248
    ds_read_b32 v187, v8 offset:1264
    ds_read_b32 v188, v8 offset:2304
    ds_read_b32 v189, v8 offset:2320
    ds_read_b32 v190, v8 offset:2336
    ds_read_b32 v191, v8 offset:2352
    ds_read_b32 v192, v8 offset:2368
    ds_read_b32 v193, v8 offset:2384
    ds_read_b32 v194, v8 offset:2400
    ds_read_b32 v195, v8 offset:2416
    ds_read_b32 v196, v8 offset:3456
    ds_read_b32 v197, v8 offset:3472
    ds_read_b32 v198, v8 offset:3488
    ds_read_b32 v199, v8 offset:3504
    ds_read_b32 v200, v8 offset:3520
    ds_read_b32 v201, v8 offset:3536
    ds_read_b32 v202, v8 offset:3552
    ds_read_b32 v203, v8 offset:3568
    s_waitcnt lgkmcnt(0)
    v_add_f32 v172, v172, v188
    v_add_f32 v173, v173, v189
    v_add_f32 v174, v174, v190
    v_add_f32 v175, v175, v191
    v_add_f32 v176, v176, v192
    v_add_f32 v177, v177, v193
    v_add_f32 v178, v178, v194
    v_add_f32 v179, v179, v195
    v_add_f32 v180, v180, v196
    v_add_f32 v181, v181, v197
    v_add_f32 v182, v182, v198
    v_add_f32 v183, v183, v199
    v_add_f32 v184, v184, v200
    v_add_f32 v185, v185, v201
    v_add_f32 v186, v186, v202
    v_add_f32 v187, v187, v203
    v_cmp_lt_u32 s[82:83], 7, v3
    s_nop 1
    v_cndmask_b32 v208, v172, v180, s[82:83]
    v_cndmask_b32 v209, v173, v181, s[82:83]
    v_cndmask_b32 v210, v174, v182, s[82:83]
    v_cndmask_b32 v211, v175, v183, s[82:83]
    v_cndmask_b32 v212, v176, v184, s[82:83]
    v_cndmask_b32 v213, v177, v185, s[82:83]
    v_cndmask_b32 v214, v178, v186, s[82:83]
    v_cndmask_b32 v215, v179, v187, s[82:83]
    v_lshlrev_b32 v8, 4, v1
    s_lshl_b32 s66, s84, 11
    s_add_u32 s66, s66, 49152
    buffer_store_dwordx4 v[208:211], v8, s[52:55], s66 offen sc1
    buffer_store_dwordx4 v[212:215], v8, s[52:55], s66 offen offset:1024 sc1
    v_mov_b32 v10, 1
    s_lshl_b32 s66, s85, 6
    s_add_u32 s66, s66, 25088
    s_mov_b64 exec, 1
    s_waitcnt vmcnt(0)
    buffer_atomic_add v10, v7, s[52:55], s66 offen sc0 sc1
    s_waitcnt vmcnt(0)
    v_readfirstlane_b32 s68, v10
    s_mov_b64 exec, -1
    s_cmp_lg_u32 s68, 7
    s_nop 2
    s_cbranch_scc1 L_end
    s_lshl_b32 s66, s85, 11
    s_add_u32 s66, s66, 49152
    buffer_load_dwordx4 v[12:15], v8, s[52:55], s66 offen sc1
    buffer_load_dwordx4 v[16:19], v8, s[52:55], s66 offen offset:1024 sc1
    s_add_u32 s66, s66, 18432
    buffer_load_dwordx4 v[20:23], v8, s[52:55], s66 offen sc1
    buffer_load_dwordx4 v[24:27], v8, s[52:55], s66 offen offset:1024 sc1
    s_add_u32 s66, s66, 18432
    buffer_load_dwordx4 v[28:31], v8, s[52:55], s66 offen sc1
    buffer_load_dwordx4 v[32:35], v8, s[52:55], s66 offen offset:1024 sc1
    s_add_u32 s66, s66, 18432
    buffer_load_dwordx4 v[36:39], v8, s[52:55], s66 offen sc1
    buffer_load_dwordx4 v[40:43], v8, s[52:55], s66 offen offset:1024 sc1
    s_add_u32 s66, s66, 18432
    buffer_load_dwordx4 v[44:47], v8, s[52:55], s66 offen sc1
    buffer_load_dwordx4 v[48:51], v8, s[52:55], s66 offen offset:1024 sc1
    s_add_u32 s66, s66, 18432
    buffer_load_dwordx4 v[52:55], v8, s[52:55], s66 offen sc1
    buffer_load_dwordx4 v[56:59], v8, s[52:55], s66 offen offset:1024 sc1
    s_add_u32 s66, s66, 18432
    buffer_load_dwordx4 v[60:63], v8, s[52:55], s66 offen sc1
    buffer_load_dwordx4 v[64:67], v8, s[52:55], s66 offen offset:1024 sc1
    s_add_u32 s66, s66, 18432
    buffer_load_dwordx4 v[68:71], v8, s[52:55], s66 offen sc1
    buffer_load_dwordx4 v[72:75], v8, s[52:55], s66 offen offset:1024 sc1
    v_and_b32 v9, 7, v3
    v_mul_u32_u24 v9, 1152, v9
    v_lshl_add_u32 v9, v2, 4, v9
    v_lshrrev_b32 v11, 3, v3
    v_lshl_add_u32 v9, v11, 6, v9
    s_lshl_b32 s66, s85, 7
    s_add_u32 s66, s66, 26624
    s_waitcnt vmcnt(0)
    v_add_f32 v12, v12, v44
    v_add_f32 v13, v13, v45
    v_add_f32 v14, v14, v46
    v_add_f32 v15, v15, v47
    v_add_f32 v16, v16, v48
    v_add_f32 v17, v17, v49
    v_add_f32 v18, v18, v50
    v_add_f32 v19, v19, v51
    v_add_f32 v20, v20, v52
    v_add_f32 v21, v21, v53
    v_add_f32 v22, v22, v54
    v_add_f32 v23, v23, v55
    v_add_f32 v24, v24, v56
    v_add_f32 v25, v25, v57
    v_add_f32 v26, v26, v58
    v_add_f32 v27, v27, v59
    v_add_f32 v28, v28, v60
    v_add_f32 v29, v29, v61
    v_add_f32 v30, v30, v62
    v_add_f32 v31, v31, v63
    v_add_f32 v32, v32, v64
    v_add_f32 v33, v33, v65
    v_add_f32 v34, v34, v66
    v_add_f32 v35, v35, v67
    v_add_f32 v36, v36, v68
    v_add_f32 v37, v37, v69
    v_add_f32 v38, v38, v70
    v_add_f32 v39, v39, v71
    v_add_f32 v40, v40, v72
    v_add_f32 v41, v41, v73
    v_add_f32 v42, v42, v74
    v_add_f32 v43, v43, v75
    v_add_f32 v12, v12, v28
    v_add_f32 v13, v13, v29
    v_add_f32 v14, v14, v30
    v_add_f32 v15, v15, v31
    v_add_f32 v16, v16, v32
    v_add_f32 v17, v17, v33
    v_add_f32 v18, v18, v34
    v_add_f32 v19, v19, v35
    v_add_f32 v20, v20, v36
    v_add_f32 v21, v21, v37
    v_add_f32 v22, v22, v38
    v_add_f32 v23, v23, v39
    v_add_f32 v24, v24, v40
    v_add_f32 v25, v25, v41
    v_add_f32 v26, v26, v42
    v_add_f32 v27, v27, v43
    v_add_f32 v12, v12, v20
    v_add_f32 v13, v13, v21
    v_add_f32 v14, v14, v22
    v_add_f32 v15, v15, v23
    v_add_f32 v16, v16, v24
    v_add_f32 v17, v17, v25
    v_add_f32 v18, v18, v26
    v_add_f32 v19, v19, v27
    v_cvt_pk_bf16_f32 v12, v12, v12
    v_and_b32 v12, 0xffff0000, v12
    v_mul_f32 v240, 0xbfb8aa3b, v12
    v_exp_f32 v240, v240
    s_nop 0
    v_add_f32 v240, 1.0, v240
    v_rcp_f32 v240, v240
    s_nop 0
    v_mul_f32 v12, v12, v240
    v_cvt_pk_bf16_f32 v13, v13, v13
    v_and_b32 v13, 0xffff0000, v13
    v_mul_f32 v240, 0xbfb8aa3b, v13
    v_exp_f32 v240, v240
    s_nop 0
    v_add_f32 v240, 1.0, v240
    v_rcp_f32 v240, v240
    s_nop 0
    v_mul_f32 v13, v13, v240
    v_cvt_pk_bf16_f32 v14, v14, v14
    v_and_b32 v14, 0xffff0000, v14
    v_mul_f32 v240, 0xbfb8aa3b, v14
    v_exp_f32 v240, v240
    s_nop 0
    v_add_f32 v240, 1.0, v240
    v_rcp_f32 v240, v240
    s_nop 0
    v_mul_f32 v14, v14, v240
    v_cvt_pk_bf16_f32 v15, v15, v15
    v_and_b32 v15, 0xffff0000, v15
    v_mul_f32 v240, 0xbfb8aa3b, v15
    v_exp_f32 v240, v240
    s_nop 0
    v_add_f32 v240, 1.0, v240
    v_rcp_f32 v240, v240
    s_nop 0
    v_mul_f32 v15, v15, v240
    v_cvt_pk_bf16_f32 v16, v16, v16
    v_and_b32 v16, 0xffff0000, v16
    v_mul_f32 v240, 0xbfb8aa3b, v16
    v_exp_f32 v240, v240
    s_nop 0
    v_add_f32 v240, 1.0, v240
    v_rcp_f32 v240, v240
    s_nop 0
    v_mul_f32 v16, v16, v240
    v_cvt_pk_bf16_f32 v17, v17, v17
    v_and_b32 v17, 0xffff0000, v17
    v_mul_f32 v240, 0xbfb8aa3b, v17
    v_exp_f32 v240, v240
    s_nop 0
    v_add_f32 v240, 1.0, v240
    v_rcp_f32 v240, v240
    s_nop 0
    v_mul_f32 v17, v17, v240
    v_cvt_pk_bf16_f32 v18, v18, v18
    v_and_b32 v18, 0xffff0000, v18
    v_mul_f32 v240, 0xbfb8aa3b, v18
    v_exp_f32 v240, v240
    s_nop 0
    v_add_f32 v240, 1.0, v240
    v_rcp_f32 v240, v240
    s_nop 0
    v_mul_f32 v18, v18, v240
    v_cvt_pk_bf16_f32 v19, v19, v19
    v_and_b32 v19, 0xffff0000, v19
    v_mul_f32 v240, 0xbfb8aa3b, v19
    v_exp_f32 v240, v240
    s_nop 0
    v_add_f32 v240, 1.0, v240
    v_rcp_f32 v240, v240
    s_nop 0
    v_mul_f32 v19, v19, v240
    v_cvt_pk_bf16_f32 v208, v12, v13
    v_cvt_pk_bf16_f32 v209, v14, v15
    v_cvt_pk_bf16_f32 v210, v16, v17
    v_cvt_pk_bf16_f32 v211, v18, v19
    buffer_store_dwordx4 v[208:211], v9, s[52:55], s66 offen sc1
    v_mov_b32 v10, 1
    s_mov_b32 s66, 25664
    s_mov_b64 exec, 1
    s_waitcnt vmcnt(0)
    buffer_atomic_add v10, v7, s[52:55], s66 offen sc0 sc1
    s_waitcnt vmcnt(0)
    v_readfirstlane_b32 s68, v10
    s_mov_b64 exec, -1
    s_cmp_lg_u32 s68, 8
    s_nop 2
    s_cbranch_scc1 L_end
    v_mov_b32 v10, 1
    s_mov_b64 exec, 1
    buffer_store_dword v10, v7, s[60:63], 0 offen offset:192 sc1
    s_mov_b64 exec, -1
    v_and_b32 v20, 7, v1
    v_lshrrev_b32 v21, 3, v1
    v_cmp_eq_u32 vcc, 6, v20
    s_nop 1
    v_cndmask_b32 v13, 0, 1.0, vcc
    v_min_u32 v20, 5, v20
    v_mad_u32_u24 v12, v21, 6, v20
    s_mov_b32 s70, 0x3f3f3f3f
    s_mov_b32 s71, 0x3f3f3f3f
    v_lshlrev_b32 v12, 1, v12
    v_lshlrev_b32 v14, 2, v1
    s_mov_b32 s66, 0
    v_mov_b32 v32, v13
    buffer_atomic_add_f32 v32, v14, s[52:55], s66 offen offset:0 sc0 sc1
    v_mov_b32 v33, v13
    buffer_atomic_add_f32 v33, v14, s[52:55], s66 offen offset:256 sc0 sc1
    v_mov_b32 v34, v13
    buffer_atomic_add_f32 v34, v14, s[52:55], s66 offen offset:512 sc0 sc1
    v_mov_b32 v35, v13
    buffer_atomic_add_f32 v35, v14, s[52:55], s66 offen offset:768 sc0 sc1
    v_mov_b32 v36, v13
    buffer_atomic_add_f32 v36, v14, s[52:55], s66 offen offset:1024 sc0 sc1
    v_mov_b32 v37, v13
    buffer_atomic_add_f32 v37, v14, s[52:55], s66 offen offset:1280 sc0 sc1
    v_mov_b32 v38, v13
    buffer_atomic_add_f32 v38, v14, s[52:55], s66 offen offset:1536 sc0 sc1
    v_mov_b32 v39, v13
    buffer_atomic_add_f32 v39, v14, s[52:55], s66 offen offset:1792 sc0 sc1
    v_mov_b32 v40, v13
    buffer_atomic_add_f32 v40, v14, s[52:55], s66 offen offset:2048 sc0 sc1
    v_mov_b32 v41, v13
    buffer_atomic_add_f32 v41, v14, s[52:55], s66 offen offset:2304 sc0 sc1
    v_mov_b32 v42, v13
    buffer_atomic_add_f32 v42, v14, s[52:55], s66 offen offset:2560 sc0 sc1
    v_mov_b32 v43, v13
    buffer_atomic_add_f32 v43, v14, s[52:55], s66 offen offset:2816 sc0 sc1
    v_mov_b32 v44, v13
    buffer_atomic_add_f32 v44, v14, s[52:55], s66 offen offset:3072 sc0 sc1
    v_mov_b32 v45, v13
    buffer_atomic_add_f32 v45, v14, s[52:55], s66 offen offset:3328 sc0 sc1
    v_mov_b32 v46, v13
    buffer_atomic_add_f32 v46, v14, s[52:55], s66 offen offset:3584 sc0 sc1
    v_mov_b32 v47, v13
    buffer_atomic_add_f32 v47, v14, s[52:55], s66 offen offset:3840 sc0 sc1
    s_mov_b32 s66, 4096
    v_mov_b32 v48, v13
    buffer_atomic_add_f32 v48, v14, s[52:55], s66 offen offset:0 sc0 sc1
    v_mov_b32 v49, v13
    buffer_atomic_add_f32 v49, v14, s[52:55], s66 offen offset:256 sc0 sc1
    v_mov_b32 v50, v13
    buffer_atomic_add_f32 v50, v14, s[52:55], s66 offen offset:512 sc0 sc1
    v_mov_b32 v51, v13
    buffer_atomic_add_f32 v51, v14, s[52:55], s66 offen offset:768 sc0 sc1
    v_mov_b32 v52, v13
    buffer_atomic_add_f32 v52, v14, s[52:55], s66 offen offset:1024 sc0 sc1
    v_mov_b32 v53, v13
    buffer_atomic_add_f32 v53, v14, s[52:55], s66 offen offset:1280 sc0 sc1
    v_mov_b32 v54, v13
    buffer_atomic_add_f32 v54, v14, s[52:55], s66 offen offset:1536 sc0 sc1
    v_mov_b32 v55, v13
    buffer_atomic_add_f32 v55, v14, s[52:55], s66 offen offset:1792 sc0 sc1
    v_mov_b32 v56, v13
    buffer_atomic_add_f32 v56, v14, s[52:55], s66 offen offset:2048 sc0 sc1
    v_mov_b32 v57, v13
    buffer_atomic_add_f32 v57, v14, s[52:55], s66 offen offset:2304 sc0 sc1
    v_mov_b32 v58, v13
    buffer_atomic_add_f32 v58, v14, s[52:55], s66 offen offset:2560 sc0 sc1
    v_mov_b32 v59, v13
    buffer_atomic_add_f32 v59, v14, s[52:55], s66 offen offset:2816 sc0 sc1
    v_mov_b32 v60, v13
    buffer_atomic_add_f32 v60, v14, s[52:55], s66 offen offset:3072 sc0 sc1
    v_mov_b32 v61, v13
    buffer_atomic_add_f32 v61, v14, s[52:55], s66 offen offset:3328 sc0 sc1
    v_mov_b32 v62, v13
    buffer_atomic_add_f32 v62, v14, s[52:55], s66 offen offset:3584 sc0 sc1
    v_mov_b32 v63, v13
    buffer_atomic_add_f32 v63, v14, s[52:55], s66 offen offset:3840 sc0 sc1
    s_mov_b32 s66, 8192
    v_mov_b32 v64, v13
    buffer_atomic_add_f32 v64, v14, s[52:55], s66 offen offset:0 sc0 sc1
    v_mov_b32 v65, v13
    buffer_atomic_add_f32 v65, v14, s[52:55], s66 offen offset:256 sc0 sc1
    v_mov_b32 v66, v13
    buffer_atomic_add_f32 v66, v14, s[52:55], s66 offen offset:512 sc0 sc1
    v_mov_b32 v67, v13
    buffer_atomic_add_f32 v67, v14, s[52:55], s66 offen offset:768 sc0 sc1
    v_mov_b32 v68, v13
    buffer_atomic_add_f32 v68, v14, s[52:55], s66 offen offset:1024 sc0 sc1
    v_mov_b32 v69, v13
    buffer_atomic_add_f32 v69, v14, s[52:55], s66 offen offset:1280 sc0 sc1
    v_mov_b32 v70, v13
    buffer_atomic_add_f32 v70, v14, s[52:55], s66 offen offset:1536 sc0 sc1
    v_mov_b32 v71, v13
    buffer_atomic_add_f32 v71, v14, s[52:55], s66 offen offset:1792 sc0 sc1
    v_mov_b32 v72, v13
    buffer_atomic_add_f32 v72, v14, s[52:55], s66 offen offset:2048 sc0 sc1
    v_mov_b32 v73, v13
    buffer_atomic_add_f32 v73, v14, s[52:55], s66 offen offset:2304 sc0 sc1
    v_mov_b32 v74, v13
    buffer_atomic_add_f32 v74, v14, s[52:55], s66 offen offset:2560 sc0 sc1
    v_mov_b32 v75, v13
    buffer_atomic_add_f32 v75, v14, s[52:55], s66 offen offset:2816 sc0 sc1
    v_mov_b32 v76, v13
    buffer_atomic_add_f32 v76, v14, s[52:55], s66 offen offset:3072 sc0 sc1
    v_mov_b32 v77, v13
    buffer_atomic_add_f32 v77, v14, s[52:55], s66 offen offset:3328 sc0 sc1
    v_mov_b32 v78, v13
    buffer_atomic_add_f32 v78, v14, s[52:55], s66 offen offset:3584 sc0 sc1
    v_mov_b32 v79, v13
    buffer_atomic_add_f32 v79, v14, s[52:55], s66 offen offset:3840 sc0 sc1
    s_mov_b32 s66, 12288
    v_mov_b32 v80, v13
    s_waitcnt vmcnt(47)
    buffer_atomic_add_f32 v80, v14, s[52:55], s66 offen offset:0 sc0 sc1
    v_mov_b32 v81, v13
    s_waitcnt vmcnt(47)
    buffer_atomic_add_f32 v81, v14, s[52:55], s66 offen offset:256 sc0 sc1
    v_mov_b32 v82, v13
    s_waitcnt vmcnt(47)
    buffer_atomic_add_f32 v82, v14, s[52:55], s66 offen offset:512 sc0 sc1
    v_mov_b32 v83, v13
    s_waitcnt vmcnt(47)
    buffer_atomic_add_f32 v83, v14, s[52:55], s66 offen offset:768 sc0 sc1
    v_mov_b32 v84, v13
    s_waitcnt vmcnt(47)
    buffer_atomic_add_f32 v84, v14, s[52:55], s66 offen offset:1024 sc0 sc1
    v_mov_b32 v85, v13
    s_waitcnt vmcnt(47)
    buffer_atomic_add_f32 v85, v14, s[52:55], s66 offen offset:1280 sc0 sc1
    v_mov_b32 v86, v13
    s_waitcnt vmcnt(47)
    buffer_atomic_add_f32 v86, v14, s[52:55], s66 offen offset:1536 sc0 sc1
    v_mov_b32 v87, v13
    s_waitcnt vmcnt(47)
    buffer_atomic_add_f32 v87, v14, s[52:55], s66 offen offset:1792 sc0 sc1
    v_mov_b32 v88, v13
    s_waitcnt vmcnt(47)
    buffer_atomic_add_f32 v88, v14, s[52:55], s66 offen offset:2048 sc0 sc1
    v_mov_b32 v89, v13
    s_waitcnt vmcnt(47)
    buffer_atomic_add_f32 v89, v14, s[52:55], s66 offen offset:2304 sc0 sc1
    v_mov_b32 v90, v13
    s_waitcnt vmcnt(47)
    buffer_atomic_add_f32 v90, v14, s[52:55], s66 offen offset:2560 sc0 sc1
    v_mov_b32 v91, v13
    s_waitcnt vmcnt(47)
    buffer_atomic_add_f32 v91, v14, s[52:55], s66 offen offset:2816 sc0 sc1
    v_mov_b32 v92, v13
    s_waitcnt vmcnt(47)
    buffer_atomic_add_f32 v92, v14, s[52:55], s66 offen offset:3072 sc0 sc1
    v_mov_b32 v93, v13
    s_waitcnt vmcnt(47)
    buffer_atomic_add_f32 v93, v14, s[52:55], s66 offen offset:3328 sc0 sc1
    v_mov_b32 v94, v13
    s_waitcnt vmcnt(47)
    buffer_atomic_add_f32 v94, v14, s[52:55], s66 offen offset:3584 sc0 sc1
    v_mov_b32 v95, v13
    s_waitcnt vmcnt(47)
    buffer_atomic_add_f32 v95, v14, s[52:55], s66 offen offset:3840 sc0 sc1
    s_mov_b32 s66, 16384
    v_mov_b32 v96, v13
    s_waitcnt vmcnt(47)
    buffer_atomic_add_f32 v96, v14, s[52:55], s66 offen offset:0 sc0 sc1
    v_mov_b32 v97, v13
    s_waitcnt vmcnt(47)
    buffer_atomic_add_f32 v97, v14, s[52:55], s66 offen offset:256 sc0 sc1
    v_mov_b32 v98, v13
    s_waitcnt vmcnt(47)
    buffer_atomic_add_f32 v98, v14, s[52:55], s66 offen offset:512 sc0 sc1
    v_mov_b32 v99, v13
    s_waitcnt vmcnt(47)
    buffer_atomic_add_f32 v99, v14, s[52:55], s66 offen offset:768 sc0 sc1
    v_mov_b32 v100, v13
    s_waitcnt vmcnt(47)
    buffer_atomic_add_f32 v100, v14, s[52:55], s66 offen offset:1024 sc0 sc1
    v_mov_b32 v101, v13
    s_waitcnt vmcnt(47)
    buffer_atomic_add_f32 v101, v14, s[52:55], s66 offen offset:1280 sc0 sc1
    v_mov_b32 v102, v13
    s_waitcnt vmcnt(47)
    buffer_atomic_add_f32 v102, v14, s[52:55], s66 offen offset:1536 sc0 sc1
    v_mov_b32 v103, v13
    s_waitcnt vmcnt(47)
    buffer_atomic_add_f32 v103, v14, s[52:55], s66 offen offset:1792 sc0 sc1
    v_mov_b32 v104, v13
    s_waitcnt vmcnt(47)
    buffer_atomic_add_f32 v104, v14, s[52:55], s66 offen offset:2048 sc0 sc1
    v_mov_b32 v105, v13
    s_waitcnt vmcnt(47)
    buffer_atomic_add_f32 v105, v14, s[52:55], s66 offen offset:2304 sc0 sc1
    v_mov_b32 v106, v13
    s_waitcnt vmcnt(47)
    buffer_atomic_add_f32 v106, v14, s[52:55], s66 offen offset:2560 sc0 sc1
    v_mov_b32 v107, v13
    s_waitcnt vmcnt(47)
    buffer_atomic_add_f32 v107, v14, s[52:55], s66 offen offset:2816 sc0 sc1
    v_mov_b32 v108, v13
    s_waitcnt vmcnt(47)
    buffer_atomic_add_f32 v108, v14, s[52:55], s66 offen offset:3072 sc0 sc1
    v_mov_b32 v109, v13
    s_waitcnt vmcnt(47)
    buffer_atomic_add_f32 v109, v14, s[52:55], s66 offen offset:3328 sc0 sc1
    v_mov_b32 v110, v13
    s_waitcnt vmcnt(47)
    buffer_atomic_add_f32 v110, v14, s[52:55], s66 offen offset:3584 sc0 sc1
    v_mov_b32 v111, v13
    s_waitcnt vmcnt(47)
    buffer_atomic_add_f32 v111, v14, s[52:55], s66 offen offset:3840 sc0 sc1
    s_mov_b32 s66, 20480
    v_mov_b32 v112, v13
    s_waitcnt vmcnt(47)
    buffer_atomic_add_f32 v112, v14, s[52:55], s66 offen offset:0 sc0 sc1
    v_mov_b32 v113, v13
    s_waitcnt vmcnt(47)
    buffer_atomic_add_f32 v113, v14, s[52:55], s66 offen offset:256 sc0 sc1
    v_mov_b32 v114, v13
    s_waitcnt vmcnt(47)
    buffer_atomic_add_f32 v114, v14, s[52:55], s66 offen offset:512 sc0 sc1
    v_mov_b32 v115, v13
    s_waitcnt vmcnt(47)
    buffer_atomic_add_f32 v115, v14, s[52:55], s66 offen offset:768 sc0 sc1
    v_mov_b32 v116, v13
    s_waitcnt vmcnt(47)
    buffer_atomic_add_f32 v116, v14, s[52:55], s66 offen offset:1024 sc0 sc1
    v_mov_b32 v117, v13
    s_waitcnt vmcnt(47)
    buffer_atomic_add_f32 v117, v14, s[52:55], s66 offen offset:1280 sc0 sc1
    v_mov_b32 v118, v13
    s_waitcnt vmcnt(47)
    buffer_atomic_add_f32 v118, v14, s[52:55], s66 offen offset:1536 sc0 sc1
    v_mov_b32 v119, v13
    s_waitcnt vmcnt(47)
    buffer_atomic_add_f32 v119, v14, s[52:55], s66 offen offset:1792 sc0 sc1
    v_mov_b32 v120, v13
    s_waitcnt vmcnt(47)
    buffer_atomic_add_f32 v120, v14, s[52:55], s66 offen offset:2048 sc0 sc1
    v_mov_b32 v121, v13
    s_waitcnt vmcnt(47)
    buffer_atomic_add_f32 v121, v14, s[52:55], s66 offen offset:2304 sc0 sc1
    v_mov_b32 v122, v13
    s_waitcnt vmcnt(47)
    buffer_atomic_add_f32 v122, v14, s[52:55], s66 offen offset:2560 sc0 sc1
    v_mov_b32 v123, v13
    s_waitcnt vmcnt(47)
    buffer_atomic_add_f32 v123, v14, s[52:55], s66 offen offset:2816 sc0 sc1
    v_mov_b32 v124, v13
    s_waitcnt vmcnt(47)
    buffer_atomic_add_f32 v124, v14, s[52:55], s66 offen offset:3072 sc0 sc1
    v_mov_b32 v125, v13
    s_waitcnt vmcnt(47)
    buffer_atomic_add_f32 v125, v14, s[52:55], s66 offen offset:3328 sc0 sc1
    v_mov_b32 v126, v13
    s_waitcnt vmcnt(47)
    buffer_atomic_add_f32 v126, v14, s[52:55], s66 offen offset:3584 sc0 sc1
    v_mov_b32 v127, v13
    s_waitcnt vmcnt(47)
    buffer_atomic_add_f32 v127, v14, s[52:55], s66 offen offset:3840 sc0 sc1
    s_waitcnt vmcnt(0)
    v_max3_f32 v15, v32, v33, v34
    v_max3_f32 v15, v15, v35, v36
    v_max3_f32 v15, v15, v37, v38
    v_max3_f32 v15, v15, v39, v40
    v_max3_f32 v15, v15, v41, v42
    v_max3_f32 v15, v15, v43, v44
    v_max3_f32 v15, v15, v45, v46
    v_max3_f32 v15, v15, v47, v48
    v_max3_f32 v15, v15, v49, v50
    v_max3_f32 v15, v15, v51, v52
    v_max3_f32 v15, v15, v53, v54
    v_max3_f32 v15, v15, v55, v56
    v_max3_f32 v15, v15, v57, v58
    v_max3_f32 v15, v15, v59, v60
    v_max3_f32 v15, v15, v61, v62
    v_max3_f32 v15, v15, v63, v64
    v_max3_f32 v15, v15, v65, v66
    v_max3_f32 v15, v15, v67, v68
    v_max3_f32 v15, v15, v69, v70
    v_max3_f32 v15, v15, v71, v72
    v_max3_f32 v15, v15, v73, v74
    v_max3_f32 v15, v15, v75, v76
    v_max3_f32 v15, v15, v77, v78
    v_max3_f32 v15, v15, v79, v80
    v_max3_f32 v15, v15, v81, v82
    v_max3_f32 v15, v15, v83, v84
    v_max3_f32 v15, v15, v85, v86
    v_max3_f32 v15, v15, v87, v88
    v_max3_f32 v15, v15, v89, v90
    v_max3_f32 v15, v15, v91, v92
    v_max3_f32 v15, v15, v93, v94
    v_max3_f32 v15, v15, v95, v96
    v_max3_f32 v15, v15, v97, v98
    v_max3_f32 v15, v15, v99, v100
    v_max3_f32 v15, v15, v101, v102
    v_max3_f32 v15, v15, v103, v104
    v_max3_f32 v15, v15, v105, v106
    v_max3_f32 v15, v15, v107, v108
    v_max3_f32 v15, v15, v109, v110
    v_max3_f32 v15, v15, v111, v112
    v_max3_f32 v15, v15, v113, v114
    v_max3_f32 v15, v15, v115, v116
    v_max3_f32 v15, v15, v117, v118
    v_max3_f32 v15, v15, v119, v120
    v_max3_f32 v15, v15, v121, v122
    v_max3_f32 v15, v15, v123, v124
    v_max3_f32 v15, v15, v125, v126
    v_max_f32 v15, v15, v127
    v_mul_f32 v15, v15, v13
    v_cmp_eq_f32 vcc, 0x42000000, v15
    s_nop 4
    s_cbranch_vccz L_end
    s_mov_b32 s29, 0
L_f_b:
    s_mul_i32 s65, s29, 1152
    s_add_u32 s56, s22, s65
    s_addc_u32 s57, s23, 0
    s_mov_b32 s58, 1152
    s_mov_b32 s59, 0x20000
    s_mov_b32 s68, 0
    v_mov_b32 v19, v12
    s_nop 2
L_f_u:
    s_mul_i32 s66, s29, 12
    s_add_u32 s66, s66, s68
    s_lshl_b32 s66, s66, 8
    v_mov_b32 v15, 0
    buffer_load_dword v16, v14, s[52:55], s66 offen sc1
    s_add_u32 s85, s65, 26624
    buffer_load_ushort v17, v19, s[52:55], s85 offen sc1
    buffer_load_ushort v18, v19, s[40:43], s65 offen
    s_waitcnt vmcnt(0)
    v_mov_b32_dpp v20, v16 row_newbcast:6 row_mask:0xf bank_mask:0x3
    v_mov_b32_dpp v20, v16 row_newbcast:14 row_mask:0xf bank_mask:0xc
    v_add_f32 v15, v15, v16
    v_cmp_eq_f32 vcc, 0x42040000, v20
    v_cvt_pk_bf16_f32 v15, v15, v15
    v_and_b32 v15, 0xffff0000, v15
    v_lshlrev_b32 v21, 16, v17
    s_and_b64 vcc, vcc, s[70:71]
    v_mul_f32 v15, v15, v21
    v_cvt_pk_bf16_f32 v15, v15, v15
    v_and_b32 v15, 0xffff0000, v15
    v_lshlrev_b32 v21, 16, v18
    v_add_f32 v15, v15, v21
    v_cvt_pk_bf16_f32 v15, v15, v15
    s_and_saveexec_b64 s[82:83], vcc
    s_nop 1
    s_cbranch_execz L_f_skip
    buffer_store_short v15, v19, s[56:59], 0 offen offset:0
L_f_skip:
    s_mov_b64 exec, s[82:83]
    v_add_u32 v19, 96, v19
    s_add_u32 s68, s68, 1
    s_cmp_lt_u32 s68, 12
    s_nop 0
    s_cbranch_scc1 L_f_u
    s_add_u32 s29, s29, 1
    s_cmp_lt_u32 s29, 8
    s_cbranch_scc1 L_f_b
L_end:
L_end2:
    s_endpgm
L_code_end:
.section .rodata,"a"
.p2align 6
.amdhsa_kernel recurrent_scan__mha_block_cached__glu_gated_swiglu__decode_kernel
  .amdhsa_next_free_vgpr 256
  .amdhsa_next_free_sgpr 102
  .amdhsa_accum_offset 256
  .amdhsa_group_segment_fixed_size 0
  .amdhsa_kernarg_size 96
  .amdhsa_user_sgpr_count 2
  .amdhsa_user_sgpr_kernarg_segment_ptr 1
  .amdhsa_system_sgpr_workgroup_id_x 1
  .amdhsa_float_denorm_mode_32 3
.end_amdhsa_kernel
```
